```python
import torch

def _softmax(x, axis=-1):
    return torch.softmax(x, dim=axis)

def _gelu(x):
    return torch.nn.functional.gelu(x, approximate='tanh')

def _silu(x):
    return torch.nn.functional.silu(x)

def _sigmoid(x):
    return torch.sigmoid(x)

def _layernorm(x, axis=-1, eps=1e-05):
    m = x.mean(dim=axis, keepdim=True)
    v = x.var(dim=axis, keepdim=True, unbiased=False)
    return (x - m) / torch.sqrt(v + eps)

def _scatter_add(tgt, idx, src, axis=0):
    return tgt.clone().index_add_(axis, idx, src)

def _segment_sum(src, seg, n):
    out = torch.zeros((n,) + src.shape[1:], dtype=src.dtype)
    return out.index_add_(0, seg, src)

def _pad(x, pw):
    flat = tuple((v for pair in reversed(pw) for v in pair))
    return torch.nn.functional.pad(x, flat)
kernel_name = 'gated_mix__memory_aug_recurrent_mem_tr__moe_arch_mod__prompt'

def setup_inputs():

    _w = lambda a: (lambda t: t.to(torch.bfloat16) if t.is_floating_point() else t)(torch.as_tensor(a))

    def _A_setup():
        B, S, Dm = (1, 2048, 1024)
        H, Dh = (32, 128)
        M, seg = (8, 32)
        seg = min(seg, S)
        S = S // seg * seg
        return {'x': _w((lambda *s: torch.randn(*s, dtype=torch.bfloat16) * 0.05)(B, S, Dm)), 'mem0': _w((lambda *s: torch.randn(*s, dtype=torch.bfloat16) * 0.8)(B, M, Dm)), 'Wq': _w((lambda *s: torch.randn(*s, dtype=torch.bfloat16) * 3.2)(Dm, H, Dh) * Dm ** (-0.5)), 'Wk': _w((lambda *s: torch.randn(*s, dtype=torch.bfloat16) * 3.2)(Dm, H, Dh) * Dm ** (-0.5)), 'Wv': _w((lambda *s: torch.randn(*s, dtype=torch.bfloat16) * 0.8)(Dm, H, Dh) * Dm ** (-0.5)), 'Wo': _w((lambda *s: torch.randn(*s, dtype=torch.bfloat16) * 0.8)(H, Dh, Dm) * (H * Dh) ** (-0.5)), 'seg_len': seg}
    _A_in = _A_setup()

    def _B_setup():
        B, S, D, F, C = (1, 2048, 1024, 3584, 1)
        return {'x': _w((lambda *s: torch.randn(*s, dtype=torch.bfloat16) * 0.05)(B, S, D)), 'w_r': _w((lambda *s: torch.randn(*s, dtype=torch.bfloat16) * 1.6)(D)), 'w_gate': _w((lambda *s: torch.randn(*s, dtype=torch.bfloat16) * 0.2)(D, F)), 'w_up': _w((lambda *s: torch.randn(*s, dtype=torch.bfloat16) * 0.2)(D, F)), 'w_down': _w((lambda *s: torch.randn(*s, dtype=torch.bfloat16) * 0.2)(F, D))}
    _B_in = _B_setup()
    return {'A_x': _A_in['x'], 'A_mem0': _A_in['mem0'], 'A_Wq': _A_in['Wq'], 'A_Wk': _A_in['Wk'], 'A_Wv': _A_in['Wv'], 'A_Wo': _A_in['Wo'], 'A_seg_len': _A_in['seg_len'], 'B_x': _B_in['x'], 'B_w_r': _B_in['w_r'], 'B_w_gate': _B_in['w_gate'], 'B_w_up': _B_in['w_up'], 'B_w_down': _B_in['w_down'], 'gate_w': _w((lambda *s: torch.randn(*s, dtype=torch.bfloat16) * 0.05)(1024) * 16.0)}

def reference(A_x, A_mem0, A_Wq, A_Wk, A_Wv, A_Wo, A_seg_len, B_x, B_w_r, B_w_gate, B_w_up, B_w_down, gate_w):

    def _A_ref(x, mem0, Wq, Wk, Wv, Wo, seg_len):
        B, S, Dm = x.shape
        H, Dh = (Wq.shape[1], Wq.shape[2])
        M = mem0.shape[1]
        scale = Dh ** (-0.5)
        n_seg = S // seg_len
        L = M + seg_len
        idx = torch.arange(L)
        mask = (idx[:, None] < M) | (idx[:, None] >= idx[None, :])
        mem = mem0
        outs = []
        for s in range(n_seg):
            xs = x[:, s * seg_len:(s + 1) * seg_len, :].clone()
            h = torch.concatenate([mem, xs], axis=1)
            q = torch.einsum('btd,dhe->bhte', h, Wq)
            k = torch.einsum('btd,dhe->bhte', h, Wk)
            v = torch.einsum('btd,dhe->bhte', h, Wv)
            scores = torch.einsum('bhqe,bhke->bhqk', q, k) * scale
            scores = torch.where(mask[None, None], scores, -1000000000.0)
            p = _softmax(scores, axis=-1)
            o = torch.einsum('bhqk,bhke->bhqe', p, v)
            o = torch.einsum('bhte,hed->btd', o, Wo)
            mem = o[:, :M, :].clone()
            outs.append(o[:, M:, :])
        return torch.concatenate(outs, axis=1)

    def _B_ref(x, w_r, w_gate, w_up, w_down):
        B, S, D = x.shape
        C = 1
        r = x @ w_r
        idx = torch.argsort(-r, axis=-1)[:, :C]
        idx_e = (lambda x, n, axis: torch.repeat_interleave(x, n, dim=axis))(idx.reshape(B, C, 1), D, axis=2)
        x_sel = (lambda x, i, axis: torch.take_along_dim(x, i, dim=axis))(x, idx_e, axis=1)
        g = _silu(x_sel @ w_gate)
        u = x_sel @ w_up
        y = g * u @ w_down
        r_sel = _sigmoid((lambda x, i, axis: torch.take_along_dim(x, i, dim=axis))(r, idx, axis=1))
        y = y * r_sel.reshape(B, C, 1)
        b_off = (torch.arange(B) * S).reshape(B, 1)
        flat_idx = (idx + b_off).reshape(B * C)
        zero = (x * 0.0).reshape(B * S, D)
        upd = _scatter_add(zero, flat_idx, y.reshape(B * C, D), axis=0)
        return x + upd.reshape(B, S, D)
    x = A_x
    g = _sigmoid((x * gate_w).sum(-1, keepdims=True))
    a = _A_ref(x, A_mem0, A_Wq, A_Wk, A_Wv, A_Wo, A_seg_len)
    b = _B_ref(x, B_w_r, B_w_gate, B_w_up, B_w_down)
    return g * a + (1 - g) * b
```

```asm
; @launch grid=(256,1,1) block=(256,1,1) lds=163840
.amdgcn_target "amdgcn-amd-amdhsa--gfx950"
.text
.globl gated_mix__memory_aug_recurrent_mem_tr__moe_arch_mod__prompt_kernel
.p2align 8
.type gated_mix__memory_aug_recurrent_mem_tr__moe_arch_mod__prompt_kernel,@function
gated_mix__memory_aug_recurrent_mem_tr__moe_arch_mod__prompt_kernel:
s_cmp_ge_u32 s2, 256
s_cbranch_scc1 L_exit
s_load_dwordx4 s[20:23], s[0:1], 112
s_getreg_b32 s16, hwreg(HW_REG_XCC_ID, 0, 3)
v_lshrrev_b32 v1, 6, v0
v_and_b32 v0, 63, v0
v_readfirstlane_b32 s12, v1
s_mov_b32 s15, 100000
s_mov_b32 s3, 0
s_mov_b32 s98, 512
s_mov_b32 s99, 0
s_waitcnt lgkmcnt(0)
s_mov_b32 s4, s22
s_mov_b32 s5, s23
s_mov_b32 s6, 0x10000000
s_mov_b32 s7, 0x20000
s_mov_b32 s8, s20
s_mov_b32 s9, s21
s_mov_b32 s10, 0x100
s_mov_b32 s11, 0x20000
s_lshl_b32 s18, s16, 5
v_mov_b32 v2, s18
v_mov_b32 v3, 1
s_cmp_eq_u32 s12, 0
s_cbranch_scc0 L_norank
s_mov_b64 exec, 1
buffer_atomic_add v3, v2, s[8:11], 0 offen sc0
s_mov_b64 exec, -1
L_norank:
s_lshl_b32 s18, s2, 13
s_lshl_b32 s19, s12, 11
s_add_u32 s18, s18, s19
s_add_u32 s18, s18, 0x8000000
v_lshlrev_b32 v8, 4, v0
v_mov_b32 v4, -1
v_mov_b32 v5, -1
v_mov_b32 v6, -1
v_mov_b32 v7, -1
buffer_store_dwordx4 v[4:7], v8, s[4:7], s18 offen sc1
buffer_store_dwordx4 v[4:7], v8, s[4:7], s18 offen offset:1024 sc1
s_cmp_eq_u32 s12, 0
s_cbranch_scc0 L_norank2
s_waitcnt vmcnt(2)
v_mov_b32 v10, 0
s_mov_b64 exec, 1
ds_write_b32 v10, v3
s_mov_b64 exec, -1
s_waitcnt lgkmcnt(0)
L_norank2:
s_barrier
v_mov_b32 v10, 0
ds_read_b32 v3, v10
s_waitcnt lgkmcnt(0)
v_readfirstlane_b32 s17, v3
s_barrier
s_lshl_b32 s13, s16, 5
s_add_u32 s13, s13, s17
s_cmp_lt_u32 s17, 32
s_cbranch_scc1 L_role
s_waitcnt vmcnt(0)
s_barrier
s_cmp_eq_u32 s12, 0
s_cbranch_scc0 L_arv_ovf
s_cmp_eq_u32 s3, 0
s_cbranch_scc0 L_arv_ovf
s_load_dwordx2 s[28:29], s[0:1], 112
s_waitcnt lgkmcnt(0)
s_mov_b32 s8, s28
s_mov_b32 s9, s29
s_mov_b32 s10, 0x100
s_mov_b32 s11, 0x20000
s_lshl_b32 s18, s16, 5
v_mov_b32 v2, s18
s_lshl_b32 s18, s98, 12
s_add_u32 s18, s18, 1
v_mov_b32 v3, s18
s_mov_b64 exec, 1
buffer_atomic_add v3, v2, s[8:11], 0 offen offset:4
s_mov_b64 exec, -1
L_arv_ovf:
s_mov_b32 s3, 1
s_load_dwordx2 s[28:29], s[0:1], 112
s_waitcnt lgkmcnt(0)
s_mov_b32 s8, s28
s_mov_b32 s9, s29
s_mov_b32 s10, 0x100
s_mov_b32 s11, 0x20000
v_lshlrev_b32 v2, 2, v0
L_arr_ovf:
buffer_load_dword v3, v2, s[8:11], 0 offen sc1
s_waitcnt vmcnt(0)
L_arr_ovf_c:
v_readlane_b32 s18, v3, 1
v_readlane_b32 s19, v3, 9
v_readlane_b32 s20, v3, 17
v_readlane_b32 s21, v3, 25
v_readlane_b32 s22, v3, 33
v_readlane_b32 s23, v3, 41
v_readlane_b32 s24, v3, 49
v_readlane_b32 s25, v3, 57
s_add_u32 s18, s18, s19
s_add_u32 s18, s18, s20
s_add_u32 s18, s18, s21
s_add_u32 s18, s18, s22
s_add_u32 s18, s18, s23
s_add_u32 s18, s18, s24
s_add_u32 s18, s18, s25
s_and_b32 s19, s18, 0xfff
s_cmp_eq_u32 s19, 256
s_cbranch_scc1 L_arr_ovf_ok
s_sub_u32 s15, s15, 1
s_cbranch_scc1 L_exit
s_sleep 4
s_branch L_arr_ovf
L_arr_ovf_ok:
s_lshr_b32 s18, s18, 12
s_cmp_gt_u32 s18, 131072
s_cselect_b32 s99, 0x2000, 0
v_readlane_b32 s18, v3, 0
v_readlane_b32 s19, v3, 8
v_readlane_b32 s20, v3, 16
v_readlane_b32 s21, v3, 24
v_readlane_b32 s22, v3, 32
v_readlane_b32 s23, v3, 40
v_readlane_b32 s24, v3, 48
v_readlane_b32 s25, v3, 56
s_mov_b32 s14, 1
s_cmp_eq_u32 s18, 32
s_cselect_b32 s14, s14, 0
s_cmp_eq_u32 s19, 32
s_cselect_b32 s14, s14, 0
s_cmp_eq_u32 s20, 32
s_cselect_b32 s14, s14, 0
s_cmp_eq_u32 s21, 32
s_cselect_b32 s14, s14, 0
s_cmp_eq_u32 s22, 32
s_cselect_b32 s14, s14, 0
s_cmp_eq_u32 s23, 32
s_cselect_b32 s14, s14, 0
s_cmp_eq_u32 s24, 32
s_cselect_b32 s14, s14, 0
s_cmp_eq_u32 s25, 32
s_cselect_b32 s14, s14, 0
s_sub_u32 s26, s17, 32
s_max_u32 s27, s18, 32
s_sub_u32 s27, s27, 32
s_cmp_gt_u32 s16, 0
s_cselect_b32 s27, s27, 0
s_add_u32 s26, s26, s27
s_max_u32 s27, s19, 32
s_sub_u32 s27, s27, 32
s_cmp_gt_u32 s16, 1
s_cselect_b32 s27, s27, 0
s_add_u32 s26, s26, s27
s_max_u32 s27, s20, 32
s_sub_u32 s27, s27, 32
s_cmp_gt_u32 s16, 2
s_cselect_b32 s27, s27, 0
s_add_u32 s26, s26, s27
s_max_u32 s27, s21, 32
s_sub_u32 s27, s27, 32
s_cmp_gt_u32 s16, 3
s_cselect_b32 s27, s27, 0
s_add_u32 s26, s26, s27
s_max_u32 s27, s22, 32
s_sub_u32 s27, s27, 32
s_cmp_gt_u32 s16, 4
s_cselect_b32 s27, s27, 0
s_add_u32 s26, s26, s27
s_max_u32 s27, s23, 32
s_sub_u32 s27, s27, 32
s_cmp_gt_u32 s16, 5
s_cselect_b32 s27, s27, 0
s_add_u32 s26, s26, s27
s_max_u32 s27, s24, 32
s_sub_u32 s27, s27, 32
s_cmp_gt_u32 s16, 6
s_cselect_b32 s27, s27, 0
s_add_u32 s26, s26, s27
s_min_u32 s27, s18, 32
s_add_u32 s13, s27, s26
s_add_u32 s13, s13, 0
s_add_u32 s26, s26, s27
s_cmp_lt_u32 s26, 32
s_cbranch_scc1 L_role
s_sub_u32 s26, s26, 32
s_min_u32 s27, s19, 32
s_add_u32 s13, s27, s26
s_add_u32 s13, s13, 32
s_add_u32 s26, s26, s27
s_cmp_lt_u32 s26, 32
s_cbranch_scc1 L_role
s_sub_u32 s26, s26, 32
s_min_u32 s27, s20, 32
s_add_u32 s13, s27, s26
s_add_u32 s13, s13, 64
s_add_u32 s26, s26, s27
s_cmp_lt_u32 s26, 32
s_cbranch_scc1 L_role
s_sub_u32 s26, s26, 32
s_min_u32 s27, s21, 32
s_add_u32 s13, s27, s26
s_add_u32 s13, s13, 96
s_add_u32 s26, s26, s27
s_cmp_lt_u32 s26, 32
s_cbranch_scc1 L_role
s_sub_u32 s26, s26, 32
s_min_u32 s27, s22, 32
s_add_u32 s13, s27, s26
s_add_u32 s13, s13, 128
s_add_u32 s26, s26, s27
s_cmp_lt_u32 s26, 32
s_cbranch_scc1 L_role
s_sub_u32 s26, s26, 32
s_min_u32 s27, s23, 32
s_add_u32 s13, s27, s26
s_add_u32 s13, s13, 160
s_add_u32 s26, s26, s27
s_cmp_lt_u32 s26, 32
s_cbranch_scc1 L_role
s_sub_u32 s26, s26, 32
s_min_u32 s27, s24, 32
s_add_u32 s13, s27, s26
s_add_u32 s13, s13, 192
s_add_u32 s26, s26, s27
s_cmp_lt_u32 s26, 32
s_cbranch_scc1 L_role
s_sub_u32 s26, s26, 32
s_min_u32 s27, s25, 32
s_add_u32 s13, s27, s26
s_add_u32 s13, s13, 224
s_add_u32 s26, s26, s27
s_cmp_lt_u32 s26, 32
s_cbranch_scc1 L_role
s_sub_u32 s26, s26, 32
s_branch L_exit
L_role:
s_and_b32 s13, s13, 255
s_cmp_lt_u32 s13, 128
s_cbranch_scc0 L_gemm
v_and_b32 v1, 15, v0
v_lshrrev_b32 v2, 4, v0
s_mov_b32 s41, 0x05040100
s_mov_b32 s42, 0x07060302
s_load_dwordx8 s[68:75], s[0:1], 16
s_lshr_b32 s26, s13, 5
s_and_b32 s27, s13, 31
s_and_b32 s18, s13, 1
v_bfe_u32 v156, v0, 4, 2
v_lshlrev_b32 v156, 1, v156
v_and_b32 v246, 7, v0
v_xor_b32 v246, v246, v156
v_lshlrev_b32 v246, 4, v246
s_lshl_b32 s76, s18, 1
v_bfe_u32 v156, v0, 3, 2
v_xor_b32 v156, s76, v156
v_lshlrev_b32 v156, 5, v156
v_and_b32 v157, 3, v0
v_lshl_add_u32 v156, v157, 3, v156
v_lshrrev_b32 v157, 2, v0
v_lshl_add_u32 v156, v157, 7, v156
s_lshl_b32 s76, s12, 15
v_add_u32 v156, s76, v156
v_xor_b32 v157, 32, v156
v_bfe_u32 v224, v0, 3, 2
v_lshrrev_b32 v225, 5, v0
v_lshlrev_b32 v244, 4, v224
v_lshl_add_u32 v244, v225, 1, v244
v_lshl_add_u32 v244, v244, 13, v246
s_lshl_b32 s18, s12, 21
s_lshr_b32 s19, s13, 1
s_lshl_b32 s19, s19, 7
s_add_u32 s18, s18, s19
v_add_u32 v244, s18, v244
v_lshrrev_b32 v245, 1, v224
v_lshlrev_b32 v245, 5, v245
v_and_b32 v224, 1, v224
v_add_u32 v245, v245, v224
v_lshl_add_u32 v245, v225, 4, v245
v_lshl_add_u32 v245, v245, 11, v246
s_lshl_b32 s18, s26, 21
s_lshl_b32 s19, s12, 19
s_add_u32 s18, s18, s19
s_lshr_b32 s19, s27, 1
s_lshl_b32 s19, s19, 7
s_add_u32 s18, s18, s19
v_add_u32 v245, s18, v245
s_waitcnt lgkmcnt(0)
s_lshl_b32 s18, s27, 2
s_add_u32 s18, s18, s12
s_lshl_b32 s18, s18, 16
s_lshl_b32 s19, s26, 11
s_add_u32 s18, s18, s19
s_add_u32 s18, s18, 384
v_lshrrev_b32 v158, 3, v0
v_and_b32 v159, 7, v0
v_lshlrev_b32 v159, 4, v159
v_lshl_add_u32 v158, v158, 13, v159
v_add_u32 v158, s18, v158
s_lshl_b32 s18, s27, 2
s_add_u32 s18, s18, s12
s_lshl_b32 s18, s18, 14
s_lshl_b32 s19, s26, 21
s_add_u32 s18, s18, s19
s_add_u32 s18, s18, 384
v_lshrrev_b32 v188, 3, v0
v_lshl_add_u32 v188, v188, 11, v159
v_add_u32 v188, s18, v188
s_cmp_eq_u32 s26, 3
s_cselect_b32 s77, 0, 0x7f000000
s_mov_b32 s8, s68
s_mov_b32 s9, s69
s_mov_b32 s10, 0x800000
s_mov_b32 s11, 0x20000
buffer_load_dwordx4 v[184:187], v158, s[8:11], 0 offen offset:0
buffer_load_dwordx4 v[184:187], v158, s[8:11], 0 offen offset:1024
buffer_load_dwordx4 v[184:187], v158, s[8:11], s77 offen offset:1536
s_mov_b32 s8, s68
s_mov_b32 s9, s69
s_mov_b32 s10, 0x800000
s_mov_b32 s11, 0x20000
s_add_u32 m0, s76, 0
s_mov_b32 s18, 0x0
buffer_load_dwordx4 v244, s[8:11], s18 offen  lds
s_add_u32 m0, s76, 1024
s_mov_b32 s18, 0x8000
buffer_load_dwordx4 v244, s[8:11], s18 offen  lds
s_add_u32 m0, s76, 2048
s_mov_b32 s18, 0x2000
buffer_load_dwordx4 v244, s[8:11], s18 offen  lds
s_add_u32 m0, s76, 3072
s_mov_b32 s18, 0xa000
buffer_load_dwordx4 v244, s[8:11], s18 offen  lds
s_add_u32 m0, s76, 4096
s_mov_b32 s18, 0x10000
buffer_load_dwordx4 v244, s[8:11], s18 offen  lds
s_add_u32 m0, s76, 5120
s_mov_b32 s18, 0x18000
buffer_load_dwordx4 v244, s[8:11], s18 offen  lds
s_add_u32 m0, s76, 6144
s_mov_b32 s18, 0x12000
buffer_load_dwordx4 v244, s[8:11], s18 offen  lds
s_add_u32 m0, s76, 7168
s_mov_b32 s18, 0x1a000
buffer_load_dwordx4 v244, s[8:11], s18 offen  lds
s_add_u32 m0, s76, 8192
s_mov_b32 s18, 0x80000
buffer_load_dwordx4 v244, s[8:11], s18 offen  lds
s_add_u32 m0, s76, 9216
s_mov_b32 s18, 0x88000
buffer_load_dwordx4 v244, s[8:11], s18 offen  lds
s_add_u32 m0, s76, 10240
s_mov_b32 s18, 0x82000
buffer_load_dwordx4 v244, s[8:11], s18 offen  lds
s_add_u32 m0, s76, 11264
s_mov_b32 s18, 0x8a000
buffer_load_dwordx4 v244, s[8:11], s18 offen  lds
s_add_u32 m0, s76, 12288
s_mov_b32 s18, 0x90000
buffer_load_dwordx4 v244, s[8:11], s18 offen  lds
s_add_u32 m0, s76, 13312
s_mov_b32 s18, 0x98000
buffer_load_dwordx4 v244, s[8:11], s18 offen  lds
s_add_u32 m0, s76, 14336
s_mov_b32 s18, 0x92000
buffer_load_dwordx4 v244, s[8:11], s18 offen  lds
s_add_u32 m0, s76, 15360
s_mov_b32 s18, 0x9a000
buffer_load_dwordx4 v244, s[8:11], s18 offen  lds
s_mov_b32 s8, s68
s_mov_b32 s9, s69
s_mov_b32 s10, 0x800000
s_mov_b32 s11, 0x20000
s_add_u32 m0, s76, 16384
s_mov_b32 s18, 0x100000
buffer_load_dwordx4 v244, s[8:11], s18 offen  lds
s_add_u32 m0, s76, 17408
s_mov_b32 s18, 0x108000
buffer_load_dwordx4 v244, s[8:11], s18 offen  lds
s_add_u32 m0, s76, 18432
s_mov_b32 s18, 0x102000
buffer_load_dwordx4 v244, s[8:11], s18 offen  lds
s_add_u32 m0, s76, 19456
s_mov_b32 s18, 0x10a000
buffer_load_dwordx4 v244, s[8:11], s18 offen  lds
s_add_u32 m0, s76, 20480
s_mov_b32 s18, 0x110000
buffer_load_dwordx4 v244, s[8:11], s18 offen  lds
s_add_u32 m0, s76, 21504
s_mov_b32 s18, 0x118000
buffer_load_dwordx4 v244, s[8:11], s18 offen  lds
s_add_u32 m0, s76, 22528
s_mov_b32 s18, 0x112000
buffer_load_dwordx4 v244, s[8:11], s18 offen  lds
s_add_u32 m0, s76, 23552
s_mov_b32 s18, 0x11a000
buffer_load_dwordx4 v244, s[8:11], s18 offen  lds
s_add_u32 m0, s76, 24576
s_mov_b32 s18, 0x180000
buffer_load_dwordx4 v244, s[8:11], s18 offen  lds
s_add_u32 m0, s76, 25600
s_mov_b32 s18, 0x188000
buffer_load_dwordx4 v244, s[8:11], s18 offen  lds
s_add_u32 m0, s76, 26624
s_mov_b32 s18, 0x182000
buffer_load_dwordx4 v244, s[8:11], s18 offen  lds
s_add_u32 m0, s76, 27648
s_mov_b32 s18, 0x18a000
buffer_load_dwordx4 v244, s[8:11], s18 offen  lds
s_add_u32 m0, s76, 28672
s_mov_b32 s18, 0x190000
buffer_load_dwordx4 v244, s[8:11], s18 offen  lds
s_add_u32 m0, s76, 29696
s_mov_b32 s18, 0x198000
buffer_load_dwordx4 v244, s[8:11], s18 offen  lds
s_add_u32 m0, s76, 30720
s_mov_b32 s18, 0x192000
buffer_load_dwordx4 v244, s[8:11], s18 offen  lds
s_add_u32 m0, s76, 31744
s_mov_b32 s18, 0x19a000
buffer_load_dwordx4 v244, s[8:11], s18 offen  lds
s_lshl_b32 s18, s2, 16
s_lshl_b32 s19, s12, 10
s_add_u32 s18, s18, s19
s_add_u32 s18, s18, 0x6000000
s_add_u32 s28, s4, s18
s_addc_u32 s29, s5, 0
s_load_dword s18, s[28:29], 4096
s_mov_b32 s86, -1
s_mov_b32 s87, -1
s_waitcnt lgkmcnt(0)
s_memtime s[20:21]
s_waitcnt lgkmcnt(0)
s_load_dword s18, s[28:29], 0
s_waitcnt lgkmcnt(0)
s_memtime s[22:23]
s_waitcnt lgkmcnt(0)
s_sub_u32 s18, s22, s20
s_min_u32 s86, s86, s18
s_load_dword s18, s[28:29], 8192
s_waitcnt lgkmcnt(0)
s_memtime s[20:21]
s_waitcnt lgkmcnt(0)
s_sub_u32 s18, s20, s22
s_min_u32 s87, s87, s18
s_load_dword s18, s[28:29], 24576
s_waitcnt lgkmcnt(0)
s_memtime s[22:23]
s_waitcnt lgkmcnt(0)
s_sub_u32 s18, s22, s20
s_min_u32 s87, s87, s18
s_load_dword s18, s[28:29], 16384
s_waitcnt lgkmcnt(0)
s_memtime s[20:21]
s_waitcnt lgkmcnt(0)
s_sub_u32 s18, s20, s22
s_min_u32 s86, s86, s18
s_lshl_b32 s18, s12, 3
s_add_u32 s18, s18, 131072
v_mov_b32 v224, s86
v_mov_b32 v225, s87
v_mov_b32 v226, s18
ds_write_b64 v226, v[224:225]
s_waitcnt lgkmcnt(0)
v_and_b32 v224, 1, v1
v_mul_u32_u24 v224, 0xaaaa, v224
v_add_u32 v3, 0x4444, v224
v_cmp_lt_u32 s[44:45], 7, v1
s_mov_b32 s46, 0xffff0000
s_mov_b32 s48, 0x00ff00ff
s_mov_b32 s49, 0x00ff00ff
v_lshlrev_b32 v7, 4, v0
v_lshlrev_b32 v27, 3, v0
s_lshl_b32 s18, s12, 10
v_add_u32 v6, s18, v7
s_lshl_b32 s18, s26, 14
s_lshl_b32 s19, s12, 12
s_add_u32 s19, s18, s19
v_add_u32 v4, s19, v7
v_add_u32 v5, 0x10000, v4
v_lshrrev_b32 v224, 2, v0
v_lshlrev_b32 v224, 10, v224
v_bfe_u32 v225, v0, 1, 1
v_lshl_add_u32 v224, v225, 4, v224
v_and_b32 v225, 1, v0
v_lshl_add_u32 v224, v225, 5, v224
v_add_u32 v224, 972, v224
v_add_u32 v17, s18, v224
s_lshr_b32 s19, s27, 1
s_lshl_b32 s19, s19, 10
s_add_u32 s18, s18, s19
s_and_b32 s19, s27, 1
s_lshl_b32 s19, s19, 4
s_add_u32 s18, s18, s19
v_and_b32 v224, 7, v1
v_lshlrev_b32 v225, 5, v224
v_lshl_add_u32 v225, v2, 8, v225
v_add_u32 v24, s18, v225
v_add_u32 v11, 0x10000, v24
v_lshrrev_b32 v226, 2, v1
v_and_b32 v227, 3, v1
v_lshlrev_b32 v227, 2, v227
v_lshl_add_u32 v225, v226, 8, v227
v_lshl_add_u32 v225, v2, 6, v225
v_add_u32 v12, s18, v225
v_mov_b32 v225, 0x7ff00000
v_cndmask_b32 v14, v11, v225, s[44:45]
s_lshr_b32 s18, s13, 2
s_lshl_b32 s18, s18, 12
s_add_u32 s18, s18, 0x20000
v_lshlrev_b32 v225, 4, v224
v_lshl_add_u32 v225, v2, 7, v225
v_add_u32 v9, s18, v225
v_and_b32 v228, 1, v1
v_lshl_add_u32 v228, v226, 1, v228
v_lshlrev_b32 v228, 4, v228
v_lshl_add_u32 v228, v2, 7, v228
v_add_u32 v10, s18, v228
s_and_b32 s19, s13, 3
s_lshl_b32 s19, s19, 9
s_add_u32 s18, s18, s19
v_add_u32 v23, s18, v27
s_bitcmp0_b32 s12, 0
s_cselect_b32 s19, 2048, 0
s_add_u32 s18, s18, s19
v_lshl_add_u32 v225, v226, 7, v227
v_lshl_add_u32 v225, v2, 5, v225
v_add_u32 v8, s18, v225
s_lshr_b32 s18, s27, 2
s_lshl_b32 s18, s18, 14
s_and_b32 s19, s27, 3
s_lshl_b32 s19, s19, 11
s_add_u32 s18, s18, s19
s_add_u32 s18, s18, 0x40000
v_add_u32 v225, s18, v27
s_lshl_b32 s18, s26, 9
v_add_u32 v13, s18, v225
s_cmp_eq_u32 s12, 0
s_cselect_b32 s19, 256, 0
v_lshlrev_b32 v226, 2, v0
v_sub_u32 v225, v225, v226
v_add_u32 v225, s19, v225
v_add_u32 v255, s18, v225
s_add_u32 s18, s26, 1
s_and_b32 s18, s18, 3
s_lshl_b32 s18, s18, 9
v_add_u32 v252, s18, v225
s_add_u32 s18, s26, 2
s_and_b32 s18, s18, 3
s_lshl_b32 s18, s18, 9
v_add_u32 v253, s18, v225
s_add_u32 s18, s26, 3
s_and_b32 s18, s18, 3
s_lshl_b32 s18, s18, 9
v_add_u32 v254, s18, v225
s_lshr_b32 s18, s13, 2
s_lshl_b32 s18, s18, 14
s_and_b32 s19, s13, 3
s_lshl_b32 s19, s19, 11
s_add_u32 s20, s19, 0x4000000
s_mov_b32 s21, 0x2000000
s_mov_b32 s36, 21504
s_mov_b32 s37, 37888
s_cmp_eq_u32 s12, 2
s_cselect_b32 s21, 0x2001000, s21
s_cselect_b32 s20, 0x0, s20
s_cselect_b32 s36, 25600, s36
s_cselect_b32 s37, 29696, s37
s_cmp_eq_u32 s12, 3
s_cselect_b32 s21, 0x800, s21
s_cselect_b32 s20, 0x1800, s20
s_cselect_b32 s36, 31744, s36
s_cselect_b32 s37, 35840, s37
s_add_u32 s21, s21, s18
s_add_u32 s20, s20, s18
v_add_u32 v15, s21, v7
v_add_u32 v16, s20, v7
v_add_u32 v18, 21504, v7
s_and_b32 s19, s12, 1
s_lshl_b32 s18, s13, 1
s_add_u32 s18, s18, s19
s_and_b32 s20, s18, 7
s_lshl_b32 s20, s20, 10
s_lshr_b32 s21, s18, 3
s_lshl_b32 s21, s21, 14
s_add_u32 s20, s20, s21
s_add_u32 s20, s20, 0x6000000
v_add_u32 v20, s20, v7
s_and_b32 s20, s18, 63
s_lshl_b32 s20, s20, 7
s_lshl_b32 s21, s26, 14
s_add_u32 s20, s20, s21
s_add_u32 s20, s20, 0x81a0000
s_lshl_b32 s21, s26, 7
s_add_u32 s21, s21, 0x8190000
s_cmp_eq_u32 s12, 0
s_cselect_b32 s20, s21, s20
v_mov_b32 v21, s20
s_lshr_b32 s18, s13, 2
s_lshl_b32 s18, s18, 4
s_add_u32 s18, s18, 0x8180000
v_mov_b32 v22, s18
s_lshl_b32 s47, s19, 10
s_lshl_b32 s19, s19, 4
v_add_u32 v225, s19, v1
v_lshlrev_b32 v226, 2, v2
v_add_u32 v227, 0, v226
v_cmp_le_u32 s[50:51], v227, v225
v_add_u32 v227, 1, v226
v_cmp_le_u32 s[52:53], v227, v225
v_add_u32 v227, 2, v226
v_cmp_le_u32 s[54:55], v227, v225
v_add_u32 v227, 3, v226
v_cmp_le_u32 s[56:57], v227, v225
v_add_u32 v227, 16, v226
v_cmp_le_u32 s[58:59], v227, v225
v_add_u32 v227, 17, v226
v_cmp_le_u32 s[60:61], v227, v225
v_add_u32 v227, 18, v226
v_cmp_le_u32 s[62:63], v227, v225
v_add_u32 v227, 19, v226
v_cmp_le_u32 s[64:65], v227, v225
s_mov_b32 s38, 0x3e0293ee
s_mov_b32 s39, 0xbe0293ee
s_mov_b32 s40, 0xd028965f
v_mov_b32 v28, 0x3f803f80
v_mov_b32 v32, -1
v_mov_b32 v29, 0x3f803f80
v_mov_b32 v33, -1
v_mov_b32 v30, 0x3f803f80
v_mov_b32 v34, -1
v_mov_b32 v31, 0x3f803f80
v_mov_b32 v35, -1
v_mov_b32 v236, 0
v_mov_b32 v237, 0
v_mov_b32 v238, 0
v_mov_b32 v239, 0
v_mov_b32 v240, 0
v_mov_b32 v241, 0
v_mov_b32 v242, 0
v_mov_b32 v243, 0
v_mov_b32 v176, 0
v_mov_b32 v177, 0
v_mov_b32 v178, 0
v_mov_b32 v179, 0
v_mov_b32 v250, 0x3f80
v_mov_b32 v251, 0x3f800000
v_mov_b32 v25, 1
v_mov_b32 v234, s40
v_mov_b32 v52, 0
v_mov_b32 v53, 0
v_mov_b32 v54, 0
v_mov_b32 v55, 0
v_mov_b32 v56, 0
v_mov_b32 v57, 0
v_mov_b32 v58, 0
v_mov_b32 v59, 0
v_mov_b32 v60, 0
v_mov_b32 v61, 0
v_mov_b32 v62, 0
v_mov_b32 v63, 0
v_mov_b32 v64, 0
v_mov_b32 v65, 0
v_mov_b32 v66, 0
v_mov_b32 v67, 0
v_mov_b32 v68, 0
v_mov_b32 v69, 0
v_mov_b32 v70, 0
v_mov_b32 v71, 0
v_mov_b32 v72, 0
v_mov_b32 v73, 0
v_mov_b32 v74, 0
v_mov_b32 v75, 0
v_mov_b32 v76, 0
v_mov_b32 v77, 0
v_mov_b32 v78, 0
v_mov_b32 v79, 0
v_mov_b32 v80, 0
v_mov_b32 v81, 0
v_mov_b32 v82, 0
v_mov_b32 v83, 0
s_mov_b32 s30, 0
s_mov_b32 s31, 0x8000000
s_mov_b32 s32, 0x8060000
s_mov_b32 s33, 0x80c0000
s_mov_b32 s35, 18432
s_mov_b32 s95, 0
s_waitcnt vmcnt(16)
s_barrier
v_mov_b32 v226, 131072
ds_read_b128 v[228:231], v226
ds_read_b128 v[160:163], v226 offset:16
s_waitcnt lgkmcnt(0)
v_min_u32 v228, v228, v230
v_min3_u32 v228, v228, v160, v162
v_min_u32 v229, v229, v231
v_min3_u32 v229, v229, v161, v163
v_sub_u32 v228, v228, v229
    s_nop 0
v_readfirstlane_b32 s18, v228
    s_nop 0
s_max_i32 s18, s18, -250
s_min_i32 s18, s18, 250
s_lshl_b32 s18, s18, 1
s_add_u32 s98, s98, s18
s_lshr_b32 s18, s2, 5
s_lshr_b32 s19, s16, 2
s_xor_b32 s18, s18, s19
s_sub_u32 s19, 1024, s98
s_bitcmp1_b32 s18, 0
s_cselect_b32 s98, s19, s98
s_cmp_eq_u32 s12, 0
s_cbranch_scc0 L_arv_chain
s_cmp_eq_u32 s3, 0
s_cbranch_scc0 L_arv_chain
s_load_dwordx2 s[28:29], s[0:1], 112
s_waitcnt lgkmcnt(0)
s_mov_b32 s8, s28
s_mov_b32 s9, s29
s_mov_b32 s10, 0x100
s_mov_b32 s11, 0x20000
s_lshl_b32 s18, s16, 5
v_mov_b32 v224, s18
s_lshl_b32 s18, s98, 12
s_add_u32 s18, s18, 1
v_mov_b32 v225, s18
s_mov_b64 exec, 1
buffer_atomic_add v225, v224, s[8:11], 0 offen offset:4
s_mov_b64 exec, -1
L_arv_chain:
s_mov_b32 s3, 1
ds_read_b64_tr_b16 a[0:1], v156 offset:0
ds_read_b64_tr_b16 a[8:9], v157 offset:0
ds_read_b64_tr_b16 a[2:3], v156 offset:2048
ds_read_b64_tr_b16 a[10:11], v157 offset:2048
ds_read_b64_tr_b16 a[4:5], v156 offset:4096
ds_read_b64_tr_b16 a[12:13], v157 offset:4096
ds_read_b64_tr_b16 a[6:7], v156 offset:6144
ds_read_b64_tr_b16 a[14:15], v157 offset:6144
ds_read_b64_tr_b16 a[48:49], v156 offset:8192
ds_read_b64_tr_b16 a[56:57], v157 offset:8192
ds_read_b64_tr_b16 a[50:51], v156 offset:10240
ds_read_b64_tr_b16 a[58:59], v157 offset:10240
ds_read_b64_tr_b16 a[52:53], v156 offset:12288
ds_read_b64_tr_b16 a[60:61], v157 offset:12288
ds_read_b64_tr_b16 a[54:55], v156 offset:14336
ds_read_b64_tr_b16 a[62:63], v157 offset:14336
s_waitcnt lgkmcnt(0)
s_mov_b32 s8, s70
s_mov_b32 s9, s71
s_mov_b32 s10, 0x800000
s_mov_b32 s11, 0x20000
buffer_load_dwordx4 v[184:187], v158, s[8:11], 0 offen offset:0
buffer_load_dwordx4 v[184:187], v158, s[8:11], 0 offen offset:1024
buffer_load_dwordx4 v[184:187], v158, s[8:11], s77 offen offset:1536
s_mov_b32 s8, s70
s_mov_b32 s9, s71
s_mov_b32 s10, 0x800000
s_mov_b32 s11, 0x20000
s_add_u32 m0, s76, 0
s_mov_b32 s18, 0x0
buffer_load_dwordx4 v244, s[8:11], s18 offen  lds
s_add_u32 m0, s76, 1024
s_mov_b32 s18, 0x8000
buffer_load_dwordx4 v244, s[8:11], s18 offen  lds
s_add_u32 m0, s76, 2048
s_mov_b32 s18, 0x2000
buffer_load_dwordx4 v244, s[8:11], s18 offen  lds
s_add_u32 m0, s76, 3072
s_mov_b32 s18, 0xa000
buffer_load_dwordx4 v244, s[8:11], s18 offen  lds
s_add_u32 m0, s76, 4096
s_mov_b32 s18, 0x10000
buffer_load_dwordx4 v244, s[8:11], s18 offen  lds
s_add_u32 m0, s76, 5120
s_mov_b32 s18, 0x18000
buffer_load_dwordx4 v244, s[8:11], s18 offen  lds
s_add_u32 m0, s76, 6144
s_mov_b32 s18, 0x12000
buffer_load_dwordx4 v244, s[8:11], s18 offen  lds
s_add_u32 m0, s76, 7168
s_mov_b32 s18, 0x1a000
buffer_load_dwordx4 v244, s[8:11], s18 offen  lds
s_add_u32 m0, s76, 8192
s_mov_b32 s18, 0x80000
buffer_load_dwordx4 v244, s[8:11], s18 offen  lds
s_add_u32 m0, s76, 9216
s_mov_b32 s18, 0x88000
buffer_load_dwordx4 v244, s[8:11], s18 offen  lds
s_add_u32 m0, s76, 10240
s_mov_b32 s18, 0x82000
buffer_load_dwordx4 v244, s[8:11], s18 offen  lds
s_add_u32 m0, s76, 11264
s_mov_b32 s18, 0x8a000
buffer_load_dwordx4 v244, s[8:11], s18 offen  lds
s_add_u32 m0, s76, 12288
s_mov_b32 s18, 0x90000
buffer_load_dwordx4 v244, s[8:11], s18 offen  lds
s_add_u32 m0, s76, 13312
s_mov_b32 s18, 0x98000
buffer_load_dwordx4 v244, s[8:11], s18 offen  lds
s_add_u32 m0, s76, 14336
s_mov_b32 s18, 0x92000
buffer_load_dwordx4 v244, s[8:11], s18 offen  lds
s_add_u32 m0, s76, 15360
s_mov_b32 s18, 0x9a000
buffer_load_dwordx4 v244, s[8:11], s18 offen  lds
s_waitcnt vmcnt(16)
ds_read_b64_tr_b16 a[96:97], v156 offset:16384
ds_read_b64_tr_b16 a[104:105], v157 offset:16384
ds_read_b64_tr_b16 a[98:99], v156 offset:18432
ds_read_b64_tr_b16 a[106:107], v157 offset:18432
ds_read_b64_tr_b16 a[100:101], v156 offset:20480
ds_read_b64_tr_b16 a[108:109], v157 offset:20480
ds_read_b64_tr_b16 a[102:103], v156 offset:22528
ds_read_b64_tr_b16 a[110:111], v157 offset:22528
ds_read_b64_tr_b16 a[144:145], v156 offset:24576
ds_read_b64_tr_b16 a[152:153], v157 offset:24576
ds_read_b64_tr_b16 a[146:147], v156 offset:26624
ds_read_b64_tr_b16 a[154:155], v157 offset:26624
ds_read_b64_tr_b16 a[148:149], v156 offset:28672
ds_read_b64_tr_b16 a[156:157], v157 offset:28672
ds_read_b64_tr_b16 a[150:151], v156 offset:30720
ds_read_b64_tr_b16 a[158:159], v157 offset:30720
s_waitcnt lgkmcnt(0)
s_mov_b32 s8, s72
s_mov_b32 s9, s73
s_mov_b32 s10, 0x800000
s_mov_b32 s11, 0x20000
buffer_load_dwordx4 v[184:187], v158, s[8:11], 0 offen offset:0
buffer_load_dwordx4 v[184:187], v158, s[8:11], 0 offen offset:1024
buffer_load_dwordx4 v[184:187], v158, s[8:11], s77 offen offset:1536
s_mov_b32 s8, s70
s_mov_b32 s9, s71
s_mov_b32 s10, 0x800000
s_mov_b32 s11, 0x20000
s_add_u32 m0, s76, 16384
s_mov_b32 s18, 0x100000
buffer_load_dwordx4 v244, s[8:11], s18 offen  lds
s_add_u32 m0, s76, 17408
s_mov_b32 s18, 0x108000
buffer_load_dwordx4 v244, s[8:11], s18 offen  lds
s_add_u32 m0, s76, 18432
s_mov_b32 s18, 0x102000
buffer_load_dwordx4 v244, s[8:11], s18 offen  lds
s_add_u32 m0, s76, 19456
s_mov_b32 s18, 0x10a000
buffer_load_dwordx4 v244, s[8:11], s18 offen  lds
s_add_u32 m0, s76, 20480
s_mov_b32 s18, 0x110000
buffer_load_dwordx4 v244, s[8:11], s18 offen  lds
s_add_u32 m0, s76, 21504
s_mov_b32 s18, 0x118000
buffer_load_dwordx4 v244, s[8:11], s18 offen  lds
s_add_u32 m0, s76, 22528
s_mov_b32 s18, 0x112000
buffer_load_dwordx4 v244, s[8:11], s18 offen  lds
s_add_u32 m0, s76, 23552
s_mov_b32 s18, 0x11a000
buffer_load_dwordx4 v244, s[8:11], s18 offen  lds
s_add_u32 m0, s76, 24576
s_mov_b32 s18, 0x180000
buffer_load_dwordx4 v244, s[8:11], s18 offen  lds
s_add_u32 m0, s76, 25600
s_mov_b32 s18, 0x188000
buffer_load_dwordx4 v244, s[8:11], s18 offen  lds
s_add_u32 m0, s76, 26624
s_mov_b32 s18, 0x182000
buffer_load_dwordx4 v244, s[8:11], s18 offen  lds
s_add_u32 m0, s76, 27648
s_mov_b32 s18, 0x18a000
buffer_load_dwordx4 v244, s[8:11], s18 offen  lds
s_add_u32 m0, s76, 28672
s_mov_b32 s18, 0x190000
buffer_load_dwordx4 v244, s[8:11], s18 offen  lds
s_add_u32 m0, s76, 29696
s_mov_b32 s18, 0x198000
buffer_load_dwordx4 v244, s[8:11], s18 offen  lds
s_add_u32 m0, s76, 30720
s_mov_b32 s18, 0x192000
buffer_load_dwordx4 v244, s[8:11], s18 offen  lds
s_add_u32 m0, s76, 31744
s_mov_b32 s18, 0x19a000
buffer_load_dwordx4 v244, s[8:11], s18 offen  lds
s_waitcnt vmcnt(16)
ds_read_b64_tr_b16 a[16:17], v156 offset:0
ds_read_b64_tr_b16 a[24:25], v157 offset:0
ds_read_b64_tr_b16 a[18:19], v156 offset:2048
ds_read_b64_tr_b16 a[26:27], v157 offset:2048
ds_read_b64_tr_b16 a[20:21], v156 offset:4096
ds_read_b64_tr_b16 a[28:29], v157 offset:4096
ds_read_b64_tr_b16 a[22:23], v156 offset:6144
ds_read_b64_tr_b16 a[30:31], v157 offset:6144
ds_read_b64_tr_b16 a[64:65], v156 offset:8192
ds_read_b64_tr_b16 a[72:73], v157 offset:8192
ds_read_b64_tr_b16 a[66:67], v156 offset:10240
ds_read_b64_tr_b16 a[74:75], v157 offset:10240
ds_read_b64_tr_b16 a[68:69], v156 offset:12288
ds_read_b64_tr_b16 a[76:77], v157 offset:12288
ds_read_b64_tr_b16 a[70:71], v156 offset:14336
ds_read_b64_tr_b16 a[78:79], v157 offset:14336
s_waitcnt lgkmcnt(0)
s_mov_b32 s8, s72
s_mov_b32 s9, s73
s_mov_b32 s10, 0x800000
s_mov_b32 s11, 0x20000
s_add_u32 m0, s76, 0
s_mov_b32 s18, 0x0
buffer_load_dwordx4 v244, s[8:11], s18 offen  lds
s_add_u32 m0, s76, 1024
s_mov_b32 s18, 0x8000
buffer_load_dwordx4 v244, s[8:11], s18 offen  lds
s_add_u32 m0, s76, 2048
s_mov_b32 s18, 0x2000
buffer_load_dwordx4 v244, s[8:11], s18 offen  lds
s_add_u32 m0, s76, 3072
s_mov_b32 s18, 0xa000
buffer_load_dwordx4 v244, s[8:11], s18 offen  lds
s_add_u32 m0, s76, 4096
s_mov_b32 s18, 0x10000
buffer_load_dwordx4 v244, s[8:11], s18 offen  lds
s_add_u32 m0, s76, 5120
s_mov_b32 s18, 0x18000
buffer_load_dwordx4 v244, s[8:11], s18 offen  lds
s_add_u32 m0, s76, 6144
s_mov_b32 s18, 0x12000
buffer_load_dwordx4 v244, s[8:11], s18 offen  lds
s_add_u32 m0, s76, 7168
s_mov_b32 s18, 0x1a000
buffer_load_dwordx4 v244, s[8:11], s18 offen  lds
s_add_u32 m0, s76, 8192
s_mov_b32 s18, 0x80000
buffer_load_dwordx4 v244, s[8:11], s18 offen  lds
s_add_u32 m0, s76, 9216
s_mov_b32 s18, 0x88000
buffer_load_dwordx4 v244, s[8:11], s18 offen  lds
s_add_u32 m0, s76, 10240
s_mov_b32 s18, 0x82000
buffer_load_dwordx4 v244, s[8:11], s18 offen  lds
s_add_u32 m0, s76, 11264
s_mov_b32 s18, 0x8a000
buffer_load_dwordx4 v244, s[8:11], s18 offen  lds
s_add_u32 m0, s76, 12288
s_mov_b32 s18, 0x90000
buffer_load_dwordx4 v244, s[8:11], s18 offen  lds
s_add_u32 m0, s76, 13312
s_mov_b32 s18, 0x98000
buffer_load_dwordx4 v244, s[8:11], s18 offen  lds
s_add_u32 m0, s76, 14336
s_mov_b32 s18, 0x92000
buffer_load_dwordx4 v244, s[8:11], s18 offen  lds
s_add_u32 m0, s76, 15360
s_mov_b32 s18, 0x9a000
buffer_load_dwordx4 v244, s[8:11], s18 offen  lds
s_waitcnt vmcnt(16)
ds_read_b64_tr_b16 a[112:113], v156 offset:16384
ds_read_b64_tr_b16 a[120:121], v157 offset:16384
ds_read_b64_tr_b16 a[114:115], v156 offset:18432
ds_read_b64_tr_b16 a[122:123], v157 offset:18432
ds_read_b64_tr_b16 a[116:117], v156 offset:20480
ds_read_b64_tr_b16 a[124:125], v157 offset:20480
ds_read_b64_tr_b16 a[118:119], v156 offset:22528
ds_read_b64_tr_b16 a[126:127], v157 offset:22528
ds_read_b64_tr_b16 a[160:161], v156 offset:24576
ds_read_b64_tr_b16 a[168:169], v157 offset:24576
ds_read_b64_tr_b16 a[162:163], v156 offset:26624
ds_read_b64_tr_b16 a[170:171], v157 offset:26624
ds_read_b64_tr_b16 a[164:165], v156 offset:28672
ds_read_b64_tr_b16 a[172:173], v157 offset:28672
ds_read_b64_tr_b16 a[166:167], v156 offset:30720
ds_read_b64_tr_b16 a[174:175], v157 offset:30720
s_waitcnt lgkmcnt(0)
s_mov_b32 s8, s74
s_mov_b32 s9, s75
s_mov_b32 s10, 0x800000
s_mov_b32 s11, 0x20000
buffer_load_dwordx4 v[184:187], v188, s[8:11], 0 offen offset:0
buffer_load_dwordx4 v[184:187], v188, s[8:11], 0 offen offset:1024
buffer_load_dwordx4 v[184:187], v188, s[8:11], s77 offen offset:1536
s_mov_b32 s8, s72
s_mov_b32 s9, s73
s_mov_b32 s10, 0x800000
s_mov_b32 s11, 0x20000
s_add_u32 m0, s76, 16384
s_mov_b32 s18, 0x100000
buffer_load_dwordx4 v244, s[8:11], s18 offen  lds
s_add_u32 m0, s76, 17408
s_mov_b32 s18, 0x108000
buffer_load_dwordx4 v244, s[8:11], s18 offen  lds
s_add_u32 m0, s76, 18432
s_mov_b32 s18, 0x102000
buffer_load_dwordx4 v244, s[8:11], s18 offen  lds
s_add_u32 m0, s76, 19456
s_mov_b32 s18, 0x10a000
buffer_load_dwordx4 v244, s[8:11], s18 offen  lds
s_add_u32 m0, s76, 20480
s_mov_b32 s18, 0x110000
buffer_load_dwordx4 v244, s[8:11], s18 offen  lds
s_add_u32 m0, s76, 21504
s_mov_b32 s18, 0x118000
buffer_load_dwordx4 v244, s[8:11], s18 offen  lds
s_add_u32 m0, s76, 22528
s_mov_b32 s18, 0x112000
buffer_load_dwordx4 v244, s[8:11], s18 offen  lds
s_add_u32 m0, s76, 23552
s_mov_b32 s18, 0x11a000
buffer_load_dwordx4 v244, s[8:11], s18 offen  lds
s_add_u32 m0, s76, 24576
s_mov_b32 s18, 0x180000
buffer_load_dwordx4 v244, s[8:11], s18 offen  lds
s_add_u32 m0, s76, 25600
s_mov_b32 s18, 0x188000
buffer_load_dwordx4 v244, s[8:11], s18 offen  lds
s_add_u32 m0, s76, 26624
s_mov_b32 s18, 0x182000
buffer_load_dwordx4 v244, s[8:11], s18 offen  lds
s_add_u32 m0, s76, 27648
s_mov_b32 s18, 0x18a000
buffer_load_dwordx4 v244, s[8:11], s18 offen  lds
s_add_u32 m0, s76, 28672
s_mov_b32 s18, 0x190000
buffer_load_dwordx4 v244, s[8:11], s18 offen  lds
s_add_u32 m0, s76, 29696
s_mov_b32 s18, 0x198000
buffer_load_dwordx4 v244, s[8:11], s18 offen  lds
s_add_u32 m0, s76, 30720
s_mov_b32 s18, 0x192000
buffer_load_dwordx4 v244, s[8:11], s18 offen  lds
s_add_u32 m0, s76, 31744
s_mov_b32 s18, 0x19a000
buffer_load_dwordx4 v244, s[8:11], s18 offen  lds
s_waitcnt vmcnt(16)
ds_read_b64_tr_b16 a[32:33], v156 offset:0
ds_read_b64_tr_b16 a[40:41], v157 offset:0
ds_read_b64_tr_b16 a[34:35], v156 offset:2048
ds_read_b64_tr_b16 a[42:43], v157 offset:2048
ds_read_b64_tr_b16 a[36:37], v156 offset:4096
ds_read_b64_tr_b16 a[44:45], v157 offset:4096
ds_read_b64_tr_b16 a[38:39], v156 offset:6144
ds_read_b64_tr_b16 a[46:47], v157 offset:6144
ds_read_b64_tr_b16 a[80:81], v156 offset:8192
ds_read_b64_tr_b16 a[88:89], v157 offset:8192
ds_read_b64_tr_b16 a[82:83], v156 offset:10240
ds_read_b64_tr_b16 a[90:91], v157 offset:10240
ds_read_b64_tr_b16 a[84:85], v156 offset:12288
ds_read_b64_tr_b16 a[92:93], v157 offset:12288
ds_read_b64_tr_b16 a[86:87], v156 offset:14336
ds_read_b64_tr_b16 a[94:95], v157 offset:14336
s_waitcnt lgkmcnt(0)
s_mov_b32 s8, s74
s_mov_b32 s9, s75
s_mov_b32 s10, 0x800000
s_mov_b32 s11, 0x20000
s_add_u32 m0, s76, 0
s_mov_b32 s18, 0x0
buffer_load_dwordx4 v245, s[8:11], s18 offen  lds
s_add_u32 m0, s76, 1024
s_mov_b32 s18, 0x2000
buffer_load_dwordx4 v245, s[8:11], s18 offen  lds
s_add_u32 m0, s76, 2048
s_mov_b32 s18, 0x1000
buffer_load_dwordx4 v245, s[8:11], s18 offen  lds
s_add_u32 m0, s76, 3072
s_mov_b32 s18, 0x3000
buffer_load_dwordx4 v245, s[8:11], s18 offen  lds
s_add_u32 m0, s76, 4096
s_mov_b32 s18, 0x4000
buffer_load_dwordx4 v245, s[8:11], s18 offen  lds
s_add_u32 m0, s76, 5120
s_mov_b32 s18, 0x6000
buffer_load_dwordx4 v245, s[8:11], s18 offen  lds
s_add_u32 m0, s76, 6144
s_mov_b32 s18, 0x5000
buffer_load_dwordx4 v245, s[8:11], s18 offen  lds
s_add_u32 m0, s76, 7168
s_mov_b32 s18, 0x7000
buffer_load_dwordx4 v245, s[8:11], s18 offen  lds
s_add_u32 m0, s76, 8192
s_mov_b32 s18, 0x20000
buffer_load_dwordx4 v245, s[8:11], s18 offen  lds
s_add_u32 m0, s76, 9216
s_mov_b32 s18, 0x22000
buffer_load_dwordx4 v245, s[8:11], s18 offen  lds
s_add_u32 m0, s76, 10240
s_mov_b32 s18, 0x21000
buffer_load_dwordx4 v245, s[8:11], s18 offen  lds
s_add_u32 m0, s76, 11264
s_mov_b32 s18, 0x23000
buffer_load_dwordx4 v245, s[8:11], s18 offen  lds
s_add_u32 m0, s76, 12288
s_mov_b32 s18, 0x24000
buffer_load_dwordx4 v245, s[8:11], s18 offen  lds
s_add_u32 m0, s76, 13312
s_mov_b32 s18, 0x26000
buffer_load_dwordx4 v245, s[8:11], s18 offen  lds
s_add_u32 m0, s76, 14336
s_mov_b32 s18, 0x25000
buffer_load_dwordx4 v245, s[8:11], s18 offen  lds
s_add_u32 m0, s76, 15360
s_mov_b32 s18, 0x27000
buffer_load_dwordx4 v245, s[8:11], s18 offen  lds
s_waitcnt vmcnt(16)
ds_read_b64_tr_b16 a[128:129], v156 offset:16384
ds_read_b64_tr_b16 a[136:137], v157 offset:16384
ds_read_b64_tr_b16 a[130:131], v156 offset:18432
ds_read_b64_tr_b16 a[138:139], v157 offset:18432
ds_read_b64_tr_b16 a[132:133], v156 offset:20480
ds_read_b64_tr_b16 a[140:141], v157 offset:20480
ds_read_b64_tr_b16 a[134:135], v156 offset:22528
ds_read_b64_tr_b16 a[142:143], v157 offset:22528
ds_read_b64_tr_b16 a[176:177], v156 offset:24576
ds_read_b64_tr_b16 a[184:185], v157 offset:24576
ds_read_b64_tr_b16 a[178:179], v156 offset:26624
ds_read_b64_tr_b16 a[186:187], v157 offset:26624
ds_read_b64_tr_b16 a[180:181], v156 offset:28672
ds_read_b64_tr_b16 a[188:189], v157 offset:28672
ds_read_b64_tr_b16 a[182:183], v156 offset:30720
ds_read_b64_tr_b16 a[190:191], v157 offset:30720
s_waitcnt lgkmcnt(0)
s_load_dwordx2 s[78:79], s[0:1], 0
s_load_dwordx2 s[80:81], s[0:1], 96
s_load_dwordx2 s[82:83], s[0:1], 64
s_lshl_b32 s18, s13, 15
s_lshl_b32 s19, s12, 9
s_add_u32 s18, s18, s19
v_lshlrev_b32 v225, 4, v2
v_lshl_add_u32 v226, v1, 11, v225
s_waitcnt lgkmcnt(0)
s_mov_b32 s8, s78
s_mov_b32 s9, s79
s_mov_b32 s10, 0x400000
s_mov_b32 s11, 0x20000
buffer_load_dwordx4 v[116:119], v226, s[8:11], s18 offen offset:0
buffer_load_dwordx4 v[120:123], v226, s[8:11], s18 offen offset:64
buffer_load_dwordx4 v[124:127], v226, s[8:11], s18 offen offset:128
buffer_load_dwordx4 v[128:131], v226, s[8:11], s18 offen offset:192
buffer_load_dwordx4 v[132:135], v226, s[8:11], s18 offen offset:256
buffer_load_dwordx4 v[136:139], v226, s[8:11], s18 offen offset:320
buffer_load_dwordx4 v[140:143], v226, s[8:11], s18 offen offset:384
buffer_load_dwordx4 v[144:147], v226, s[8:11], s18 offen offset:448
s_mov_b32 s8, s80
s_mov_b32 s9, s81
s_mov_b32 s10, 0x800
s_mov_b32 s11, 0x20000
buffer_load_dwordx4 v[84:87], v225, s[8:11], s19 offen offset:0
buffer_load_dwordx4 v[88:91], v225, s[8:11], s19 offen offset:64
buffer_load_dwordx4 v[92:95], v225, s[8:11], s19 offen offset:128
buffer_load_dwordx4 v[96:99], v225, s[8:11], s19 offen offset:192
buffer_load_dwordx4 v[100:103], v225, s[8:11], s19 offen offset:256
buffer_load_dwordx4 v[104:107], v225, s[8:11], s19 offen offset:320
buffer_load_dwordx4 v[108:111], v225, s[8:11], s19 offen offset:384
buffer_load_dwordx4 v[112:115], v225, s[8:11], s19 offen offset:448
s_mov_b32 s8, s82
s_mov_b32 s9, s83
s_mov_b32 s10, 0x800
s_mov_b32 s11, 0x20000
buffer_load_dwordx4 v[192:195], v225, s[8:11], s19 offen offset:0
buffer_load_dwordx4 v[196:199], v225, s[8:11], s19 offen offset:64
buffer_load_dwordx4 v[200:203], v225, s[8:11], s19 offen offset:128
buffer_load_dwordx4 v[204:207], v225, s[8:11], s19 offen offset:192
buffer_load_dwordx4 v[208:211], v225, s[8:11], s19 offen offset:256
buffer_load_dwordx4 v[212:215], v225, s[8:11], s19 offen offset:320
buffer_load_dwordx4 v[216:219], v225, s[8:11], s19 offen offset:384
buffer_load_dwordx4 v[220:223], v225, s[8:11], s19 offen offset:448
s_mov_b32 s8, s74
s_mov_b32 s9, s75
s_mov_b32 s10, 0x800000
s_mov_b32 s11, 0x20000
s_add_u32 m0, s76, 16384
s_mov_b32 s18, 0x40000
buffer_load_dwordx4 v245, s[8:11], s18 offen  lds
s_add_u32 m0, s76, 17408
s_mov_b32 s18, 0x42000
buffer_load_dwordx4 v245, s[8:11], s18 offen  lds
s_add_u32 m0, s76, 18432
s_mov_b32 s18, 0x41000
buffer_load_dwordx4 v245, s[8:11], s18 offen  lds
s_add_u32 m0, s76, 19456
s_mov_b32 s18, 0x43000
buffer_load_dwordx4 v245, s[8:11], s18 offen  lds
s_add_u32 m0, s76, 20480
s_mov_b32 s18, 0x44000
buffer_load_dwordx4 v245, s[8:11], s18 offen  lds
s_add_u32 m0, s76, 21504
s_mov_b32 s18, 0x46000
buffer_load_dwordx4 v245, s[8:11], s18 offen  lds
s_add_u32 m0, s76, 22528
s_mov_b32 s18, 0x45000
buffer_load_dwordx4 v245, s[8:11], s18 offen  lds
s_add_u32 m0, s76, 23552
s_mov_b32 s18, 0x47000
buffer_load_dwordx4 v245, s[8:11], s18 offen  lds
s_add_u32 m0, s76, 24576
s_mov_b32 s18, 0x60000
buffer_load_dwordx4 v245, s[8:11], s18 offen  lds
s_add_u32 m0, s76, 25600
s_mov_b32 s18, 0x62000
buffer_load_dwordx4 v245, s[8:11], s18 offen  lds
s_add_u32 m0, s76, 26624
s_mov_b32 s18, 0x61000
buffer_load_dwordx4 v245, s[8:11], s18 offen  lds
s_add_u32 m0, s76, 27648
s_mov_b32 s18, 0x63000
buffer_load_dwordx4 v245, s[8:11], s18 offen  lds
s_add_u32 m0, s76, 28672
s_mov_b32 s18, 0x64000
buffer_load_dwordx4 v245, s[8:11], s18 offen  lds
s_add_u32 m0, s76, 29696
s_mov_b32 s18, 0x66000
buffer_load_dwordx4 v245, s[8:11], s18 offen  lds
s_add_u32 m0, s76, 30720
s_mov_b32 s18, 0x65000
buffer_load_dwordx4 v245, s[8:11], s18 offen  lds
s_add_u32 m0, s76, 31744
s_mov_b32 s18, 0x67000
buffer_load_dwordx4 v245, s[8:11], s18 offen  lds
s_waitcnt vmcnt(40)
ds_read_b64_tr_b16 a[192:193], v156 offset:0
ds_read_b64_tr_b16 a[200:201], v157 offset:0
ds_read_b64_tr_b16 a[194:195], v156 offset:2048
ds_read_b64_tr_b16 a[202:203], v157 offset:2048
ds_read_b64_tr_b16 a[196:197], v156 offset:4096
ds_read_b64_tr_b16 a[204:205], v157 offset:4096
ds_read_b64_tr_b16 a[198:199], v156 offset:6144
ds_read_b64_tr_b16 a[206:207], v157 offset:6144
ds_read_b64_tr_b16 a[208:209], v156 offset:8192
ds_read_b64_tr_b16 a[216:217], v157 offset:8192
ds_read_b64_tr_b16 a[210:211], v156 offset:10240
ds_read_b64_tr_b16 a[218:219], v157 offset:10240
ds_read_b64_tr_b16 a[212:213], v156 offset:12288
ds_read_b64_tr_b16 a[220:221], v157 offset:12288
ds_read_b64_tr_b16 a[214:215], v156 offset:14336
ds_read_b64_tr_b16 a[222:223], v157 offset:14336
s_waitcnt lgkmcnt(0)
s_waitcnt vmcnt(16)
s_load_dwordx2 s[28:29], s[0:1], 112
s_waitcnt lgkmcnt(0)
s_mov_b32 s8, s28
s_mov_b32 s9, s29
s_mov_b32 s10, 0x100
s_mov_b32 s11, 0x20000
v_lshlrev_b32 v244, 2, v0
buffer_load_dword v245, v244, s[8:11], 0 offen sc1
v_mfma_f32_16x16x32_bf16 v[160:163], v[84:87], v[116:119], 0
v_mfma_f32_16x16x32_bf16 v[164:167], v[192:195], v[116:119], 0
v_mfma_f32_16x16x32_bf16 v[160:163], v[88:91], v[120:123], v[160:163]
v_mfma_f32_16x16x32_bf16 v[164:167], v[196:199], v[120:123], v[164:167]
v_mfma_f32_16x16x32_bf16 v[160:163], v[92:95], v[124:127], v[160:163]
v_mfma_f32_16x16x32_bf16 v[164:167], v[200:203], v[124:127], v[164:167]
v_mfma_f32_16x16x32_bf16 v[160:163], v[96:99], v[128:131], v[160:163]
v_mfma_f32_16x16x32_bf16 v[164:167], v[204:207], v[128:131], v[164:167]
v_mfma_f32_16x16x32_bf16 v[160:163], v[100:103], v[132:135], v[160:163]
v_mfma_f32_16x16x32_bf16 v[164:167], v[208:211], v[132:135], v[164:167]
v_mfma_f32_16x16x32_bf16 v[160:163], v[104:107], v[136:139], v[160:163]
v_mfma_f32_16x16x32_bf16 v[164:167], v[212:215], v[136:139], v[164:167]
v_mfma_f32_16x16x32_bf16 v[160:163], v[108:111], v[140:143], v[160:163]
v_mfma_f32_16x16x32_bf16 v[164:167], v[216:219], v[140:143], v[164:167]
v_mfma_f32_16x16x32_bf16 v[160:163], v[112:115], v[144:147], v[160:163]
v_mfma_f32_16x16x32_bf16 v[164:167], v[220:223], v[144:147], v[164:167]
s_waitcnt vmcnt(0)
ds_read_b64_tr_b16 a[224:225], v156 offset:16384
ds_read_b64_tr_b16 a[232:233], v157 offset:16384
ds_read_b64_tr_b16 a[226:227], v156 offset:18432
ds_read_b64_tr_b16 a[234:235], v157 offset:18432
ds_read_b64_tr_b16 a[228:229], v156 offset:20480
ds_read_b64_tr_b16 a[236:237], v157 offset:20480
ds_read_b64_tr_b16 a[230:231], v156 offset:22528
ds_read_b64_tr_b16 a[238:239], v157 offset:22528
ds_read_b64_tr_b16 a[240:241], v156 offset:24576
ds_read_b64_tr_b16 a[248:249], v157 offset:24576
ds_read_b64_tr_b16 a[242:243], v156 offset:26624
ds_read_b64_tr_b16 a[250:251], v157 offset:26624
ds_read_b64_tr_b16 a[244:245], v156 offset:28672
ds_read_b64_tr_b16 a[252:253], v157 offset:28672
ds_read_b64_tr_b16 a[246:247], v156 offset:30720
ds_read_b64_tr_b16 a[254:255], v157 offset:30720
s_waitcnt lgkmcnt(0)
s_barrier
v_mov_b32 v161, v164
ds_write_b64 v6, v[160:161]
s_waitcnt lgkmcnt(0)
s_barrier
ds_read_b64 v[160:161], v7 offset:0
ds_read_b64 v[162:163], v7 offset:1024
ds_read_b64 v[164:165], v7 offset:2048
ds_read_b64 v[166:167], v7 offset:3072
s_waitcnt lgkmcnt(0)
s_barrier
v_add_f32 v160, v160, v162
v_add_f32 v164, v164, v166
v_add_f32 v160, v160, v164
v_add_f32 v161, v161, v163
v_add_f32 v165, v165, v167
v_add_f32 v161, v161, v165
v_cvt_pk_bf16_f32 v160, v160, v161
v_and_b32 v161, 0xffff0000, v160
v_lshlrev_b32 v160, 16, v160
v_mul_f32 v160, 0xbfb8aa3b, v160
v_exp_f32 v160, v160
    s_nop 0
v_add_f32 v160, 1.0, v160
v_rcp_f32 v160, v160
    s_nop 0
v_cvt_pk_bf16_f32 v160, v160, v160
v_lshlrev_b32 v160, 16, v160
v_ashrrev_i32 v162, 31, v161
v_or_b32 v162, 0x80000000, v162
v_xor_b32 v161, v161, v162
v_and_b32 v161, 0xffff0000, v161
s_lshl_b32 s18, s13, 4
s_sub_u32 s18, 2047, s18
v_sub_u32 v162, s18, v1
v_or_b32 v161, v161, v162
s_branch L_arr_chain_c
L_arr_chain:
s_load_dwordx2 s[28:29], s[0:1], 112
s_waitcnt lgkmcnt(0)
s_mov_b32 s8, s28
s_mov_b32 s9, s29
s_mov_b32 s10, 0x100
s_mov_b32 s11, 0x20000
v_lshlrev_b32 v244, 2, v0
buffer_load_dword v245, v244, s[8:11], 0 offen sc1
s_waitcnt vmcnt(0)
L_arr_chain_c:
v_readlane_b32 s18, v245, 1
v_readlane_b32 s19, v245, 9
v_readlane_b32 s20, v245, 17
v_readlane_b32 s21, v245, 25
v_readlane_b32 s22, v245, 33
v_readlane_b32 s23, v245, 41
v_readlane_b32 s24, v245, 49
v_readlane_b32 s25, v245, 57
s_add_u32 s18, s18, s19
s_add_u32 s18, s18, s20
s_add_u32 s18, s18, s21
s_add_u32 s18, s18, s22
s_add_u32 s18, s18, s23
s_add_u32 s18, s18, s24
s_add_u32 s18, s18, s25
s_and_b32 s19, s18, 0xfff
s_cmp_eq_u32 s19, 256
s_cbranch_scc1 L_arr_chain_ok
s_sub_u32 s15, s15, 1
s_cbranch_scc1 L_exit
s_sleep 4
s_branch L_arr_chain
L_arr_chain_ok:
s_lshr_b32 s18, s18, 12
s_cmp_gt_u32 s18, 131072
s_cselect_b32 s99, 0x2000, 0
v_readlane_b32 s18, v245, 0
v_readlane_b32 s19, v245, 8
v_readlane_b32 s20, v245, 16
v_readlane_b32 s21, v245, 24
v_readlane_b32 s22, v245, 32
v_readlane_b32 s23, v245, 40
v_readlane_b32 s24, v245, 48
v_readlane_b32 s25, v245, 56
s_mov_b32 s14, 1
s_cmp_eq_u32 s18, 32
s_cselect_b32 s14, s14, 0
s_cmp_eq_u32 s19, 32
s_cselect_b32 s14, s14, 0
s_cmp_eq_u32 s20, 32
s_cselect_b32 s14, s14, 0
s_cmp_eq_u32 s21, 32
s_cselect_b32 s14, s14, 0
s_cmp_eq_u32 s22, 32
s_cselect_b32 s14, s14, 0
s_cmp_eq_u32 s23, 32
s_cselect_b32 s14, s14, 0
s_cmp_eq_u32 s24, 32
s_cselect_b32 s14, s14, 0
s_cmp_eq_u32 s25, 32
s_cselect_b32 s14, s14, 0
v_add_u32 v255, s99, v255
v_add_u32 v13, s99, v13
v_add_u32 v252, s99, v252
v_add_u32 v253, s99, v253
v_add_u32 v254, s99, v254
v_add_u32 v22, s99, v22
v_add_u32 v21, s99, v21
s_mov_b32 s34, s99
s_xor_b32 s43, s99, 0
s_mul_i32 s18, s12, 0x60000
s_add_u32 s18, s18, 0x8000000
s_lshr_b32 s19, s13, 5
s_lshl_b32 s19, s19, 14
s_and_b32 s20, s13, 31
s_lshl_b32 s20, s20, 9
s_add_u32 s19, s19, s20
v_and_b32 v225, 31, v0
v_lshlrev_b32 v225, 4, v225
v_lshrrev_b32 v226, 5, v0
v_lshl_add_u32 v225, v226, 16, v225
v_add_u32 v225, s19, v225
s_lshl_b32 s19, s13, 10
s_add_u32 s19, s19, 0x20000
v_add_u32 v226, s19, v7
buffer_load_dwordx4 v[184:187], v225, s[4:7], s18 offen sc1
buffer_load_dwordx4 v[184:187], v226, s[4:7], s18 offen sc1
s_cmp_eq_u32 s12, 1
s_cbranch_scc0 L_ci_stage
s_load_dwordx2 s[28:29], s[0:1], 8
s_waitcnt lgkmcnt(0)
s_mov_b32 s8, s28
s_mov_b32 s9, s29
s_mov_b32 s10, 0x4000
s_mov_b32 s11, 0x20000
s_and_b32 s18, s13, 31
s_lshl_b32 s18, s18, 6
v_and_b32 v225, 7, v1
v_lshlrev_b32 v225, 11, v225
v_lshl_add_u32 v225, v2, 3, v225
buffer_load_dwordx2 v[196:197], v225, s[8:11], s18 offen
buffer_load_dwordx2 v[198:199], v225, s[8:11], s18 offen offset:32
s_waitcnt vmcnt(0)
v_perm_b32 v192, v198, v196, s41
v_perm_b32 v193, v198, v196, s42
v_perm_b32 v194, v199, v197, s41
v_perm_b32 v195, v199, v197, s42
v_min_u32 v192, -2, v192
v_min_u32 v193, -2, v193
v_min_u32 v194, -2, v194
v_min_u32 v195, -2, v195
s_cmp_eq_u32 s14, 0
s_cbranch_scc1 L_pub_1_s
buffer_store_dwordx4 v[192:195], v24, s[4:7], s31 offen
L_pub_1_d:
s_branch L_ci_go
L_ci_stage:
s_mov_b32 s19, 0
L_kv_init:
buffer_load_dwordx4 v[192:195], v22, s[4:7], s19 offen sc1
s_waitcnt vmcnt(0)
v_max3_u32 v224, v192, v193, v194
v_cmp_eq_u32 vcc, -1, v224
s_cbranch_vccz L_kv_init_ok
s_sub_u32 s15, s15, 1
s_cbranch_scc1 L_exit
s_sleep 2
s_branch L_kv_init
L_kv_init_ok:
s_mov_b32 m0, s36
    s_nop 0
buffer_load_dwordx4 v15, s[4:7], s34 offen offset:0 sc1 lds
buffer_load_dwordx4 v15, s[4:7], s34 offen offset:1024 sc1 lds
buffer_load_dwordx4 v15, s[4:7], s34 offen offset:2048 sc1 lds
buffer_load_dwordx4 v15, s[4:7], s34 offen offset:3072 sc1 lds
s_mov_b32 m0, s37
    s_nop 0
buffer_load_dwordx4 v16, s[4:7], s34 offen offset:0 sc1 lds
buffer_load_dwordx4 v16, s[4:7], s34 offen offset:1024 sc1 lds
s_cmp_eq_u32 s12, 0
s_cbranch_scc0 L_ci_nogate
s_lshl_b32 s18, s13, 6
s_add_u32 s19, s18, 0x8186000
s_add_u32 s18, s18, 0x8184000
v_lshlrev_b32 v225, 2, v1
s_mov_b64 exec, 0xffff
buffer_store_dword v160, v225, s[4:7], s19 offen sc1
s_waitcnt vmcnt(0)
buffer_store_dword v161, v225, s[4:7], s18 offen sc1
s_mov_b64 exec, -1
s_branch L_ci_gated
L_ci_nogate:
s_waitcnt vmcnt(0)
L_ci_gated:
L_ci_go:
s_add_u32 s34, s34, 0x80000
s_add_u32 s36, s36, 18432
s_add_u32 s37, s37, 18432
s_cmp_eq_u32 s12, 0
s_cbranch_scc1 L_w0
s_cmp_eq_u32 s12, 1
s_cbranch_scc1 L_w1
s_branch L_w23
L_pub_1_s:
buffer_store_dwordx4 v[192:195], v24, s[4:7], s31 offen  sc1
s_branch L_pub_1_d
.p2align 6
L_w0:
s_barrier
buffer_load_dwordx4 v[36:39], v4, s[4:7], s31 offen offset:0 sc1
s_nop 10
buffer_load_dwordx4 v[40:43], v4, s[4:7], s31 offen offset:1024 sc1
s_nop 10
buffer_load_dwordx4 v[44:47], v4, s[4:7], s31 offen offset:2048 sc1
s_nop 10
buffer_load_dwordx4 v[48:51], v4, s[4:7], s31 offen offset:3072 sc1
ds_read_b128 v[116:119], v18 offset:0
ds_read_b128 v[120:123], v18 offset:1024
ds_read_b128 v[124:127], v18 offset:2048
ds_read_b128 v[128:131], v18 offset:3072
ds_read_b128 v[132:135], v18 offset:4096
ds_read_b128 v[136:139], v18 offset:5120
ds_read_b128 v[140:143], v18 offset:6144
ds_read_b128 v[144:147], v18 offset:7168
ds_read_b128 v[148:151], v18 offset:16384
ds_read_b128 v[152:155], v18 offset:17408
s_waitcnt vmcnt(3)
v_cmp_eq_u32 vcc, -1, v39
s_cbranch_vccnz L_A_F0123
v_smfmac_f32_16x16x64_bf16 v[52:55], v[36:39], a[0:7], v3
v_smfmac_f32_16x16x64_bf16 v[56:59], v[36:39], a[8:15], v3
v_smfmac_f32_16x16x64_bf16 v[60:63], v[36:39], a[16:23], v3
s_waitcnt vmcnt(2)
v_cmp_eq_u32 vcc, -1, v43
v_smfmac_f32_16x16x64_bf16 v[64:67], v[36:39], a[24:31], v3
s_cbranch_vccnz L_A_F123
v_smfmac_f32_16x16x64_bf16 v[52:55], v[40:43], a[48:55], v3
v_smfmac_f32_16x16x64_bf16 v[56:59], v[40:43], a[56:63], v3
v_smfmac_f32_16x16x64_bf16 v[60:63], v[40:43], a[64:71], v3
s_waitcnt vmcnt(1)
v_cmp_eq_u32 vcc, -1, v47
v_smfmac_f32_16x16x64_bf16 v[64:67], v[40:43], a[72:79], v3
s_cbranch_vccnz L_A_F23
v_smfmac_f32_16x16x64_bf16 v[52:55], v[44:47], a[96:103], v3
v_smfmac_f32_16x16x64_bf16 v[56:59], v[44:47], a[104:111], v3
v_smfmac_f32_16x16x64_bf16 v[60:63], v[44:47], a[112:119], v3
s_waitcnt vmcnt(0)
v_cmp_eq_u32 vcc, -1, v51
v_smfmac_f32_16x16x64_bf16 v[64:67], v[44:47], a[120:127], v3
s_cbranch_vccnz L_A_F3
v_smfmac_f32_16x16x64_bf16 v[52:55], v[48:51], a[144:151], v3
v_smfmac_f32_16x16x64_bf16 v[56:59], v[48:51], a[152:159], v3
v_smfmac_f32_16x16x64_bf16 v[60:63], v[48:51], a[160:167], v3
v_smfmac_f32_16x16x64_bf16 v[64:67], v[48:51], a[168:175], v3
L_w0A_done:
v_add_f32 v156, v52, v53
v_add_f32 v158, v54, v55
v_add_f32 v157, v56, v57
v_add_f32 v159, v58, v59
ds_write_b128 v6, v[156:159] offset:0
v_add_f32 v244, v60, v61
v_add_f32 v246, v62, v63
    s_nop 0
v_add_f32 v245, v64, v65
v_add_f32 v247, v66, v67
ds_write_b128 v6, v[244:247] offset:4096
v_cmp_u_f32 vcc, v156, v158
s_cbranch_vccnz L_A_redo
L_w0A_ok:
v_smfmac_f32_16x16x64_bf16 v[68:71], v[36:39], a[32:39], v3
v_smfmac_f32_16x16x64_bf16 v[72:75], v[36:39], a[40:47], v3
s_waitcnt lgkmcnt(0)
s_barrier
ds_read_b64 v[192:193], v7 offset:5128
ds_read_b64 v[194:195], v7 offset:6152
ds_read_b64 v[196:197], v7 offset:7176
s_cmp_eq_u32 s14, 0
s_waitcnt lgkmcnt(2)
v_pk_add_f32 v[192:193], v[192:193], v[246:247]
s_waitcnt lgkmcnt(1)
v_pk_add_f32 v[192:193], v[192:193], v[194:195]
s_waitcnt lgkmcnt(0)
v_pk_add_f32 v[192:193], v[192:193], v[196:197]
v_cvt_pk_bf16_f32 v192, v192, v193
s_cbranch_scc1 L_pub_2_s
buffer_store_dword v192, v8, s[4:7], s31 offen offset:16
L_pub_2_d:
v_smfmac_f32_16x16x64_bf16 v[68:71], v[40:43], a[80:87], v3
v_smfmac_f32_16x16x64_bf16 v[72:75], v[40:43], a[88:95], v3
v_smfmac_f32_16x16x64_bf16 v[68:71], v[44:47], a[128:135], v3
v_smfmac_f32_16x16x64_bf16 v[72:75], v[44:47], a[136:143], v3
v_smfmac_f32_16x16x64_bf16 v[68:71], v[48:51], a[176:183], v3
v_smfmac_f32_16x16x64_bf16 v[72:75], v[48:51], a[184:191], v3
    s_nop 3
v_add_f32 v156, v68, v69
v_add_f32 v158, v70, v71
    s_nop 1
v_add_f32 v157, v72, v73
v_add_f32 v159, v74, v75
ds_write_b128 v6, v[156:159] offset:8192
s_nop 15
buffer_load_dwordx4 v[84:87], v9, s[4:7], s31 offen offset:0 sc1
buffer_load_dwordx4 v[100:103], v10, s[4:7], s31 offen offset:2048 sc1
buffer_load_dwordx4 v[88:91], v9, s[4:7], s31 offen offset:512 sc1
buffer_load_dwordx4 v[104:107], v10, s[4:7], s31 offen offset:2560 sc1
buffer_load_dwordx4 v[92:95], v9, s[4:7], s31 offen offset:1024 sc1
buffer_load_dwordx4 v[108:111], v10, s[4:7], s31 offen offset:3072 sc1
buffer_load_dwordx4 v[96:99], v9, s[4:7], s31 offen offset:1536 sc1
buffer_load_dwordx4 v[112:115], v10, s[4:7], s31 offen offset:3584 sc1
v_mov_b32 v160, 0
v_mov_b32 v161, 0
v_mov_b32 v162, 0
v_mov_b32 v163, 0
v_mov_b32 v164, 0
v_mov_b32 v165, 0
v_mov_b32 v166, 0
v_mov_b32 v167, 0
v_mov_b32 v168, 0
v_mov_b32 v169, 0
v_mov_b32 v170, 0
v_mov_b32 v171, 0
s_waitcnt lgkmcnt(0)
s_barrier
s_waitcnt vmcnt(6)
v_max_u32 v224, v87, v103
v_cmp_eq_u32 vcc, -1, v224
s_cbranch_vccnz L_S_F0123
v_mfma_f32_16x16x32_bf16 v[160:163], v[116:119], v[84:87], v[160:163]
v_mfma_f32_16x16x32_bf16 v[164:167], v[120:123], v[84:87], v[164:167]
s_waitcnt vmcnt(4)
v_max_u32 v224, v91, v107
v_cmp_eq_u32 vcc, -1, v224
v_mfma_f32_16x16x32_bf16 v[168:171], v[100:103], v[84:87], v[168:171]
s_cbranch_vccnz L_S_F123
v_mfma_f32_16x16x32_bf16 v[160:163], v[124:127], v[88:91], v[160:163]
v_mfma_f32_16x16x32_bf16 v[164:167], v[128:131], v[88:91], v[164:167]
s_waitcnt vmcnt(2)
v_max_u32 v224, v95, v111
v_cmp_eq_u32 vcc, -1, v224
v_mfma_f32_16x16x32_bf16 v[168:171], v[104:107], v[88:91], v[168:171]
s_cbranch_vccnz L_S_F23
v_mfma_f32_16x16x32_bf16 v[160:163], v[132:135], v[92:95], v[160:163]
v_mfma_f32_16x16x32_bf16 v[164:167], v[136:139], v[92:95], v[164:167]
s_waitcnt vmcnt(0)
v_max_u32 v224, v99, v115
v_cmp_eq_u32 vcc, -1, v224
v_mfma_f32_16x16x32_bf16 v[168:171], v[108:111], v[92:95], v[168:171]
s_cbranch_vccnz L_S_F3
v_mfma_f32_16x16x32_bf16 v[160:163], v[140:143], v[96:99], v[160:163]
v_mfma_f32_16x16x32_bf16 v[164:167], v[144:147], v[96:99], v[164:167]
v_mfma_f32_16x16x32_bf16 v[168:171], v[112:115], v[96:99], v[168:171]
L_w0_Sdone:
    s_nop 3
v_cndmask_b32 v160, v160, v164, s[44:45]
v_cndmask_b32 v161, v161, v165, s[44:45]
v_cndmask_b32 v162, v162, v166, s[44:45]
v_cndmask_b32 v163, v163, v167, s[44:45]
v_max3_f32 v26, v160, v161, v162
s_cmp_eq_u32 s30, 63
v_cmp_u_f32 vcc, v168, v169
v_cndmask_b32 v232, v168, v169, s[44:45]
s_cbranch_vccnz L_w0_Sretry
L_w0_Sok:
s_cbranch_scc1 L_w0_last
v_max3_f32 v26, v26, v163, v232
    s_nop 1
v_max_f32_dpp v26, v26, v26 row_ror:8 row_mask:0xf bank_mask:0xf
v_mov_b32 v224, v26
    s_nop 1
v_permlane16_swap_b32 v26, v224
v_max_f32 v26, v26, v224
v_mov_b32 v224, v26
s_barrier
ds_read_b32 v236, v27 offset:20480
v_permlane32_swap_b32 v26, v224
v_max_f32 v26, v26, v224
ds_read_b32 v240, v27 offset:20484
v_mul_f32 v26, s39, v26
v_fma_f32 v232, v232, s38, v26
v_fma_f32 v160, v160, s38, v26
v_exp_f32 v232, v232
v_fma_f32 v161, v161, s38, v26
v_exp_f32 v160, v160
v_mov_b32_dpp v224, v232 row_ror:8 row_mask:0xf bank_mask:0xf
v_fma_f32 v162, v162, s38, v26
v_exp_f32 v161, v161
v_cvt_pk_bf16_f32 v176, v232, v224
v_add_f32 v226, v232, v160
v_fma_f32 v163, v163, s38, v26
v_exp_f32 v162, v162
v_cvt_pk_bf16_f32 v172, v160, v161
v_add_f32 v226, v226, v161
v_exp_f32 v163, v163
v_add_f32 v226, v226, v162
v_cvt_pk_bf16_f32 v173, v162, v163
v_mov_b32_dpp v174, v172 row_ror:8 row_mask:0xf bank_mask:0xf
    s_nop 0
v_mov_b32_dpp v175, v173 row_ror:8 row_mask:0xf bank_mask:0xf
v_add_f32 v227, v226, v163
v_add_f32 v226, v226, v163
s_cmp_eq_u32 s14, 0
v_mfma_f32_16x16x32_bf16 v[184:187], v[148:151], v[172:175], 0
v_add_f32_dpp v226, v226, v226 row_ror:8 row_mask:0xf bank_mask:0xf
v_add_f32_dpp v227, v227, v227 row_ror:8 row_mask:0xf bank_mask:0xf
v_mfma_f32_16x16x32_bf16 v[188:191], v[152:155], v[172:175], 0
s_waitcnt lgkmcnt(0)
v_permlane16_swap_b32 v226, v227
v_add_f32 v224, v226, v227
v_add_f32 v225, v226, v227
v_mfma_f32_16x16x32_bf16 v[184:187], v[236:239], v[176:179], v[184:187]
v_mfma_f32_16x16x32_bf16 v[188:191], v[240:243], v[176:179], v[188:191]
v_permlane32_swap_b32 v224, v225
v_add_f32 v224, v224, v225
v_rcp_f32 v224, v224
    s_nop 0
v_pk_mul_f32 v[184:185], v[184:185], v[224:225] op_sel_hi:[1,0]
v_pk_mul_f32 v[186:187], v[186:187], v[224:225] op_sel_hi:[1,0]
v_cvt_pk_bf16_f32 v192, v184, v185
v_cvt_pk_bf16_f32 v193, v186, v187
v_pk_mul_f32 v[188:189], v[188:189], v[224:225] op_sel_hi:[1,0]
v_pk_mul_f32 v[190:191], v[190:191], v[224:225] op_sel_hi:[1,0]
v_cvt_pk_bf16_f32 v194, v188, v189
v_cvt_pk_bf16_f32 v195, v190, v191
s_cbranch_scc1 L_pub_3_s
buffer_store_dwordx4 v[192:195], v14, s[4:7], s31 offen
L_pub_3_d:
s_barrier
s_nop 15
s_nop 4
buffer_load_dwordx4 v[36:39], v5, s[4:7], s31 offen offset:0 sc1
s_nop 10
buffer_load_dwordx4 v[40:43], v5, s[4:7], s31 offen offset:1024 sc1
s_nop 10
buffer_load_dwordx4 v[44:47], v5, s[4:7], s31 offen offset:2048 sc1
s_nop 10
buffer_load_dwordx4 v[48:51], v5, s[4:7], s31 offen offset:3072 sc1
ds_write_b128 v7, v[100:103] offset:16384
ds_write_b128 v7, v[104:107] offset:17408
ds_write_b128 v7, v[108:111] offset:18432
ds_write_b128 v7, v[112:115] offset:19456
s_waitcnt vmcnt(3)
v_cmp_eq_u32 vcc, -1, v39
s_cbranch_vccnz L_C_F0123
v_smfmac_f32_16x16x64_bf16 v[76:79], v[36:39], a[192:199], v3
v_smfmac_f32_16x16x64_bf16 v[80:83], v[36:39], a[200:207], v3
s_waitcnt vmcnt(2)
v_cmp_eq_u32 vcc, -1, v43
s_cbranch_vccnz L_C_F123
v_smfmac_f32_16x16x64_bf16 v[76:79], v[40:43], a[208:215], v3
v_smfmac_f32_16x16x64_bf16 v[80:83], v[40:43], a[216:223], v3
s_waitcnt vmcnt(1)
v_cmp_eq_u32 vcc, -1, v47
s_cbranch_vccnz L_C_F23
v_smfmac_f32_16x16x64_bf16 v[76:79], v[44:47], a[224:231], v3
v_smfmac_f32_16x16x64_bf16 v[80:83], v[44:47], a[232:239], v3
s_waitcnt vmcnt(0)
v_cmp_eq_u32 vcc, -1, v51
s_cbranch_vccnz L_C_F3
v_smfmac_f32_16x16x64_bf16 v[76:79], v[48:51], a[240:247], v3
v_smfmac_f32_16x16x64_bf16 v[80:83], v[48:51], a[248:255], v3
L_w0C_done:
    s_nop 3
v_add_f32 v156, v76, v77
v_add_f32 v158, v78, v79
    s_nop 1
v_add_f32 v157, v80, v81
v_add_f32 v159, v82, v83
ds_write_b128 v6, v[156:159] offset:12288
v_cmp_u_f32 vcc, v156, v158
s_cbranch_vccnz L_C_redo
L_w0C_ok:
s_mov_b32 m0, s36
    s_nop 0
buffer_load_dwordx4 v15, s[4:7], s34 offen offset:0 sc1 lds
buffer_load_dwordx4 v15, s[4:7], s34 offen offset:1024 sc1 lds
buffer_load_dwordx4 v15, s[4:7], s34 offen offset:2048 sc1 lds
buffer_load_dwordx4 v15, s[4:7], s34 offen offset:3072 sc1 lds
s_waitcnt lgkmcnt(0)
s_barrier
ds_read_b64 v[192:193], v7 offset:13320
ds_read_b64 v[194:195], v7 offset:14344
ds_read_b64 v[196:197], v7 offset:15368
s_cmp_eq_u32 s14, 0
s_waitcnt lgkmcnt(2)
v_pk_add_f32 v[192:193], v[192:193], v[158:159]
s_waitcnt lgkmcnt(1)
v_pk_add_f32 v[192:193], v[192:193], v[194:195]
s_waitcnt lgkmcnt(0)
v_pk_add_f32 v[192:193], v[192:193], v[196:197]
v_cvt_pk_bf16_f32 v192, v192, v193
buffer_store_dword v192, v255, s[4:7], s31 offen sc1
v_lshlrev_b32 v246, 16, v192
v_and_b32 v247, 0xffff0000, v192
s_mov_b32 s94, s31
s_mov_b32 m0, s37
    s_nop 0
buffer_load_dwordx4 v16, s[4:7], s34 offen offset:0 sc1 lds
buffer_load_dwordx4 v16, s[4:7], s34 offen offset:1024 sc1 lds
buffer_store_dwordx2 v[32:33], v13, s[4:7], s33 offen sc1
s_and_b32 s18, s13, 31
s_cmp_eq_u32 s18, 0
s_cbranch_scc0 L_w0_noflag
s_cmp_eq_u32 s30, 0
s_cbranch_scc1 L_w0_noflag
s_sub_u32 s18, s30, 1
s_and_b32 s19, s18, 0x30
s_add_u32 s18, s18, s19
s_lshl_b32 s18, s18, 9
s_mov_b64 exec, 1
buffer_store_dword v25, v21, s[4:7], s18 offen sc1
s_mov_b64 exec, -1
L_w0_noflag:
s_cmp_eq_u32 s14, 0
s_cbranch_scc1 L_pub_4_s
buffer_store_dwordx2 v[32:33], v23, s[4:7], s33 offen
buffer_store_dwordx2 v[32:33], v23, s[4:7], s33 offen offset:2048
buffer_store_dwordx4 v[32:35], v11, s[4:7], s33 offen
buffer_store_dwordx4 v[32:35], v24, s[4:7], s33 offen
L_pub_4_d:
v_mov_b32 v52, 0
v_mov_b32 v53, 0
v_mov_b32 v54, 0
v_mov_b32 v55, 0
v_mov_b32 v56, 0
v_mov_b32 v57, 0
v_mov_b32 v58, 0
v_mov_b32 v59, 0
v_mov_b32 v60, 0
v_mov_b32 v61, 0
v_mov_b32 v62, 0
v_mov_b32 v63, 0
v_mov_b32 v64, 0
v_mov_b32 v65, 0
v_mov_b32 v66, 0
v_mov_b32 v67, 0
v_mov_b32 v68, 0
v_mov_b32 v69, 0
v_mov_b32 v70, 0
v_mov_b32 v71, 0
v_mov_b32 v72, 0
v_mov_b32 v73, 0
v_mov_b32 v74, 0
v_mov_b32 v75, 0
v_mov_b32 v76, 0
v_mov_b32 v77, 0
v_mov_b32 v78, 0
v_mov_b32 v79, 0
v_mov_b32 v80, 0
v_mov_b32 v81, 0
v_mov_b32 v82, 0
v_mov_b32 v83, 0
s_sleep 2
s_nop 7
buffer_load_dword v84, v252, s[4:7], s94 offen sc1
buffer_load_dword v85, v253, s[4:7], s94 offen sc1
buffer_load_dword v86, v254, s[4:7], s94 offen sc1
s_add_u32 s30, s30, 1
s_mov_b32 s31, s32
s_mov_b32 s32, s33
s_add_u32 s33, s33, 0x60000
s_cmp_eq_u32 s33, 0x8180000
s_cselect_b32 s33, 0x8000000, s33
s_xor_b32 s43, s34, 0
s_add_u32 s34, s34, 0x80000
s_and_b32 s18, s34, 0x180000
s_cselect_b32 s18, 0, 0x2000
s_xor_b32 s34, s34, s18
s_sub_u32 s36, s36, s35
s_sub_u32 s37, s37, s35
v_add_u32 v18, s35, v18
s_sub_u32 s35, 0, s35
L_w0_P:
s_cmp_eq_u32 s14, 0
s_waitcnt vmcnt(0)
v_max3_u32 v224, v84, v85, v86
v_lshlrev_b32 v200, 16, v84
v_and_b32 v201, s46, v84
v_cmp_eq_u32 vcc, -1, v224
v_lshlrev_b32 v202, 16, v85
v_and_b32 v203, s46, v85
v_pk_add_f32 v[200:201], v[200:201], v[246:247]
v_lshlrev_b32 v204, 16, v86
v_and_b32 v205, s46, v86
s_cbranch_vccnz L_w0_Pf
v_pk_add_f32 v[202:203], v[202:203], v[204:205]
v_pk_add_f32 v[200:201], v[200:201], v[202:203]
v_cvt_pk_bf16_f32 v192, v200, v201
s_cbranch_scc1 L_pub_5_s
buffer_store_dword v192, v12, s[4:7], s31 offen offset:32
L_pub_5_d:
s_nop 15
s_nop 3
s_branch L_w0
L_w0_Pf:
buffer_load_dword v84, v252, s[4:7], s94 offen sc1
buffer_load_dword v85, v253, s[4:7], s94 offen sc1
buffer_load_dword v86, v254, s[4:7], s94 offen sc1
s_sub_u32 s15, s15, 1
s_cbranch_scc1 L_exit
s_branch L_w0_P
L_w0_last:
s_barrier
ds_write_b128 v7, v[100:103] offset:16384
ds_write_b128 v7, v[104:107] offset:17408
ds_write_b128 v7, v[108:111] offset:18432
ds_write_b128 v7, v[112:115] offset:19456
s_waitcnt lgkmcnt(0)
s_barrier
s_branch L_exit
L_pub_2_s:
buffer_store_dword v192, v8, s[4:7], s31 offen offset:16 sc1
s_branch L_pub_2_d
L_S_F0123:
buffer_load_dwordx4 v[84:87], v9, s[4:7], s31 offen offset:0 sc1
buffer_load_dwordx4 v[100:103], v10, s[4:7], s31 offen offset:2048 sc1
s_sub_u32 s15, s15, 1
s_cbranch_scc1 L_exit
s_waitcnt vmcnt(6)
v_max_u32 v224, v91, v107
v_cmp_eq_u32 vcc, -1, v224
s_cbranch_vccnz L_S_F1230
L_S_G1230:
v_mfma_f32_16x16x32_bf16 v[160:163], v[124:127], v[88:91], v[160:163]
v_mfma_f32_16x16x32_bf16 v[164:167], v[128:131], v[88:91], v[164:167]
s_waitcnt vmcnt(4)
v_max_u32 v224, v95, v111
v_cmp_eq_u32 vcc, -1, v224
v_mfma_f32_16x16x32_bf16 v[168:171], v[104:107], v[88:91], v[168:171]
s_cbranch_vccnz L_S_F230
L_S_G230:
v_mfma_f32_16x16x32_bf16 v[160:163], v[132:135], v[92:95], v[160:163]
v_mfma_f32_16x16x32_bf16 v[164:167], v[136:139], v[92:95], v[164:167]
s_waitcnt vmcnt(2)
v_max_u32 v224, v99, v115
v_cmp_eq_u32 vcc, -1, v224
v_mfma_f32_16x16x32_bf16 v[168:171], v[108:111], v[92:95], v[168:171]
s_cbranch_vccnz L_S_F30
L_S_G30:
v_mfma_f32_16x16x32_bf16 v[160:163], v[140:143], v[96:99], v[160:163]
v_mfma_f32_16x16x32_bf16 v[164:167], v[144:147], v[96:99], v[164:167]
s_waitcnt vmcnt(0)
v_max_u32 v224, v87, v103
v_cmp_eq_u32 vcc, -1, v224
v_mfma_f32_16x16x32_bf16 v[168:171], v[112:115], v[96:99], v[168:171]
s_cbranch_vccnz L_S_F0
L_S_G0:
v_mfma_f32_16x16x32_bf16 v[160:163], v[116:119], v[84:87], v[160:163]
v_mfma_f32_16x16x32_bf16 v[164:167], v[120:123], v[84:87], v[164:167]
v_mfma_f32_16x16x32_bf16 v[168:171], v[100:103], v[84:87], v[168:171]
s_branch L_w0_Sdone
L_S_F123:
buffer_load_dwordx4 v[88:91], v9, s[4:7], s31 offen offset:512 sc1
buffer_load_dwordx4 v[104:107], v10, s[4:7], s31 offen offset:2560 sc1
s_sub_u32 s15, s15, 1
s_cbranch_scc1 L_exit
s_waitcnt vmcnt(4)
v_max_u32 v224, v95, v111
v_cmp_eq_u32 vcc, -1, v224
s_cbranch_vccnz L_S_F231
L_S_G231:
v_mfma_f32_16x16x32_bf16 v[160:163], v[132:135], v[92:95], v[160:163]
v_mfma_f32_16x16x32_bf16 v[164:167], v[136:139], v[92:95], v[164:167]
s_waitcnt vmcnt(2)
v_max_u32 v224, v99, v115
v_cmp_eq_u32 vcc, -1, v224
v_mfma_f32_16x16x32_bf16 v[168:171], v[108:111], v[92:95], v[168:171]
s_cbranch_vccnz L_S_F31
L_S_G31:
v_mfma_f32_16x16x32_bf16 v[160:163], v[140:143], v[96:99], v[160:163]
v_mfma_f32_16x16x32_bf16 v[164:167], v[144:147], v[96:99], v[164:167]
s_waitcnt vmcnt(0)
v_max_u32 v224, v91, v107
v_cmp_eq_u32 vcc, -1, v224
v_mfma_f32_16x16x32_bf16 v[168:171], v[112:115], v[96:99], v[168:171]
s_cbranch_vccnz L_S_F1
L_S_G1:
v_mfma_f32_16x16x32_bf16 v[160:163], v[124:127], v[88:91], v[160:163]
v_mfma_f32_16x16x32_bf16 v[164:167], v[128:131], v[88:91], v[164:167]
v_mfma_f32_16x16x32_bf16 v[168:171], v[104:107], v[88:91], v[168:171]
s_branch L_w0_Sdone
L_S_F23:
buffer_load_dwordx4 v[92:95], v9, s[4:7], s31 offen offset:1024 sc1
buffer_load_dwordx4 v[108:111], v10, s[4:7], s31 offen offset:3072 sc1
s_sub_u32 s15, s15, 1
s_cbranch_scc1 L_exit
s_waitcnt vmcnt(2)
v_max_u32 v224, v99, v115
v_cmp_eq_u32 vcc, -1, v224
s_cbranch_vccnz L_S_F32
L_S_G32:
v_mfma_f32_16x16x32_bf16 v[160:163], v[140:143], v[96:99], v[160:163]
v_mfma_f32_16x16x32_bf16 v[164:167], v[144:147], v[96:99], v[164:167]
s_waitcnt vmcnt(0)
v_max_u32 v224, v95, v111
v_cmp_eq_u32 vcc, -1, v224
v_mfma_f32_16x16x32_bf16 v[168:171], v[112:115], v[96:99], v[168:171]
s_cbranch_vccnz L_S_F2
L_S_G2:
v_mfma_f32_16x16x32_bf16 v[160:163], v[132:135], v[92:95], v[160:163]
v_mfma_f32_16x16x32_bf16 v[164:167], v[136:139], v[92:95], v[164:167]
v_mfma_f32_16x16x32_bf16 v[168:171], v[108:111], v[92:95], v[168:171]
s_branch L_w0_Sdone
L_S_F3:
buffer_load_dwordx4 v[96:99], v9, s[4:7], s31 offen offset:1536 sc1
buffer_load_dwordx4 v[112:115], v10, s[4:7], s31 offen offset:3584 sc1
s_nop 14
L_S_L3:
buffer_load_dwordx4 v[96:99], v9, s[4:7], s31 offen offset:1536 sc1
buffer_load_dwordx4 v[112:115], v10, s[4:7], s31 offen offset:3584 sc1
s_sub_u32 s15, s15, 1
s_cbranch_scc1 L_exit
s_waitcnt vmcnt(2)
v_max_u32 v224, v99, v115
v_cmp_eq_u32 vcc, -1, v224
s_cbranch_vccnz L_S_L3
L_S_G3:
v_mfma_f32_16x16x32_bf16 v[160:163], v[140:143], v[96:99], v[160:163]
v_mfma_f32_16x16x32_bf16 v[164:167], v[144:147], v[96:99], v[164:167]
v_mfma_f32_16x16x32_bf16 v[168:171], v[112:115], v[96:99], v[168:171]
s_branch L_w0_Sdone
L_S_F1230:
buffer_load_dwordx4 v[88:91], v9, s[4:7], s31 offen offset:512 sc1
buffer_load_dwordx4 v[104:107], v10, s[4:7], s31 offen offset:2560 sc1
s_waitcnt vmcnt(6)
v_max_u32 v224, v95, v111
v_cmp_eq_u32 vcc, -1, v224
s_cbranch_vccnz L_S_F2301
L_S_G2301:
v_mfma_f32_16x16x32_bf16 v[160:163], v[132:135], v[92:95], v[160:163]
v_mfma_f32_16x16x32_bf16 v[164:167], v[136:139], v[92:95], v[164:167]
s_waitcnt vmcnt(4)
v_max_u32 v224, v99, v115
v_cmp_eq_u32 vcc, -1, v224
v_mfma_f32_16x16x32_bf16 v[168:171], v[108:111], v[92:95], v[168:171]
s_cbranch_vccnz L_S_F301
L_S_G301:
v_mfma_f32_16x16x32_bf16 v[160:163], v[140:143], v[96:99], v[160:163]
v_mfma_f32_16x16x32_bf16 v[164:167], v[144:147], v[96:99], v[164:167]
s_waitcnt vmcnt(2)
v_max_u32 v224, v87, v103
v_cmp_eq_u32 vcc, -1, v224
v_mfma_f32_16x16x32_bf16 v[168:171], v[112:115], v[96:99], v[168:171]
s_cbranch_vccnz L_S_F01
L_S_G01:
v_mfma_f32_16x16x32_bf16 v[160:163], v[116:119], v[84:87], v[160:163]
v_mfma_f32_16x16x32_bf16 v[164:167], v[120:123], v[84:87], v[164:167]
s_waitcnt vmcnt(0)
v_max_u32 v224, v91, v107
v_cmp_eq_u32 vcc, -1, v224
v_mfma_f32_16x16x32_bf16 v[168:171], v[100:103], v[84:87], v[168:171]
s_cbranch_vccnz L_S_F1
s_branch L_S_G1
L_S_F230:
buffer_load_dwordx4 v[92:95], v9, s[4:7], s31 offen offset:1024 sc1
buffer_load_dwordx4 v[108:111], v10, s[4:7], s31 offen offset:3072 sc1
s_waitcnt vmcnt(4)
v_max_u32 v224, v99, v115
v_cmp_eq_u32 vcc, -1, v224
s_cbranch_vccnz L_S_F302
L_S_G302:
v_mfma_f32_16x16x32_bf16 v[160:163], v[140:143], v[96:99], v[160:163]
v_mfma_f32_16x16x32_bf16 v[164:167], v[144:147], v[96:99], v[164:167]
s_waitcnt vmcnt(2)
v_max_u32 v224, v87, v103
v_cmp_eq_u32 vcc, -1, v224
v_mfma_f32_16x16x32_bf16 v[168:171], v[112:115], v[96:99], v[168:171]
s_cbranch_vccnz L_S_F02
L_S_G02:
v_mfma_f32_16x16x32_bf16 v[160:163], v[116:119], v[84:87], v[160:163]
v_mfma_f32_16x16x32_bf16 v[164:167], v[120:123], v[84:87], v[164:167]
s_waitcnt vmcnt(0)
v_max_u32 v224, v95, v111
v_cmp_eq_u32 vcc, -1, v224
v_mfma_f32_16x16x32_bf16 v[168:171], v[100:103], v[84:87], v[168:171]
s_cbranch_vccnz L_S_F2
s_branch L_S_G2
L_S_F30:
buffer_load_dwordx4 v[96:99], v9, s[4:7], s31 offen offset:1536 sc1
buffer_load_dwordx4 v[112:115], v10, s[4:7], s31 offen offset:3584 sc1
s_waitcnt vmcnt(2)
v_max_u32 v224, v87, v103
v_cmp_eq_u32 vcc, -1, v224
s_cbranch_vccnz L_S_F03
L_S_G03:
v_mfma_f32_16x16x32_bf16 v[160:163], v[116:119], v[84:87], v[160:163]
v_mfma_f32_16x16x32_bf16 v[164:167], v[120:123], v[84:87], v[164:167]
s_waitcnt vmcnt(0)
v_max_u32 v224, v99, v115
v_cmp_eq_u32 vcc, -1, v224
v_mfma_f32_16x16x32_bf16 v[168:171], v[100:103], v[84:87], v[168:171]
s_cbranch_vccnz L_S_F3
s_branch L_S_G3
L_S_F0:
buffer_load_dwordx4 v[84:87], v9, s[4:7], s31 offen offset:0 sc1
buffer_load_dwordx4 v[100:103], v10, s[4:7], s31 offen offset:2048 sc1
s_nop 14
L_S_L0:
buffer_load_dwordx4 v[84:87], v9, s[4:7], s31 offen offset:0 sc1
buffer_load_dwordx4 v[100:103], v10, s[4:7], s31 offen offset:2048 sc1
s_sub_u32 s15, s15, 1
s_cbranch_scc1 L_exit
s_waitcnt vmcnt(2)
v_max_u32 v224, v87, v103
v_cmp_eq_u32 vcc, -1, v224
s_cbranch_vccnz L_S_L0
s_branch L_S_G0
L_S_F231:
buffer_load_dwordx4 v[92:95], v9, s[4:7], s31 offen offset:1024 sc1
buffer_load_dwordx4 v[108:111], v10, s[4:7], s31 offen offset:3072 sc1
s_waitcnt vmcnt(4)
v_max_u32 v224, v99, v115
v_cmp_eq_u32 vcc, -1, v224
s_cbranch_vccnz L_S_F312
L_S_G312:
v_mfma_f32_16x16x32_bf16 v[160:163], v[140:143], v[96:99], v[160:163]
v_mfma_f32_16x16x32_bf16 v[164:167], v[144:147], v[96:99], v[164:167]
s_waitcnt vmcnt(2)
v_max_u32 v224, v91, v107
v_cmp_eq_u32 vcc, -1, v224
v_mfma_f32_16x16x32_bf16 v[168:171], v[112:115], v[96:99], v[168:171]
s_cbranch_vccnz L_S_F12
L_S_G12:
v_mfma_f32_16x16x32_bf16 v[160:163], v[124:127], v[88:91], v[160:163]
v_mfma_f32_16x16x32_bf16 v[164:167], v[128:131], v[88:91], v[164:167]
s_waitcnt vmcnt(0)
v_max_u32 v224, v95, v111
v_cmp_eq_u32 vcc, -1, v224
v_mfma_f32_16x16x32_bf16 v[168:171], v[104:107], v[88:91], v[168:171]
s_cbranch_vccnz L_S_F2
s_branch L_S_G2
L_S_F31:
buffer_load_dwordx4 v[96:99], v9, s[4:7], s31 offen offset:1536 sc1
buffer_load_dwordx4 v[112:115], v10, s[4:7], s31 offen offset:3584 sc1
s_waitcnt vmcnt(2)
v_max_u32 v224, v91, v107
v_cmp_eq_u32 vcc, -1, v224
s_cbranch_vccnz L_S_F13
L_S_G13:
v_mfma_f32_16x16x32_bf16 v[160:163], v[124:127], v[88:91], v[160:163]
v_mfma_f32_16x16x32_bf16 v[164:167], v[128:131], v[88:91], v[164:167]
s_waitcnt vmcnt(0)
v_max_u32 v224, v99, v115
v_cmp_eq_u32 vcc, -1, v224
v_mfma_f32_16x16x32_bf16 v[168:171], v[104:107], v[88:91], v[168:171]
s_cbranch_vccnz L_S_F3
s_branch L_S_G3
L_S_F1:
buffer_load_dwordx4 v[88:91], v9, s[4:7], s31 offen offset:512 sc1
buffer_load_dwordx4 v[104:107], v10, s[4:7], s31 offen offset:2560 sc1
s_nop 14
L_S_L1:
buffer_load_dwordx4 v[88:91], v9, s[4:7], s31 offen offset:512 sc1
buffer_load_dwordx4 v[104:107], v10, s[4:7], s31 offen offset:2560 sc1
s_sub_u32 s15, s15, 1
s_cbranch_scc1 L_exit
s_waitcnt vmcnt(2)
v_max_u32 v224, v91, v107
v_cmp_eq_u32 vcc, -1, v224
s_cbranch_vccnz L_S_L1
s_branch L_S_G1
L_S_F32:
buffer_load_dwordx4 v[96:99], v9, s[4:7], s31 offen offset:1536 sc1
buffer_load_dwordx4 v[112:115], v10, s[4:7], s31 offen offset:3584 sc1
s_waitcnt vmcnt(2)
v_max_u32 v224, v95, v111
v_cmp_eq_u32 vcc, -1, v224
s_cbranch_vccnz L_S_F23
L_S_G23:
v_mfma_f32_16x16x32_bf16 v[160:163], v[132:135], v[92:95], v[160:163]
v_mfma_f32_16x16x32_bf16 v[164:167], v[136:139], v[92:95], v[164:167]
s_waitcnt vmcnt(0)
v_max_u32 v224, v99, v115
v_cmp_eq_u32 vcc, -1, v224
v_mfma_f32_16x16x32_bf16 v[168:171], v[108:111], v[92:95], v[168:171]
s_cbranch_vccnz L_S_F3
s_branch L_S_G3
L_S_F2:
buffer_load_dwordx4 v[92:95], v9, s[4:7], s31 offen offset:1024 sc1
buffer_load_dwordx4 v[108:111], v10, s[4:7], s31 offen offset:3072 sc1
s_nop 14
L_S_L2:
buffer_load_dwordx4 v[92:95], v9, s[4:7], s31 offen offset:1024 sc1
buffer_load_dwordx4 v[108:111], v10, s[4:7], s31 offen offset:3072 sc1
s_sub_u32 s15, s15, 1
s_cbranch_scc1 L_exit
s_waitcnt vmcnt(2)
v_max_u32 v224, v95, v111
v_cmp_eq_u32 vcc, -1, v224
s_cbranch_vccnz L_S_L2
s_branch L_S_G2
L_S_F2301:
buffer_load_dwordx4 v[92:95], v9, s[4:7], s31 offen offset:1024 sc1
buffer_load_dwordx4 v[108:111], v10, s[4:7], s31 offen offset:3072 sc1
s_waitcnt vmcnt(6)
v_max_u32 v224, v99, v115
v_cmp_eq_u32 vcc, -1, v224
s_cbranch_vccnz L_S_F3012
L_S_G3012:
v_mfma_f32_16x16x32_bf16 v[160:163], v[140:143], v[96:99], v[160:163]
v_mfma_f32_16x16x32_bf16 v[164:167], v[144:147], v[96:99], v[164:167]
s_waitcnt vmcnt(4)
v_max_u32 v224, v87, v103
v_cmp_eq_u32 vcc, -1, v224
v_mfma_f32_16x16x32_bf16 v[168:171], v[112:115], v[96:99], v[168:171]
s_cbranch_vccnz L_S_F012
L_S_G012:
v_mfma_f32_16x16x32_bf16 v[160:163], v[116:119], v[84:87], v[160:163]
v_mfma_f32_16x16x32_bf16 v[164:167], v[120:123], v[84:87], v[164:167]
s_waitcnt vmcnt(2)
v_max_u32 v224, v91, v107
v_cmp_eq_u32 vcc, -1, v224
v_mfma_f32_16x16x32_bf16 v[168:171], v[100:103], v[84:87], v[168:171]
s_cbranch_vccnz L_S_F12
s_branch L_S_G12
L_S_F301:
buffer_load_dwordx4 v[96:99], v9, s[4:7], s31 offen offset:1536 sc1
buffer_load_dwordx4 v[112:115], v10, s[4:7], s31 offen offset:3584 sc1
s_waitcnt vmcnt(4)
v_max_u32 v224, v87, v103
v_cmp_eq_u32 vcc, -1, v224
s_cbranch_vccnz L_S_F013
L_S_G013:
v_mfma_f32_16x16x32_bf16 v[160:163], v[116:119], v[84:87], v[160:163]
v_mfma_f32_16x16x32_bf16 v[164:167], v[120:123], v[84:87], v[164:167]
s_waitcnt vmcnt(2)
v_max_u32 v224, v91, v107
v_cmp_eq_u32 vcc, -1, v224
v_mfma_f32_16x16x32_bf16 v[168:171], v[100:103], v[84:87], v[168:171]
s_cbranch_vccnz L_S_F13
s_branch L_S_G13
L_S_F01:
buffer_load_dwordx4 v[84:87], v9, s[4:7], s31 offen offset:0 sc1
buffer_load_dwordx4 v[100:103], v10, s[4:7], s31 offen offset:2048 sc1
s_sub_u32 s15, s15, 1
s_cbranch_scc1 L_exit
s_waitcnt vmcnt(2)
v_max_u32 v224, v91, v107
v_cmp_eq_u32 vcc, -1, v224
s_cbranch_vccnz L_S_F10
L_S_G10:
v_mfma_f32_16x16x32_bf16 v[160:163], v[124:127], v[88:91], v[160:163]
v_mfma_f32_16x16x32_bf16 v[164:167], v[128:131], v[88:91], v[164:167]
s_waitcnt vmcnt(0)
v_max_u32 v224, v87, v103
v_cmp_eq_u32 vcc, -1, v224
v_mfma_f32_16x16x32_bf16 v[168:171], v[104:107], v[88:91], v[168:171]
s_cbranch_vccnz L_S_F0
s_branch L_S_G0
L_S_F302:
buffer_load_dwordx4 v[96:99], v9, s[4:7], s31 offen offset:1536 sc1
buffer_load_dwordx4 v[112:115], v10, s[4:7], s31 offen offset:3584 sc1
s_waitcnt vmcnt(4)
v_max_u32 v224, v87, v103
v_cmp_eq_u32 vcc, -1, v224
s_cbranch_vccnz L_S_F023
L_S_G023:
v_mfma_f32_16x16x32_bf16 v[160:163], v[116:119], v[84:87], v[160:163]
v_mfma_f32_16x16x32_bf16 v[164:167], v[120:123], v[84:87], v[164:167]
s_waitcnt vmcnt(2)
v_max_u32 v224, v95, v111
v_cmp_eq_u32 vcc, -1, v224
v_mfma_f32_16x16x32_bf16 v[168:171], v[100:103], v[84:87], v[168:171]
s_cbranch_vccnz L_S_F23
s_branch L_S_G23
L_S_F02:
buffer_load_dwordx4 v[84:87], v9, s[4:7], s31 offen offset:0 sc1
buffer_load_dwordx4 v[100:103], v10, s[4:7], s31 offen offset:2048 sc1
s_sub_u32 s15, s15, 1
s_cbranch_scc1 L_exit
s_waitcnt vmcnt(2)
v_max_u32 v224, v95, v111
v_cmp_eq_u32 vcc, -1, v224
s_cbranch_vccnz L_S_F20
L_S_G20:
v_mfma_f32_16x16x32_bf16 v[160:163], v[132:135], v[92:95], v[160:163]
v_mfma_f32_16x16x32_bf16 v[164:167], v[136:139], v[92:95], v[164:167]
s_waitcnt vmcnt(0)
v_max_u32 v224, v87, v103
v_cmp_eq_u32 vcc, -1, v224
v_mfma_f32_16x16x32_bf16 v[168:171], v[108:111], v[92:95], v[168:171]
s_cbranch_vccnz L_S_F0
s_branch L_S_G0
L_S_F03:
buffer_load_dwordx4 v[84:87], v9, s[4:7], s31 offen offset:0 sc1
buffer_load_dwordx4 v[100:103], v10, s[4:7], s31 offen offset:2048 sc1
s_sub_u32 s15, s15, 1
s_cbranch_scc1 L_exit
s_waitcnt vmcnt(2)
v_max_u32 v224, v99, v115
v_cmp_eq_u32 vcc, -1, v224
s_cbranch_vccnz L_S_F30
s_branch L_S_G30
L_S_F312:
buffer_load_dwordx4 v[96:99], v9, s[4:7], s31 offen offset:1536 sc1
buffer_load_dwordx4 v[112:115], v10, s[4:7], s31 offen offset:3584 sc1
s_waitcnt vmcnt(4)
v_max_u32 v224, v91, v107
v_cmp_eq_u32 vcc, -1, v224
s_cbranch_vccnz L_S_F123
L_S_G123:
v_mfma_f32_16x16x32_bf16 v[160:163], v[124:127], v[88:91], v[160:163]
v_mfma_f32_16x16x32_bf16 v[164:167], v[128:131], v[88:91], v[164:167]
s_waitcnt vmcnt(2)
v_max_u32 v224, v95, v111
v_cmp_eq_u32 vcc, -1, v224
v_mfma_f32_16x16x32_bf16 v[168:171], v[104:107], v[88:91], v[168:171]
s_cbranch_vccnz L_S_F23
s_branch L_S_G23
L_S_F12:
buffer_load_dwordx4 v[88:91], v9, s[4:7], s31 offen offset:512 sc1
buffer_load_dwordx4 v[104:107], v10, s[4:7], s31 offen offset:2560 sc1
s_sub_u32 s15, s15, 1
s_cbranch_scc1 L_exit
s_waitcnt vmcnt(2)
v_max_u32 v224, v95, v111
v_cmp_eq_u32 vcc, -1, v224
s_cbranch_vccnz L_S_F21
L_S_G21:
v_mfma_f32_16x16x32_bf16 v[160:163], v[132:135], v[92:95], v[160:163]
v_mfma_f32_16x16x32_bf16 v[164:167], v[136:139], v[92:95], v[164:167]
s_waitcnt vmcnt(0)
v_max_u32 v224, v91, v107
v_cmp_eq_u32 vcc, -1, v224
v_mfma_f32_16x16x32_bf16 v[168:171], v[108:111], v[92:95], v[168:171]
s_cbranch_vccnz L_S_F1
s_branch L_S_G1
L_S_F13:
buffer_load_dwordx4 v[88:91], v9, s[4:7], s31 offen offset:512 sc1
buffer_load_dwordx4 v[104:107], v10, s[4:7], s31 offen offset:2560 sc1
s_sub_u32 s15, s15, 1
s_cbranch_scc1 L_exit
s_waitcnt vmcnt(2)
v_max_u32 v224, v99, v115
v_cmp_eq_u32 vcc, -1, v224
s_cbranch_vccnz L_S_F31
s_branch L_S_G31
L_S_F3012:
buffer_load_dwordx4 v[96:99], v9, s[4:7], s31 offen offset:1536 sc1
buffer_load_dwordx4 v[112:115], v10, s[4:7], s31 offen offset:3584 sc1
s_waitcnt vmcnt(6)
v_max_u32 v224, v87, v103
v_cmp_eq_u32 vcc, -1, v224
s_cbranch_vccnz L_S_F0123
L_S_G0123:
v_mfma_f32_16x16x32_bf16 v[160:163], v[116:119], v[84:87], v[160:163]
v_mfma_f32_16x16x32_bf16 v[164:167], v[120:123], v[84:87], v[164:167]
s_waitcnt vmcnt(4)
v_max_u32 v224, v91, v107
v_cmp_eq_u32 vcc, -1, v224
v_mfma_f32_16x16x32_bf16 v[168:171], v[100:103], v[84:87], v[168:171]
s_cbranch_vccnz L_S_F123
s_branch L_S_G123
L_S_F012:
buffer_load_dwordx4 v[84:87], v9, s[4:7], s31 offen offset:0 sc1
buffer_load_dwordx4 v[100:103], v10, s[4:7], s31 offen offset:2048 sc1
s_sub_u32 s15, s15, 1
s_cbranch_scc1 L_exit
s_waitcnt vmcnt(4)
v_max_u32 v224, v91, v107
v_cmp_eq_u32 vcc, -1, v224
s_cbranch_vccnz L_S_F120
L_S_G120:
v_mfma_f32_16x16x32_bf16 v[160:163], v[124:127], v[88:91], v[160:163]
v_mfma_f32_16x16x32_bf16 v[164:167], v[128:131], v[88:91], v[164:167]
s_waitcnt vmcnt(2)
v_max_u32 v224, v95, v111
v_cmp_eq_u32 vcc, -1, v224
v_mfma_f32_16x16x32_bf16 v[168:171], v[104:107], v[88:91], v[168:171]
s_cbranch_vccnz L_S_F20
s_branch L_S_G20
L_S_F013:
buffer_load_dwordx4 v[84:87], v9, s[4:7], s31 offen offset:0 sc1
buffer_load_dwordx4 v[100:103], v10, s[4:7], s31 offen offset:2048 sc1
s_sub_u32 s15, s15, 1
s_cbranch_scc1 L_exit
s_waitcnt vmcnt(4)
v_max_u32 v224, v91, v107
v_cmp_eq_u32 vcc, -1, v224
s_cbranch_vccnz L_S_F130
L_S_G130:
v_mfma_f32_16x16x32_bf16 v[160:163], v[124:127], v[88:91], v[160:163]
v_mfma_f32_16x16x32_bf16 v[164:167], v[128:131], v[88:91], v[164:167]
s_waitcnt vmcnt(2)
v_max_u32 v224, v99, v115
v_cmp_eq_u32 vcc, -1, v224
v_mfma_f32_16x16x32_bf16 v[168:171], v[104:107], v[88:91], v[168:171]
s_cbranch_vccnz L_S_F30
s_branch L_S_G30
L_S_F10:
buffer_load_dwordx4 v[88:91], v9, s[4:7], s31 offen offset:512 sc1
buffer_load_dwordx4 v[104:107], v10, s[4:7], s31 offen offset:2560 sc1
s_waitcnt vmcnt(2)
v_max_u32 v224, v87, v103
v_cmp_eq_u32 vcc, -1, v224
s_cbranch_vccnz L_S_F01
s_branch L_S_G01
L_S_F023:
buffer_load_dwordx4 v[84:87], v9, s[4:7], s31 offen offset:0 sc1
buffer_load_dwordx4 v[100:103], v10, s[4:7], s31 offen offset:2048 sc1
s_sub_u32 s15, s15, 1
s_cbranch_scc1 L_exit
s_waitcnt vmcnt(4)
v_max_u32 v224, v95, v111
v_cmp_eq_u32 vcc, -1, v224
s_cbranch_vccnz L_S_F230
s_branch L_S_G230
L_S_F20:
buffer_load_dwordx4 v[92:95], v9, s[4:7], s31 offen offset:1024 sc1
buffer_load_dwordx4 v[108:111], v10, s[4:7], s31 offen offset:3072 sc1
s_waitcnt vmcnt(2)
v_max_u32 v224, v87, v103
v_cmp_eq_u32 vcc, -1, v224
s_cbranch_vccnz L_S_F02
s_branch L_S_G02
L_S_F21:
buffer_load_dwordx4 v[92:95], v9, s[4:7], s31 offen offset:1024 sc1
buffer_load_dwordx4 v[108:111], v10, s[4:7], s31 offen offset:3072 sc1
s_waitcnt vmcnt(2)
v_max_u32 v224, v91, v107
v_cmp_eq_u32 vcc, -1, v224
s_cbranch_vccnz L_S_F12
s_branch L_S_G12
L_S_F120:
buffer_load_dwordx4 v[88:91], v9, s[4:7], s31 offen offset:512 sc1
buffer_load_dwordx4 v[104:107], v10, s[4:7], s31 offen offset:2560 sc1
s_waitcnt vmcnt(4)
v_max_u32 v224, v95, v111
v_cmp_eq_u32 vcc, -1, v224
s_cbranch_vccnz L_S_F201
L_S_G201:
v_mfma_f32_16x16x32_bf16 v[160:163], v[132:135], v[92:95], v[160:163]
v_mfma_f32_16x16x32_bf16 v[164:167], v[136:139], v[92:95], v[164:167]
s_waitcnt vmcnt(2)
v_max_u32 v224, v87, v103
v_cmp_eq_u32 vcc, -1, v224
v_mfma_f32_16x16x32_bf16 v[168:171], v[108:111], v[92:95], v[168:171]
s_cbranch_vccnz L_S_F01
s_branch L_S_G01
L_S_F130:
buffer_load_dwordx4 v[88:91], v9, s[4:7], s31 offen offset:512 sc1
buffer_load_dwordx4 v[104:107], v10, s[4:7], s31 offen offset:2560 sc1
s_waitcnt vmcnt(4)
v_max_u32 v224, v99, v115
v_cmp_eq_u32 vcc, -1, v224
s_cbranch_vccnz L_S_F301
s_branch L_S_G301
L_S_F201:
buffer_load_dwordx4 v[92:95], v9, s[4:7], s31 offen offset:1024 sc1
buffer_load_dwordx4 v[108:111], v10, s[4:7], s31 offen offset:3072 sc1
s_waitcnt vmcnt(4)
v_max_u32 v224, v87, v103
v_cmp_eq_u32 vcc, -1, v224
s_cbranch_vccnz L_S_F012
s_branch L_S_G012
L_w0_Sretry:
buffer_load_dwordx4 v[84:87], v9, s[4:7], s31 offen offset:0 sc1
buffer_load_dwordx4 v[100:103], v10, s[4:7], s31 offen offset:2048 sc1
buffer_load_dwordx4 v[88:91], v9, s[4:7], s31 offen offset:512 sc1
buffer_load_dwordx4 v[104:107], v10, s[4:7], s31 offen offset:2560 sc1
buffer_load_dwordx4 v[92:95], v9, s[4:7], s31 offen offset:1024 sc1
buffer_load_dwordx4 v[108:111], v10, s[4:7], s31 offen offset:3072 sc1
buffer_load_dwordx4 v[96:99], v9, s[4:7], s31 offen offset:1536 sc1
buffer_load_dwordx4 v[112:115], v10, s[4:7], s31 offen offset:3584 sc1
s_sub_u32 s15, s15, 1
s_cbranch_scc1 L_exit
s_waitcnt vmcnt(0)
v_max3_u32 v224, v84, v85, v86
v_max_u32 v224, v224, v87
v_max3_u32 v224, v224, v88, v89
v_max3_u32 v224, v224, v90, v91
v_max3_u32 v224, v224, v92, v93
v_max3_u32 v224, v224, v94, v95
v_max3_u32 v224, v224, v96, v97
v_max3_u32 v224, v224, v98, v99
v_max3_u32 v224, v224, v100, v101
v_max3_u32 v224, v224, v102, v103
v_max3_u32 v224, v224, v104, v105
v_max3_u32 v224, v224, v106, v107
v_max3_u32 v224, v224, v108, v109
v_max3_u32 v224, v224, v110, v111
v_max3_u32 v224, v224, v112, v113
v_max3_u32 v224, v224, v114, v115
v_cmp_eq_u32 vcc, -1, v224
s_cbranch_vccnz L_w0_Sretry
v_mov_b32 v160, 0
v_mov_b32 v161, 0
v_mov_b32 v162, 0
v_mov_b32 v163, 0
v_mov_b32 v164, 0
v_mov_b32 v165, 0
v_mov_b32 v166, 0
v_mov_b32 v167, 0
v_mov_b32 v168, 0
v_mov_b32 v169, 0
v_mov_b32 v170, 0
v_mov_b32 v171, 0
v_mfma_f32_16x16x32_bf16 v[160:163], v[116:119], v[84:87], v[160:163]
v_mfma_f32_16x16x32_bf16 v[164:167], v[120:123], v[84:87], v[164:167]
v_mfma_f32_16x16x32_bf16 v[168:171], v[100:103], v[84:87], v[168:171]
v_mfma_f32_16x16x32_bf16 v[160:163], v[124:127], v[88:91], v[160:163]
v_mfma_f32_16x16x32_bf16 v[164:167], v[128:131], v[88:91], v[164:167]
v_mfma_f32_16x16x32_bf16 v[168:171], v[104:107], v[88:91], v[168:171]
v_mfma_f32_16x16x32_bf16 v[160:163], v[132:135], v[92:95], v[160:163]
v_mfma_f32_16x16x32_bf16 v[164:167], v[136:139], v[92:95], v[164:167]
v_mfma_f32_16x16x32_bf16 v[168:171], v[108:111], v[92:95], v[168:171]
v_mfma_f32_16x16x32_bf16 v[160:163], v[140:143], v[96:99], v[160:163]
v_mfma_f32_16x16x32_bf16 v[164:167], v[144:147], v[96:99], v[164:167]
v_mfma_f32_16x16x32_bf16 v[168:171], v[112:115], v[96:99], v[168:171]
    s_nop 3
v_cndmask_b32 v160, v160, v164, s[44:45]
v_cndmask_b32 v161, v161, v165, s[44:45]
v_cndmask_b32 v162, v162, v166, s[44:45]
v_cndmask_b32 v163, v163, v167, s[44:45]
v_max3_f32 v26, v160, v161, v162
v_cndmask_b32 v232, v168, v169, s[44:45]
s_cmp_eq_u32 s30, 63
s_branch L_w0_Sok
L_pub_3_s:
buffer_store_dwordx4 v[192:195], v14, s[4:7], s31 offen  sc1
s_branch L_pub_3_d
L_pub_4_s:
buffer_store_dwordx2 v[32:33], v23, s[4:7], s33 offen  sc1
buffer_store_dwordx2 v[32:33], v23, s[4:7], s33 offen offset:2048 sc1
buffer_store_dwordx4 v[32:35], v11, s[4:7], s33 offen  sc1
buffer_store_dwordx4 v[32:35], v24, s[4:7], s33 offen  sc1
s_branch L_pub_4_d
L_pub_5_s:
buffer_store_dword v192, v12, s[4:7], s31 offen offset:32 sc1
s_branch L_pub_5_d
.p2align 6
L_w1:
s_barrier
buffer_load_dwordx4 v[36:39], v4, s[4:7], s31 offen offset:0 sc1
s_nop 10
buffer_load_dwordx4 v[40:43], v4, s[4:7], s31 offen offset:1024 sc1
s_nop 10
buffer_load_dwordx4 v[44:47], v4, s[4:7], s31 offen offset:2048 sc1
s_nop 10
buffer_load_dwordx4 v[48:51], v4, s[4:7], s31 offen offset:3072 sc1
s_waitcnt vmcnt(3)
v_cmp_eq_u32 vcc, -1, v39
s_cbranch_vccnz L_A_F0123
v_smfmac_f32_16x16x64_bf16 v[52:55], v[36:39], a[0:7], v3
v_smfmac_f32_16x16x64_bf16 v[56:59], v[36:39], a[8:15], v3
v_smfmac_f32_16x16x64_bf16 v[60:63], v[36:39], a[16:23], v3
s_waitcnt vmcnt(2)
v_cmp_eq_u32 vcc, -1, v43
v_smfmac_f32_16x16x64_bf16 v[64:67], v[36:39], a[24:31], v3
s_cbranch_vccnz L_A_F123
v_smfmac_f32_16x16x64_bf16 v[52:55], v[40:43], a[48:55], v3
v_smfmac_f32_16x16x64_bf16 v[56:59], v[40:43], a[56:63], v3
v_smfmac_f32_16x16x64_bf16 v[60:63], v[40:43], a[64:71], v3
s_waitcnt vmcnt(1)
v_cmp_eq_u32 vcc, -1, v47
v_smfmac_f32_16x16x64_bf16 v[64:67], v[40:43], a[72:79], v3
s_cbranch_vccnz L_A_F23
v_smfmac_f32_16x16x64_bf16 v[52:55], v[44:47], a[96:103], v3
v_smfmac_f32_16x16x64_bf16 v[56:59], v[44:47], a[104:111], v3
v_smfmac_f32_16x16x64_bf16 v[60:63], v[44:47], a[112:119], v3
s_waitcnt vmcnt(0)
v_cmp_eq_u32 vcc, -1, v51
v_smfmac_f32_16x16x64_bf16 v[64:67], v[44:47], a[120:127], v3
s_cbranch_vccnz L_A_F3
v_smfmac_f32_16x16x64_bf16 v[52:55], v[48:51], a[144:151], v3
v_smfmac_f32_16x16x64_bf16 v[56:59], v[48:51], a[152:159], v3
v_smfmac_f32_16x16x64_bf16 v[60:63], v[48:51], a[160:167], v3
v_smfmac_f32_16x16x64_bf16 v[64:67], v[48:51], a[168:175], v3
L_w1A_done:
v_add_f32 v156, v52, v53
v_add_f32 v158, v54, v55
v_add_f32 v157, v56, v57
v_add_f32 v159, v58, v59
ds_write_b128 v6, v[156:159] offset:0
v_add_f32 v244, v60, v61
v_add_f32 v246, v62, v63
    s_nop 0
v_add_f32 v245, v64, v65
v_add_f32 v247, v66, v67
ds_write_b128 v6, v[244:247] offset:4096
v_cmp_u_f32 vcc, v156, v158
s_cbranch_vccnz L_A_redo
L_w1A_ok:
v_smfmac_f32_16x16x64_bf16 v[68:71], v[36:39], a[32:39], v3
v_smfmac_f32_16x16x64_bf16 v[72:75], v[36:39], a[40:47], v3
s_waitcnt lgkmcnt(0)
s_barrier
ds_read_b64 v[192:193], v7 offset:0
ds_read_b64 v[194:195], v7 offset:2048
ds_read_b64 v[196:197], v7 offset:3072
s_cmp_eq_u32 s14, 0
s_waitcnt lgkmcnt(2)
v_pk_add_f32 v[192:193], v[192:193], v[156:157]
s_waitcnt lgkmcnt(1)
v_pk_add_f32 v[192:193], v[192:193], v[194:195]
s_waitcnt lgkmcnt(0)
v_pk_add_f32 v[192:193], v[192:193], v[196:197]
v_cvt_pk_bf16_f32 v192, v192, v193
s_cbranch_scc1 L_pub_6_s
buffer_store_dword v192, v8, s[4:7], s31 offen offset:0
L_pub_6_d:
v_smfmac_f32_16x16x64_bf16 v[68:71], v[40:43], a[80:87], v3
v_smfmac_f32_16x16x64_bf16 v[72:75], v[40:43], a[88:95], v3
v_smfmac_f32_16x16x64_bf16 v[68:71], v[44:47], a[128:135], v3
v_smfmac_f32_16x16x64_bf16 v[72:75], v[44:47], a[136:143], v3
v_smfmac_f32_16x16x64_bf16 v[68:71], v[48:51], a[176:183], v3
v_smfmac_f32_16x16x64_bf16 v[72:75], v[48:51], a[184:191], v3
    s_nop 3
v_add_f32 v156, v68, v69
v_add_f32 v158, v70, v71
    s_nop 1
v_add_f32 v157, v72, v73
v_add_f32 v159, v74, v75
ds_write_b128 v6, v[156:159] offset:8192
s_waitcnt lgkmcnt(0)
s_barrier
s_cmp_eq_u32 s30, 63
s_cbranch_scc1 L_w1_last
s_barrier
s_add_u32 s94, s31, 0x0
s_barrier
s_nop 15
s_nop 4
buffer_load_dwordx4 v[36:39], v5, s[4:7], s31 offen offset:0 sc1
s_nop 10
buffer_load_dwordx4 v[40:43], v5, s[4:7], s31 offen offset:1024 sc1
s_nop 10
buffer_load_dwordx4 v[44:47], v5, s[4:7], s31 offen offset:2048 sc1
s_nop 10
buffer_load_dwordx4 v[48:51], v5, s[4:7], s31 offen offset:3072 sc1
s_waitcnt vmcnt(3)
v_cmp_eq_u32 vcc, -1, v39
s_cbranch_vccnz L_C_F0123
v_smfmac_f32_16x16x64_bf16 v[76:79], v[36:39], a[192:199], v3
v_smfmac_f32_16x16x64_bf16 v[80:83], v[36:39], a[200:207], v3
s_waitcnt vmcnt(2)
v_cmp_eq_u32 vcc, -1, v43
s_cbranch_vccnz L_C_F123
v_smfmac_f32_16x16x64_bf16 v[76:79], v[40:43], a[208:215], v3
v_smfmac_f32_16x16x64_bf16 v[80:83], v[40:43], a[216:223], v3
s_waitcnt vmcnt(1)
v_cmp_eq_u32 vcc, -1, v47
s_cbranch_vccnz L_C_F23
v_smfmac_f32_16x16x64_bf16 v[76:79], v[44:47], a[224:231], v3
v_smfmac_f32_16x16x64_bf16 v[80:83], v[44:47], a[232:239], v3
s_waitcnt vmcnt(0)
v_cmp_eq_u32 vcc, -1, v51
s_cbranch_vccnz L_C_F3
v_smfmac_f32_16x16x64_bf16 v[76:79], v[48:51], a[240:247], v3
v_smfmac_f32_16x16x64_bf16 v[80:83], v[48:51], a[248:255], v3
L_w1C_done:
    s_nop 3
v_add_f32 v156, v76, v77
v_add_f32 v158, v78, v79
    s_nop 1
v_add_f32 v157, v80, v81
v_add_f32 v159, v82, v83
ds_write_b128 v6, v[156:159] offset:12288
v_cmp_u_f32 vcc, v156, v158
s_cbranch_vccnz L_C_redo
L_w1C_ok:
s_waitcnt lgkmcnt(0)
s_barrier
ds_read_b64 v[192:193], v7 offset:12288
ds_read_b64 v[194:195], v7 offset:14336
ds_read_b64 v[196:197], v7 offset:15360
s_cmp_eq_u32 s14, 0
s_waitcnt lgkmcnt(2)
v_pk_add_f32 v[192:193], v[192:193], v[156:157]
s_waitcnt lgkmcnt(1)
v_pk_add_f32 v[192:193], v[192:193], v[194:195]
s_waitcnt lgkmcnt(0)
v_pk_add_f32 v[192:193], v[192:193], v[196:197]
v_cvt_pk_bf16_f32 v192, v192, v193
buffer_store_dword v192, v255, s[4:7], s31 offen sc1
v_lshlrev_b32 v246, 16, v192
v_and_b32 v247, 0xffff0000, v192
s_mov_b32 s94, s31
v_mov_b32 v52, 0
v_mov_b32 v53, 0
v_mov_b32 v54, 0
v_mov_b32 v55, 0
v_mov_b32 v56, 0
v_mov_b32 v57, 0
v_mov_b32 v58, 0
v_mov_b32 v59, 0
v_mov_b32 v60, 0
v_mov_b32 v61, 0
v_mov_b32 v62, 0
v_mov_b32 v63, 0
v_mov_b32 v64, 0
v_mov_b32 v65, 0
v_mov_b32 v66, 0
v_mov_b32 v67, 0
v_mov_b32 v68, 0
v_mov_b32 v69, 0
v_mov_b32 v70, 0
v_mov_b32 v71, 0
v_mov_b32 v72, 0
v_mov_b32 v73, 0
v_mov_b32 v74, 0
v_mov_b32 v75, 0
v_mov_b32 v76, 0
v_mov_b32 v77, 0
v_mov_b32 v78, 0
v_mov_b32 v79, 0
v_mov_b32 v80, 0
v_mov_b32 v81, 0
v_mov_b32 v82, 0
v_mov_b32 v83, 0
s_sleep 4
s_nop 5
buffer_load_dword v84, v252, s[4:7], s94 offen sc1
buffer_load_dword v85, v253, s[4:7], s94 offen sc1
buffer_load_dword v86, v254, s[4:7], s94 offen sc1
s_add_u32 s30, s30, 1
s_mov_b32 s31, s32
s_mov_b32 s32, s33
s_add_u32 s33, s33, 0x60000
s_cmp_eq_u32 s33, 0x8180000
s_cselect_b32 s33, 0x8000000, s33
s_xor_b32 s43, s34, 0
s_add_u32 s34, s34, 0x80000
s_and_b32 s18, s34, 0x180000
s_cselect_b32 s18, 0, 0x2000
s_xor_b32 s34, s34, s18
s_sub_u32 s36, s36, s35
s_sub_u32 s37, s37, s35
v_add_u32 v18, s35, v18
s_sub_u32 s35, 0, s35
L_w1_P:
s_cmp_eq_u32 s14, 0
s_waitcnt vmcnt(0)
v_max3_u32 v224, v84, v85, v86
v_lshlrev_b32 v200, 16, v84
v_and_b32 v201, s46, v84
v_cmp_eq_u32 vcc, -1, v224
v_lshlrev_b32 v202, 16, v85
v_and_b32 v203, s46, v85
v_pk_add_f32 v[200:201], v[200:201], v[246:247]
v_lshlrev_b32 v204, 16, v86
v_and_b32 v205, s46, v86
s_cbranch_vccnz L_w1_Pf
v_pk_add_f32 v[202:203], v[202:203], v[204:205]
v_pk_add_f32 v[200:201], v[200:201], v[202:203]
v_cvt_pk_bf16_f32 v192, v200, v201
s_cbranch_scc1 L_pub_7_s
buffer_store_dword v192, v12, s[4:7], s31 offen offset:0
L_pub_7_d:
s_nop 15
s_nop 3
s_branch L_w1
L_w1_Pf:
buffer_load_dword v84, v252, s[4:7], s94 offen sc1
buffer_load_dword v85, v253, s[4:7], s94 offen sc1
buffer_load_dword v86, v254, s[4:7], s94 offen sc1
s_sub_u32 s15, s15, 1
s_cbranch_scc1 L_exit
s_branch L_w1_P
L_w1_last:
s_barrier
s_barrier
s_branch L_exit
L_pub_6_s:
buffer_store_dword v192, v8, s[4:7], s31 offen offset:0 sc1
s_branch L_pub_6_d
L_pub_7_s:
buffer_store_dword v192, v12, s[4:7], s31 offen offset:0 sc1
s_branch L_pub_7_d
.p2align 6
L_w23:
s_barrier
buffer_load_dwordx4 v[36:39], v4, s[4:7], s31 offen offset:0 sc1
s_nop 10
buffer_load_dwordx4 v[40:43], v4, s[4:7], s31 offen offset:1024 sc1
s_nop 10
buffer_load_dwordx4 v[44:47], v4, s[4:7], s31 offen offset:2048 sc1
s_nop 10
buffer_load_dwordx4 v[48:51], v4, s[4:7], s31 offen offset:3072 sc1
v_add_u32 v226, s47, v18
ds_read_b128 v[84:87], v226 offset:8192
ds_read_b128 v[88:91], v226 offset:10240
ds_read_b128 v[92:95], v226 offset:12288
ds_read_b128 v[96:99], v226 offset:14336
ds_read_b128 v[116:119], v18 offset:0
ds_read_b128 v[120:123], v18 offset:1024
ds_read_b128 v[124:127], v18 offset:2048
ds_read_b128 v[128:131], v18 offset:3072
ds_read_b128 v[132:135], v18 offset:4096
ds_read_b128 v[136:139], v18 offset:5120
ds_read_b128 v[140:143], v18 offset:6144
ds_read_b128 v[144:147], v18 offset:7168
ds_read_b128 v[148:151], v18 offset:16384
ds_read_b128 v[152:155], v18 offset:17408
s_waitcnt vmcnt(3)
v_cmp_eq_u32 vcc, -1, v39
s_cbranch_vccnz L_A_F0123
v_smfmac_f32_16x16x64_bf16 v[52:55], v[36:39], a[0:7], v3
v_smfmac_f32_16x16x64_bf16 v[56:59], v[36:39], a[8:15], v3
v_smfmac_f32_16x16x64_bf16 v[60:63], v[36:39], a[16:23], v3
s_waitcnt vmcnt(2)
v_cmp_eq_u32 vcc, -1, v43
v_smfmac_f32_16x16x64_bf16 v[64:67], v[36:39], a[24:31], v3
s_cbranch_vccnz L_A_F123
v_smfmac_f32_16x16x64_bf16 v[52:55], v[40:43], a[48:55], v3
v_smfmac_f32_16x16x64_bf16 v[56:59], v[40:43], a[56:63], v3
v_smfmac_f32_16x16x64_bf16 v[60:63], v[40:43], a[64:71], v3
s_waitcnt vmcnt(1)
v_cmp_eq_u32 vcc, -1, v47
v_smfmac_f32_16x16x64_bf16 v[64:67], v[40:43], a[72:79], v3
s_cbranch_vccnz L_A_F23
v_smfmac_f32_16x16x64_bf16 v[52:55], v[44:47], a[96:103], v3
v_smfmac_f32_16x16x64_bf16 v[56:59], v[44:47], a[104:111], v3
v_smfmac_f32_16x16x64_bf16 v[60:63], v[44:47], a[112:119], v3
s_waitcnt vmcnt(0)
v_cmp_eq_u32 vcc, -1, v51
v_smfmac_f32_16x16x64_bf16 v[64:67], v[44:47], a[120:127], v3
s_cbranch_vccnz L_A_F3
v_smfmac_f32_16x16x64_bf16 v[52:55], v[48:51], a[144:151], v3
v_smfmac_f32_16x16x64_bf16 v[56:59], v[48:51], a[152:159], v3
v_smfmac_f32_16x16x64_bf16 v[60:63], v[48:51], a[160:167], v3
v_smfmac_f32_16x16x64_bf16 v[64:67], v[48:51], a[168:175], v3
L_w2A_done:
v_add_f32 v156, v52, v53
v_add_f32 v158, v54, v55
v_add_f32 v157, v56, v57
v_add_f32 v159, v58, v59
ds_write_b128 v6, v[156:159] offset:0
v_add_f32 v244, v60, v61
v_add_f32 v246, v62, v63
    s_nop 0
v_add_f32 v245, v64, v65
v_add_f32 v247, v66, v67
ds_write_b128 v6, v[244:247] offset:4096
v_cmp_u_f32 vcc, v156, v158
s_cbranch_vccnz L_A_redo
L_w2A_ok:
v_smfmac_f32_16x16x64_bf16 v[68:71], v[36:39], a[32:39], v3
v_smfmac_f32_16x16x64_bf16 v[72:75], v[36:39], a[40:47], v3
s_waitcnt lgkmcnt(0)
s_barrier
s_cmp_eq_u32 s12, 2
s_cbranch_scc0 L_w23_nok
ds_read_b64 v[192:193], v7 offset:4096
ds_read_b64 v[194:195], v7 offset:5120
ds_read_b64 v[196:197], v7 offset:7168
s_cmp_eq_u32 s14, 0
s_waitcnt lgkmcnt(2)
v_pk_add_f32 v[192:193], v[192:193], v[244:245]
s_waitcnt lgkmcnt(1)
v_pk_add_f32 v[192:193], v[192:193], v[194:195]
s_waitcnt lgkmcnt(0)
v_pk_add_f32 v[192:193], v[192:193], v[196:197]
v_cvt_pk_bf16_f32 v192, v192, v193
s_cbranch_scc1 L_pub_8_s
buffer_store_dword v192, v8, s[4:7], s31 offen offset:0
L_pub_8_d:
s_branch L_w23_qd
L_w23_nok:
ds_read_b64 v[192:193], v7 offset:8
ds_read_b64 v[194:195], v7 offset:1032
ds_read_b64 v[196:197], v7 offset:2056
s_cmp_eq_u32 s14, 0
s_waitcnt lgkmcnt(2)
v_pk_add_f32 v[192:193], v[192:193], v[158:159]
s_waitcnt lgkmcnt(1)
v_pk_add_f32 v[192:193], v[192:193], v[194:195]
s_waitcnt lgkmcnt(0)
v_pk_add_f32 v[192:193], v[192:193], v[196:197]
v_cvt_pk_bf16_f32 v192, v192, v193
s_cbranch_scc1 L_pub_9_s
buffer_store_dword v192, v8, s[4:7], s31 offen offset:16
L_pub_9_d:
L_w23_qd:
v_smfmac_f32_16x16x64_bf16 v[68:71], v[40:43], a[80:87], v3
v_smfmac_f32_16x16x64_bf16 v[72:75], v[40:43], a[88:95], v3
v_smfmac_f32_16x16x64_bf16 v[68:71], v[44:47], a[128:135], v3
v_smfmac_f32_16x16x64_bf16 v[72:75], v[44:47], a[136:143], v3
v_smfmac_f32_16x16x64_bf16 v[68:71], v[48:51], a[176:183], v3
v_smfmac_f32_16x16x64_bf16 v[72:75], v[48:51], a[184:191], v3
s_cmp_eq_u32 s30, 63
s_cbranch_scc0 L_w23_noflag
s_mov_b64 exec, 1
buffer_store_dword v25, v21, s[4:7], 0 offen sc1
s_mov_b64 exec, -1
L_w23_noflag:
    s_nop 1
v_add_f32 v156, v68, v69
v_add_f32 v158, v70, v71
    s_nop 1
v_add_f32 v157, v72, v73
v_add_f32 v159, v74, v75
ds_write_b128 v6, v[156:159] offset:8192
s_waitcnt lgkmcnt(0)
s_barrier
ds_read_b128 v[192:195], v7 offset:8192
ds_read_b128 v[196:199], v7 offset:9216
ds_read_b128 v[200:203], v7 offset:10240
ds_read_b128 v[204:207], v7 offset:11264
s_cmp_eq_u32 s14, 0
s_waitcnt lgkmcnt(2)
v_add_f32 v192, v192, v196
v_add_f32 v193, v193, v197
v_add_f32 v194, v194, v198
v_add_f32 v195, v195, v199
s_waitcnt lgkmcnt(1)
v_add_f32 v192, v192, v200
v_add_f32 v193, v193, v201
v_add_f32 v194, v194, v202
v_add_f32 v195, v195, v203
s_waitcnt lgkmcnt(0)
v_add_f32 v192, v192, v204
v_add_f32 v193, v193, v205
v_add_f32 v194, v194, v206
v_add_f32 v195, v195, v207
v_cvt_pk_bf16_f32 v236, v192, v194
v_cvt_pk_bf16_f32 v240, v193, v195
v_add_u32 v227, 20480, v27
ds_write2_b32 v227, v236, v240 offset1:1
v_mfma_f32_16x16x32_bf16 v[160:163], v[116:119], v[84:87], 0
v_mov_b32 v52, 0
v_mov_b32 v53, 0
v_mov_b32 v54, 0
v_mfma_f32_16x16x32_bf16 v[164:167], v[120:123], v[84:87], 0
v_mov_b32 v55, 0
v_mov_b32 v56, 0
v_mov_b32 v57, 0
v_mfma_f32_16x16x32_bf16 v[160:163], v[124:127], v[88:91], v[160:163]
v_mov_b32 v58, 0
v_mov_b32 v59, 0
v_mov_b32 v60, 0
v_mfma_f32_16x16x32_bf16 v[164:167], v[128:131], v[88:91], v[164:167]
v_mov_b32 v61, 0
v_mov_b32 v62, 0
v_mov_b32 v63, 0
v_mfma_f32_16x16x32_bf16 v[160:163], v[132:135], v[92:95], v[160:163]
v_mov_b32 v64, 0
v_mov_b32 v65, 0
v_mov_b32 v66, 0
v_mfma_f32_16x16x32_bf16 v[164:167], v[136:139], v[92:95], v[164:167]
v_mov_b32 v67, 0
v_mov_b32 v68, 0
v_mov_b32 v69, 0
v_mfma_f32_16x16x32_bf16 v[160:163], v[140:143], v[96:99], v[160:163]
v_mov_b32 v70, 0
v_mov_b32 v71, 0
v_mov_b32 v72, 0
v_mfma_f32_16x16x32_bf16 v[164:167], v[144:147], v[96:99], v[164:167]
v_mov_b32 v73, 0
v_mov_b32 v74, 0
v_mov_b32 v75, 0
    s_nop 0
v_cndmask_b32 v160, v234, v160, s[50:51]
v_cndmask_b32 v161, v234, v161, s[52:53]
v_cndmask_b32 v162, v234, v162, s[54:55]
v_cndmask_b32 v163, v234, v163, s[56:57]
v_cndmask_b32 v164, v234, v164, s[58:59]
v_cndmask_b32 v165, v234, v165, s[60:61]
v_cndmask_b32 v166, v234, v166, s[62:63]
v_cndmask_b32 v167, v234, v167, s[64:65]
v_max3_f32 v26, v160, v161, v162
v_max3_f32 v26, v26, v163, v164
v_max3_f32 v26, v26, v165, v166
v_max_f32 v26, v26, v167
s_waitcnt lgkmcnt(0)
s_barrier
s_cmp_eq_u32 s30, 63
s_cbranch_scc1 L_w23_last
s_barrier
s_nop 15
s_nop 4
buffer_load_dwordx4 v[36:39], v5, s[4:7], s31 offen offset:0 sc1
s_nop 10
buffer_load_dwordx4 v[40:43], v5, s[4:7], s31 offen offset:1024 sc1
s_nop 10
buffer_load_dwordx4 v[44:47], v5, s[4:7], s31 offen offset:2048 sc1
s_nop 10
buffer_load_dwordx4 v[48:51], v5, s[4:7], s31 offen offset:3072 sc1
s_waitcnt vmcnt(3)
v_cmp_eq_u32 vcc, -1, v39
s_cbranch_vccnz L_C_F0123
v_smfmac_f32_16x16x64_bf16 v[76:79], v[36:39], a[192:199], v3
v_smfmac_f32_16x16x64_bf16 v[80:83], v[36:39], a[200:207], v3
s_waitcnt vmcnt(2)
v_cmp_eq_u32 vcc, -1, v43
s_cbranch_vccnz L_C_F123
v_smfmac_f32_16x16x64_bf16 v[76:79], v[40:43], a[208:215], v3
v_smfmac_f32_16x16x64_bf16 v[80:83], v[40:43], a[216:223], v3
s_waitcnt vmcnt(1)
v_cmp_eq_u32 vcc, -1, v47
s_cbranch_vccnz L_C_F23
v_smfmac_f32_16x16x64_bf16 v[76:79], v[44:47], a[224:231], v3
v_smfmac_f32_16x16x64_bf16 v[80:83], v[44:47], a[232:239], v3
s_waitcnt vmcnt(0)
v_cmp_eq_u32 vcc, -1, v51
s_cbranch_vccnz L_C_F3
v_smfmac_f32_16x16x64_bf16 v[76:79], v[48:51], a[240:247], v3
v_smfmac_f32_16x16x64_bf16 v[80:83], v[48:51], a[248:255], v3
L_w2C_done:
    s_nop 3
v_add_f32 v156, v76, v77
v_add_f32 v158, v78, v79
    s_nop 1
v_add_f32 v157, v80, v81
v_add_f32 v159, v82, v83
ds_write_b128 v6, v[156:159] offset:12288
v_cmp_u_f32 vcc, v156, v158
s_cbranch_vccnz L_C_redo
L_w2C_ok:
s_mov_b32 m0, s36
    s_nop 0
buffer_load_dwordx4 v15, s[4:7], s34 offen offset:0 sc1 lds
buffer_load_dwordx4 v15, s[4:7], s34 offen offset:1024 sc1 lds
buffer_load_dwordx4 v15, s[4:7], s34 offen offset:2048 sc1 lds
buffer_load_dwordx4 v15, s[4:7], s34 offen offset:3072 sc1 lds
s_waitcnt lgkmcnt(0)
s_barrier
s_mov_b32 m0, s37
    s_nop 0
buffer_load_dwordx4 v16, s[4:7], s34 offen offset:0 sc1 lds
buffer_load_dwordx4 v16, s[4:7], s34 offen offset:1024 sc1 lds
ds_read_b128 v[100:103], v7 offset:16384
ds_read_b128 v[104:107], v7 offset:17408
ds_read_b128 v[108:111], v7 offset:18432
ds_read_b128 v[112:115], v7 offset:19456
s_waitcnt lgkmcnt(3)
v_mfma_f32_16x16x32_bf16 v[168:171], v[100:103], v[84:87], 0
s_waitcnt lgkmcnt(2)
v_mfma_f32_16x16x32_bf16 v[168:171], v[104:107], v[88:91], v[168:171]
s_waitcnt lgkmcnt(1)
v_mfma_f32_16x16x32_bf16 v[168:171], v[108:111], v[92:95], v[168:171]
s_waitcnt lgkmcnt(0)
v_mfma_f32_16x16x32_bf16 v[168:171], v[112:115], v[96:99], v[168:171]
    s_nop 7
v_max3_f32 v26, v26, v168, v169
v_mov_b32 v224, v26
    s_nop 1
v_permlane16_swap_b32 v26, v224
v_max_f32 v26, v26, v224
v_mov_b32 v224, v26
    s_nop 1
v_permlane32_swap_b32 v26, v224
v_max_f32 v26, v26, v224
v_mul_f32 v26, s39, v26
v_fma_f32 v160, v160, s38, v26
v_fma_f32 v161, v161, s38, v26
v_fma_f32 v162, v162, s38, v26
v_fma_f32 v163, v163, s38, v26
v_fma_f32 v164, v164, s38, v26
v_fma_f32 v165, v165, s38, v26
v_fma_f32 v166, v166, s38, v26
v_fma_f32 v167, v167, s38, v26
v_fma_f32 v168, v168, s38, v26
v_fma_f32 v169, v169, s38, v26
v_exp_f32 v160, v160
v_exp_f32 v161, v161
v_exp_f32 v162, v162
v_exp_f32 v163, v163
v_exp_f32 v164, v164
v_exp_f32 v165, v165
v_exp_f32 v166, v166
v_exp_f32 v167, v167
v_exp_f32 v168, v168
v_exp_f32 v169, v169
v_cvt_pk_bf16_f32 v172, v160, v161
v_cvt_pk_bf16_f32 v173, v162, v163
v_cvt_pk_bf16_f32 v174, v164, v165
v_cvt_pk_bf16_f32 v175, v166, v167
v_cvt_pk_bf16_f32 v176, v168, v169
    s_nop 1
v_mfma_f32_16x16x32_bf16 v[180:183], v[28:31], v[176:179], 0
v_mfma_f32_16x16x32_bf16 v[180:183], v[28:31], v[172:175], v[180:183]
v_mfma_f32_16x16x32_bf16 v[184:187], v[148:151], v[172:175], 0
v_mfma_f32_16x16x32_bf16 v[184:187], v[236:239], v[176:179], v[184:187]
v_mfma_f32_16x16x32_bf16 v[188:191], v[152:155], v[172:175], 0
v_rcp_f32 v224, v180
v_mfma_f32_16x16x32_bf16 v[188:191], v[240:243], v[176:179], v[188:191]
v_pk_mul_f32 v[184:185], v[184:185], v[224:225] op_sel_hi:[1,0]
v_pk_mul_f32 v[186:187], v[186:187], v[224:225] op_sel_hi:[1,0]
v_cvt_pk_bf16_f32 v192, v184, v185
v_cvt_pk_bf16_f32 v193, v186, v187
    s_nop 3
v_pk_mul_f32 v[188:189], v[188:189], v[224:225] op_sel_hi:[1,0]
v_pk_mul_f32 v[190:191], v[190:191], v[224:225] op_sel_hi:[1,0]
v_cvt_pk_bf16_f32 v194, v188, v189
v_cvt_pk_bf16_f32 v195, v190, v191
buffer_store_dwordx4 v[192:195], v20, s[4:7], s43 offen sc1
v_mov_b32 v76, 0
v_mov_b32 v77, 0
v_mov_b32 v78, 0
v_mov_b32 v79, 0
v_mov_b32 v80, 0
v_mov_b32 v81, 0
v_mov_b32 v82, 0
v_mov_b32 v83, 0
s_and_b32 s18, s30, 3
s_add_u32 s18, s18, s12
s_cmp_eq_u32 s18, 5
s_cbranch_scc0 L_w3_nokv
s_cmp_eq_u32 s12, 3
s_cbranch_scc0 L_w3_nokv
s_cmp_eq_u32 s30, 62
s_cbranch_scc1 L_w3_nokv
s_add_u32 s18, s30, 2
s_lshl_b32 s18, s18, 7
L_kv_loop3:
buffer_load_dwordx4 v[244:247], v22, s[4:7], s18 offen sc1
s_waitcnt vmcnt(0)
v_max3_u32 v224, v244, v245, v246
v_cmp_eq_u32 vcc, -1, v224
s_cbranch_vccz L_kv_loop3_ok
s_sub_u32 s15, s15, 1
s_cbranch_scc1 L_exit
s_sleep 2
s_branch L_kv_loop3
L_kv_loop3_ok:
L_w3_nokv:
s_add_u32 s30, s30, 1
s_mov_b32 s31, s32
s_mov_b32 s32, s33
s_add_u32 s33, s33, 0x60000
s_cmp_eq_u32 s33, 0x8180000
s_cselect_b32 s33, 0x8000000, s33
s_xor_b32 s43, s34, 0
s_add_u32 s34, s34, 0x80000
s_and_b32 s18, s34, 0x180000
s_cselect_b32 s18, 0, 0x2000
s_xor_b32 s34, s34, s18
s_sub_u32 s36, s36, s35
s_sub_u32 s37, s37, s35
v_add_u32 v18, s35, v18
s_sub_u32 s35, 0, s35
s_waitcnt vmcnt(1)
s_branch L_w23
L_w23_last:
s_barrier
ds_read_b128 v[100:103], v7 offset:16384
ds_read_b128 v[104:107], v7 offset:17408
ds_read_b128 v[108:111], v7 offset:18432
ds_read_b128 v[112:115], v7 offset:19456
s_waitcnt lgkmcnt(3)
v_mfma_f32_16x16x32_bf16 v[168:171], v[100:103], v[84:87], 0
s_waitcnt lgkmcnt(2)
v_mfma_f32_16x16x32_bf16 v[168:171], v[104:107], v[88:91], v[168:171]
s_waitcnt lgkmcnt(1)
v_mfma_f32_16x16x32_bf16 v[168:171], v[108:111], v[92:95], v[168:171]
s_waitcnt lgkmcnt(0)
v_mfma_f32_16x16x32_bf16 v[168:171], v[112:115], v[96:99], v[168:171]
    s_nop 7
v_max3_f32 v26, v26, v168, v169
v_mov_b32 v224, v26
    s_nop 1
v_permlane16_swap_b32 v26, v224
v_max_f32 v26, v26, v224
v_mov_b32 v224, v26
    s_nop 1
v_permlane32_swap_b32 v26, v224
v_max_f32 v26, v26, v224
v_mul_f32 v26, s39, v26
v_fma_f32 v160, v160, s38, v26
v_fma_f32 v161, v161, s38, v26
v_fma_f32 v162, v162, s38, v26
v_fma_f32 v163, v163, s38, v26
v_fma_f32 v164, v164, s38, v26
v_fma_f32 v165, v165, s38, v26
v_fma_f32 v166, v166, s38, v26
v_fma_f32 v167, v167, s38, v26
v_fma_f32 v168, v168, s38, v26
v_fma_f32 v169, v169, s38, v26
v_exp_f32 v160, v160
v_exp_f32 v161, v161
v_exp_f32 v162, v162
v_exp_f32 v163, v163
v_exp_f32 v164, v164
v_exp_f32 v165, v165
v_exp_f32 v166, v166
v_exp_f32 v167, v167
v_exp_f32 v168, v168
v_exp_f32 v169, v169
v_cvt_pk_bf16_f32 v172, v160, v161
v_cvt_pk_bf16_f32 v173, v162, v163
v_cvt_pk_bf16_f32 v174, v164, v165
v_cvt_pk_bf16_f32 v175, v166, v167
v_cvt_pk_bf16_f32 v176, v168, v169
    s_nop 1
v_mfma_f32_16x16x32_bf16 v[180:183], v[28:31], v[176:179], 0
v_mfma_f32_16x16x32_bf16 v[180:183], v[28:31], v[172:175], v[180:183]
v_mfma_f32_16x16x32_bf16 v[184:187], v[148:151], v[172:175], 0
v_mfma_f32_16x16x32_bf16 v[184:187], v[236:239], v[176:179], v[184:187]
v_mfma_f32_16x16x32_bf16 v[188:191], v[152:155], v[172:175], 0
v_rcp_f32 v224, v180
v_mfma_f32_16x16x32_bf16 v[188:191], v[240:243], v[176:179], v[188:191]
v_pk_mul_f32 v[184:185], v[184:185], v[224:225] op_sel_hi:[1,0]
v_pk_mul_f32 v[186:187], v[186:187], v[224:225] op_sel_hi:[1,0]
v_cvt_pk_bf16_f32 v192, v184, v185
v_cvt_pk_bf16_f32 v193, v186, v187
    s_nop 3
v_pk_mul_f32 v[188:189], v[188:189], v[224:225] op_sel_hi:[1,0]
v_pk_mul_f32 v[190:191], v[190:191], v[224:225] op_sel_hi:[1,0]
v_cvt_pk_bf16_f32 v194, v188, v189
v_cvt_pk_bf16_f32 v195, v190, v191
buffer_store_dwordx4 v[192:195], v20, s[4:7], s43 offen sc1
s_waitcnt vmcnt(0)
s_mov_b32 s18, 0x10000
s_mov_b64 exec, 1
buffer_store_dword v25, v21, s[4:7], s18 offen sc1
s_mov_b64 exec, -1
s_branch L_exit
L_pub_8_s:
buffer_store_dword v192, v8, s[4:7], s31 offen offset:0 sc1
s_branch L_pub_8_d
L_pub_9_s:
buffer_store_dword v192, v8, s[4:7], s31 offen offset:16 sc1
s_branch L_pub_9_d
L_A_F0123:
buffer_load_dwordx4 v[36:39], v4, s[4:7], s31 offen offset:0 sc1
s_sub_u32 s15, s15, 1
s_cbranch_scc1 L_exit
s_waitcnt vmcnt(3)
v_cmp_eq_u32 vcc, -1, v43
s_cbranch_vccnz L_A_F1230
L_A_G1230:
v_smfmac_f32_16x16x64_bf16 v[52:55], v[40:43], a[48:55], v3
v_smfmac_f32_16x16x64_bf16 v[56:59], v[40:43], a[56:63], v3
v_smfmac_f32_16x16x64_bf16 v[60:63], v[40:43], a[64:71], v3
s_waitcnt vmcnt(2)
v_cmp_eq_u32 vcc, -1, v47
v_smfmac_f32_16x16x64_bf16 v[64:67], v[40:43], a[72:79], v3
s_cbranch_vccnz L_A_F230
L_A_G230:
v_smfmac_f32_16x16x64_bf16 v[52:55], v[44:47], a[96:103], v3
v_smfmac_f32_16x16x64_bf16 v[56:59], v[44:47], a[104:111], v3
v_smfmac_f32_16x16x64_bf16 v[60:63], v[44:47], a[112:119], v3
s_waitcnt vmcnt(1)
v_cmp_eq_u32 vcc, -1, v51
v_smfmac_f32_16x16x64_bf16 v[64:67], v[44:47], a[120:127], v3
s_cbranch_vccnz L_A_F30
L_A_G30:
v_smfmac_f32_16x16x64_bf16 v[52:55], v[48:51], a[144:151], v3
v_smfmac_f32_16x16x64_bf16 v[56:59], v[48:51], a[152:159], v3
v_smfmac_f32_16x16x64_bf16 v[60:63], v[48:51], a[160:167], v3
s_waitcnt vmcnt(0)
v_cmp_eq_u32 vcc, -1, v39
v_smfmac_f32_16x16x64_bf16 v[64:67], v[48:51], a[168:175], v3
s_cbranch_vccnz L_A_F0
L_A_G0:
v_smfmac_f32_16x16x64_bf16 v[52:55], v[36:39], a[0:7], v3
v_smfmac_f32_16x16x64_bf16 v[56:59], v[36:39], a[8:15], v3
v_smfmac_f32_16x16x64_bf16 v[60:63], v[36:39], a[16:23], v3
v_smfmac_f32_16x16x64_bf16 v[64:67], v[36:39], a[24:31], v3
s_cmp_eq_u32 s12, 1
s_cbranch_scc1 L_w1A_done
s_cmp_eq_u32 s12, 0
s_cbranch_scc1 L_w0A_done
s_branch L_w2A_done
L_A_F123:
buffer_load_dwordx4 v[40:43], v4, s[4:7], s31 offen offset:1024 sc1
s_sub_u32 s15, s15, 1
s_cbranch_scc1 L_exit
s_waitcnt vmcnt(2)
v_cmp_eq_u32 vcc, -1, v47
s_cbranch_vccnz L_A_F231
L_A_G231:
v_smfmac_f32_16x16x64_bf16 v[52:55], v[44:47], a[96:103], v3
v_smfmac_f32_16x16x64_bf16 v[56:59], v[44:47], a[104:111], v3
v_smfmac_f32_16x16x64_bf16 v[60:63], v[44:47], a[112:119], v3
s_waitcnt vmcnt(1)
v_cmp_eq_u32 vcc, -1, v51
v_smfmac_f32_16x16x64_bf16 v[64:67], v[44:47], a[120:127], v3
s_cbranch_vccnz L_A_F31
L_A_G31:
v_smfmac_f32_16x16x64_bf16 v[52:55], v[48:51], a[144:151], v3
v_smfmac_f32_16x16x64_bf16 v[56:59], v[48:51], a[152:159], v3
v_smfmac_f32_16x16x64_bf16 v[60:63], v[48:51], a[160:167], v3
s_waitcnt vmcnt(0)
v_cmp_eq_u32 vcc, -1, v43
v_smfmac_f32_16x16x64_bf16 v[64:67], v[48:51], a[168:175], v3
s_cbranch_vccnz L_A_F1
L_A_G1:
v_smfmac_f32_16x16x64_bf16 v[52:55], v[40:43], a[48:55], v3
v_smfmac_f32_16x16x64_bf16 v[56:59], v[40:43], a[56:63], v3
v_smfmac_f32_16x16x64_bf16 v[60:63], v[40:43], a[64:71], v3
v_smfmac_f32_16x16x64_bf16 v[64:67], v[40:43], a[72:79], v3
s_cmp_eq_u32 s12, 1
s_cbranch_scc1 L_w1A_done
s_cmp_eq_u32 s12, 0
s_cbranch_scc1 L_w0A_done
s_branch L_w2A_done
L_A_F23:
buffer_load_dwordx4 v[44:47], v4, s[4:7], s31 offen offset:2048 sc1
s_sub_u32 s15, s15, 1
s_cbranch_scc1 L_exit
s_waitcnt vmcnt(1)
v_cmp_eq_u32 vcc, -1, v51
s_cbranch_vccnz L_A_F32
L_A_G32:
v_smfmac_f32_16x16x64_bf16 v[52:55], v[48:51], a[144:151], v3
v_smfmac_f32_16x16x64_bf16 v[56:59], v[48:51], a[152:159], v3
v_smfmac_f32_16x16x64_bf16 v[60:63], v[48:51], a[160:167], v3
s_waitcnt vmcnt(0)
v_cmp_eq_u32 vcc, -1, v47
v_smfmac_f32_16x16x64_bf16 v[64:67], v[48:51], a[168:175], v3
s_cbranch_vccnz L_A_F2
L_A_G2:
v_smfmac_f32_16x16x64_bf16 v[52:55], v[44:47], a[96:103], v3
v_smfmac_f32_16x16x64_bf16 v[56:59], v[44:47], a[104:111], v3
v_smfmac_f32_16x16x64_bf16 v[60:63], v[44:47], a[112:119], v3
v_smfmac_f32_16x16x64_bf16 v[64:67], v[44:47], a[120:127], v3
s_cmp_eq_u32 s12, 1
s_cbranch_scc1 L_w1A_done
s_cmp_eq_u32 s12, 0
s_cbranch_scc1 L_w0A_done
s_branch L_w2A_done
L_A_F3:
buffer_load_dwordx4 v[48:51], v4, s[4:7], s31 offen offset:3072 sc1
s_nop 14
L_A_L3:
buffer_load_dwordx4 v[48:51], v4, s[4:7], s31 offen offset:3072 sc1
s_sub_u32 s15, s15, 1
s_cbranch_scc1 L_exit
s_waitcnt vmcnt(1)
v_cmp_eq_u32 vcc, -1, v51
s_cbranch_vccnz L_A_L3
L_A_G3:
v_smfmac_f32_16x16x64_bf16 v[52:55], v[48:51], a[144:151], v3
v_smfmac_f32_16x16x64_bf16 v[56:59], v[48:51], a[152:159], v3
v_smfmac_f32_16x16x64_bf16 v[60:63], v[48:51], a[160:167], v3
v_smfmac_f32_16x16x64_bf16 v[64:67], v[48:51], a[168:175], v3
s_cmp_eq_u32 s12, 1
s_cbranch_scc1 L_w1A_done
s_cmp_eq_u32 s12, 0
s_cbranch_scc1 L_w0A_done
s_branch L_w2A_done
L_A_F1230:
buffer_load_dwordx4 v[40:43], v4, s[4:7], s31 offen offset:1024 sc1
s_waitcnt vmcnt(3)
v_cmp_eq_u32 vcc, -1, v47
s_cbranch_vccnz L_A_F2301
L_A_G2301:
v_smfmac_f32_16x16x64_bf16 v[52:55], v[44:47], a[96:103], v3
v_smfmac_f32_16x16x64_bf16 v[56:59], v[44:47], a[104:111], v3
v_smfmac_f32_16x16x64_bf16 v[60:63], v[44:47], a[112:119], v3
s_waitcnt vmcnt(2)
v_cmp_eq_u32 vcc, -1, v51
v_smfmac_f32_16x16x64_bf16 v[64:67], v[44:47], a[120:127], v3
s_cbranch_vccnz L_A_F301
L_A_G301:
v_smfmac_f32_16x16x64_bf16 v[52:55], v[48:51], a[144:151], v3
v_smfmac_f32_16x16x64_bf16 v[56:59], v[48:51], a[152:159], v3
v_smfmac_f32_16x16x64_bf16 v[60:63], v[48:51], a[160:167], v3
s_waitcnt vmcnt(1)
v_cmp_eq_u32 vcc, -1, v39
v_smfmac_f32_16x16x64_bf16 v[64:67], v[48:51], a[168:175], v3
s_cbranch_vccnz L_A_F01
L_A_G01:
v_smfmac_f32_16x16x64_bf16 v[52:55], v[36:39], a[0:7], v3
v_smfmac_f32_16x16x64_bf16 v[56:59], v[36:39], a[8:15], v3
v_smfmac_f32_16x16x64_bf16 v[60:63], v[36:39], a[16:23], v3
s_waitcnt vmcnt(0)
v_cmp_eq_u32 vcc, -1, v43
v_smfmac_f32_16x16x64_bf16 v[64:67], v[36:39], a[24:31], v3
s_cbranch_vccnz L_A_F1
s_branch L_A_G1
L_A_F230:
buffer_load_dwordx4 v[44:47], v4, s[4:7], s31 offen offset:2048 sc1
s_waitcnt vmcnt(2)
v_cmp_eq_u32 vcc, -1, v51
s_cbranch_vccnz L_A_F302
L_A_G302:
v_smfmac_f32_16x16x64_bf16 v[52:55], v[48:51], a[144:151], v3
v_smfmac_f32_16x16x64_bf16 v[56:59], v[48:51], a[152:159], v3
v_smfmac_f32_16x16x64_bf16 v[60:63], v[48:51], a[160:167], v3
s_waitcnt vmcnt(1)
v_cmp_eq_u32 vcc, -1, v39
v_smfmac_f32_16x16x64_bf16 v[64:67], v[48:51], a[168:175], v3
s_cbranch_vccnz L_A_F02
L_A_G02:
v_smfmac_f32_16x16x64_bf16 v[52:55], v[36:39], a[0:7], v3
v_smfmac_f32_16x16x64_bf16 v[56:59], v[36:39], a[8:15], v3
v_smfmac_f32_16x16x64_bf16 v[60:63], v[36:39], a[16:23], v3
s_waitcnt vmcnt(0)
v_cmp_eq_u32 vcc, -1, v47
v_smfmac_f32_16x16x64_bf16 v[64:67], v[36:39], a[24:31], v3
s_cbranch_vccnz L_A_F2
s_branch L_A_G2
L_A_F30:
buffer_load_dwordx4 v[48:51], v4, s[4:7], s31 offen offset:3072 sc1
s_waitcnt vmcnt(1)
v_cmp_eq_u32 vcc, -1, v39
s_cbranch_vccnz L_A_F03
L_A_G03:
v_smfmac_f32_16x16x64_bf16 v[52:55], v[36:39], a[0:7], v3
v_smfmac_f32_16x16x64_bf16 v[56:59], v[36:39], a[8:15], v3
v_smfmac_f32_16x16x64_bf16 v[60:63], v[36:39], a[16:23], v3
s_waitcnt vmcnt(0)
v_cmp_eq_u32 vcc, -1, v51
v_smfmac_f32_16x16x64_bf16 v[64:67], v[36:39], a[24:31], v3
s_cbranch_vccnz L_A_F3
s_branch L_A_G3
L_A_F0:
buffer_load_dwordx4 v[36:39], v4, s[4:7], s31 offen offset:0 sc1
s_nop 14
L_A_L0:
buffer_load_dwordx4 v[36:39], v4, s[4:7], s31 offen offset:0 sc1
s_sub_u32 s15, s15, 1
s_cbranch_scc1 L_exit
s_waitcnt vmcnt(1)
v_cmp_eq_u32 vcc, -1, v39
s_cbranch_vccnz L_A_L0
s_branch L_A_G0
L_A_F231:
buffer_load_dwordx4 v[44:47], v4, s[4:7], s31 offen offset:2048 sc1
s_waitcnt vmcnt(2)
v_cmp_eq_u32 vcc, -1, v51
s_cbranch_vccnz L_A_F312
L_A_G312:
v_smfmac_f32_16x16x64_bf16 v[52:55], v[48:51], a[144:151], v3
v_smfmac_f32_16x16x64_bf16 v[56:59], v[48:51], a[152:159], v3
v_smfmac_f32_16x16x64_bf16 v[60:63], v[48:51], a[160:167], v3
s_waitcnt vmcnt(1)
v_cmp_eq_u32 vcc, -1, v43
v_smfmac_f32_16x16x64_bf16 v[64:67], v[48:51], a[168:175], v3
s_cbranch_vccnz L_A_F12
L_A_G12:
v_smfmac_f32_16x16x64_bf16 v[52:55], v[40:43], a[48:55], v3
v_smfmac_f32_16x16x64_bf16 v[56:59], v[40:43], a[56:63], v3
v_smfmac_f32_16x16x64_bf16 v[60:63], v[40:43], a[64:71], v3
s_waitcnt vmcnt(0)
v_cmp_eq_u32 vcc, -1, v47
v_smfmac_f32_16x16x64_bf16 v[64:67], v[40:43], a[72:79], v3
s_cbranch_vccnz L_A_F2
s_branch L_A_G2
L_A_F31:
buffer_load_dwordx4 v[48:51], v4, s[4:7], s31 offen offset:3072 sc1
s_waitcnt vmcnt(1)
v_cmp_eq_u32 vcc, -1, v43
s_cbranch_vccnz L_A_F13
L_A_G13:
v_smfmac_f32_16x16x64_bf16 v[52:55], v[40:43], a[48:55], v3
v_smfmac_f32_16x16x64_bf16 v[56:59], v[40:43], a[56:63], v3
v_smfmac_f32_16x16x64_bf16 v[60:63], v[40:43], a[64:71], v3
s_waitcnt vmcnt(0)
v_cmp_eq_u32 vcc, -1, v51
v_smfmac_f32_16x16x64_bf16 v[64:67], v[40:43], a[72:79], v3
s_cbranch_vccnz L_A_F3
s_branch L_A_G3
L_A_F1:
buffer_load_dwordx4 v[40:43], v4, s[4:7], s31 offen offset:1024 sc1
s_nop 14
L_A_L1:
buffer_load_dwordx4 v[40:43], v4, s[4:7], s31 offen offset:1024 sc1
s_sub_u32 s15, s15, 1
s_cbranch_scc1 L_exit
s_waitcnt vmcnt(1)
v_cmp_eq_u32 vcc, -1, v43
s_cbranch_vccnz L_A_L1
s_branch L_A_G1
L_A_F32:
buffer_load_dwordx4 v[48:51], v4, s[4:7], s31 offen offset:3072 sc1
s_waitcnt vmcnt(1)
v_cmp_eq_u32 vcc, -1, v47
s_cbranch_vccnz L_A_F23
L_A_G23:
v_smfmac_f32_16x16x64_bf16 v[52:55], v[44:47], a[96:103], v3
v_smfmac_f32_16x16x64_bf16 v[56:59], v[44:47], a[104:111], v3
v_smfmac_f32_16x16x64_bf16 v[60:63], v[44:47], a[112:119], v3
s_waitcnt vmcnt(0)
v_cmp_eq_u32 vcc, -1, v51
v_smfmac_f32_16x16x64_bf16 v[64:67], v[44:47], a[120:127], v3
s_cbranch_vccnz L_A_F3
s_branch L_A_G3
L_A_F2:
buffer_load_dwordx4 v[44:47], v4, s[4:7], s31 offen offset:2048 sc1
s_nop 14
L_A_L2:
buffer_load_dwordx4 v[44:47], v4, s[4:7], s31 offen offset:2048 sc1
s_sub_u32 s15, s15, 1
s_cbranch_scc1 L_exit
s_waitcnt vmcnt(1)
v_cmp_eq_u32 vcc, -1, v47
s_cbranch_vccnz L_A_L2
s_branch L_A_G2
L_A_F2301:
buffer_load_dwordx4 v[44:47], v4, s[4:7], s31 offen offset:2048 sc1
s_waitcnt vmcnt(3)
v_cmp_eq_u32 vcc, -1, v51
s_cbranch_vccnz L_A_F3012
L_A_G3012:
v_smfmac_f32_16x16x64_bf16 v[52:55], v[48:51], a[144:151], v3
v_smfmac_f32_16x16x64_bf16 v[56:59], v[48:51], a[152:159], v3
v_smfmac_f32_16x16x64_bf16 v[60:63], v[48:51], a[160:167], v3
s_waitcnt vmcnt(2)
v_cmp_eq_u32 vcc, -1, v39
v_smfmac_f32_16x16x64_bf16 v[64:67], v[48:51], a[168:175], v3
s_cbranch_vccnz L_A_F012
L_A_G012:
v_smfmac_f32_16x16x64_bf16 v[52:55], v[36:39], a[0:7], v3
v_smfmac_f32_16x16x64_bf16 v[56:59], v[36:39], a[8:15], v3
v_smfmac_f32_16x16x64_bf16 v[60:63], v[36:39], a[16:23], v3
s_waitcnt vmcnt(1)
v_cmp_eq_u32 vcc, -1, v43
v_smfmac_f32_16x16x64_bf16 v[64:67], v[36:39], a[24:31], v3
s_cbranch_vccnz L_A_F12
s_branch L_A_G12
L_A_F301:
buffer_load_dwordx4 v[48:51], v4, s[4:7], s31 offen offset:3072 sc1
s_waitcnt vmcnt(2)
v_cmp_eq_u32 vcc, -1, v39
s_cbranch_vccnz L_A_F013
L_A_G013:
v_smfmac_f32_16x16x64_bf16 v[52:55], v[36:39], a[0:7], v3
v_smfmac_f32_16x16x64_bf16 v[56:59], v[36:39], a[8:15], v3
v_smfmac_f32_16x16x64_bf16 v[60:63], v[36:39], a[16:23], v3
s_waitcnt vmcnt(1)
v_cmp_eq_u32 vcc, -1, v43
v_smfmac_f32_16x16x64_bf16 v[64:67], v[36:39], a[24:31], v3
s_cbranch_vccnz L_A_F13
s_branch L_A_G13
L_A_F01:
buffer_load_dwordx4 v[36:39], v4, s[4:7], s31 offen offset:0 sc1
s_sub_u32 s15, s15, 1
s_cbranch_scc1 L_exit
s_waitcnt vmcnt(1)
v_cmp_eq_u32 vcc, -1, v43
s_cbranch_vccnz L_A_F10
L_A_G10:
v_smfmac_f32_16x16x64_bf16 v[52:55], v[40:43], a[48:55], v3
v_smfmac_f32_16x16x64_bf16 v[56:59], v[40:43], a[56:63], v3
v_smfmac_f32_16x16x64_bf16 v[60:63], v[40:43], a[64:71], v3
s_waitcnt vmcnt(0)
v_cmp_eq_u32 vcc, -1, v39
v_smfmac_f32_16x16x64_bf16 v[64:67], v[40:43], a[72:79], v3
s_cbranch_vccnz L_A_F0
s_branch L_A_G0
L_A_F302:
buffer_load_dwordx4 v[48:51], v4, s[4:7], s31 offen offset:3072 sc1
s_waitcnt vmcnt(2)
v_cmp_eq_u32 vcc, -1, v39
s_cbranch_vccnz L_A_F023
L_A_G023:
v_smfmac_f32_16x16x64_bf16 v[52:55], v[36:39], a[0:7], v3
v_smfmac_f32_16x16x64_bf16 v[56:59], v[36:39], a[8:15], v3
v_smfmac_f32_16x16x64_bf16 v[60:63], v[36:39], a[16:23], v3
s_waitcnt vmcnt(1)
v_cmp_eq_u32 vcc, -1, v47
v_smfmac_f32_16x16x64_bf16 v[64:67], v[36:39], a[24:31], v3
s_cbranch_vccnz L_A_F23
s_branch L_A_G23
L_A_F02:
buffer_load_dwordx4 v[36:39], v4, s[4:7], s31 offen offset:0 sc1
s_sub_u32 s15, s15, 1
s_cbranch_scc1 L_exit
s_waitcnt vmcnt(1)
v_cmp_eq_u32 vcc, -1, v47
s_cbranch_vccnz L_A_F20
L_A_G20:
v_smfmac_f32_16x16x64_bf16 v[52:55], v[44:47], a[96:103], v3
v_smfmac_f32_16x16x64_bf16 v[56:59], v[44:47], a[104:111], v3
v_smfmac_f32_16x16x64_bf16 v[60:63], v[44:47], a[112:119], v3
s_waitcnt vmcnt(0)
v_cmp_eq_u32 vcc, -1, v39
v_smfmac_f32_16x16x64_bf16 v[64:67], v[44:47], a[120:127], v3
s_cbranch_vccnz L_A_F0
s_branch L_A_G0
L_A_F03:
buffer_load_dwordx4 v[36:39], v4, s[4:7], s31 offen offset:0 sc1
s_sub_u32 s15, s15, 1
s_cbranch_scc1 L_exit
s_waitcnt vmcnt(1)
v_cmp_eq_u32 vcc, -1, v51
s_cbranch_vccnz L_A_F30
s_branch L_A_G30
L_A_F312:
buffer_load_dwordx4 v[48:51], v4, s[4:7], s31 offen offset:3072 sc1
s_waitcnt vmcnt(2)
v_cmp_eq_u32 vcc, -1, v43
s_cbranch_vccnz L_A_F123
L_A_G123:
v_smfmac_f32_16x16x64_bf16 v[52:55], v[40:43], a[48:55], v3
v_smfmac_f32_16x16x64_bf16 v[56:59], v[40:43], a[56:63], v3
v_smfmac_f32_16x16x64_bf16 v[60:63], v[40:43], a[64:71], v3
s_waitcnt vmcnt(1)
v_cmp_eq_u32 vcc, -1, v47
v_smfmac_f32_16x16x64_bf16 v[64:67], v[40:43], a[72:79], v3
s_cbranch_vccnz L_A_F23
s_branch L_A_G23
L_A_F12:
buffer_load_dwordx4 v[40:43], v4, s[4:7], s31 offen offset:1024 sc1
s_sub_u32 s15, s15, 1
s_cbranch_scc1 L_exit
s_waitcnt vmcnt(1)
v_cmp_eq_u32 vcc, -1, v47
s_cbranch_vccnz L_A_F21
L_A_G21:
v_smfmac_f32_16x16x64_bf16 v[52:55], v[44:47], a[96:103], v3
v_smfmac_f32_16x16x64_bf16 v[56:59], v[44:47], a[104:111], v3
v_smfmac_f32_16x16x64_bf16 v[60:63], v[44:47], a[112:119], v3
s_waitcnt vmcnt(0)
v_cmp_eq_u32 vcc, -1, v43
v_smfmac_f32_16x16x64_bf16 v[64:67], v[44:47], a[120:127], v3
s_cbranch_vccnz L_A_F1
s_branch L_A_G1
L_A_F13:
buffer_load_dwordx4 v[40:43], v4, s[4:7], s31 offen offset:1024 sc1
s_sub_u32 s15, s15, 1
s_cbranch_scc1 L_exit
s_waitcnt vmcnt(1)
v_cmp_eq_u32 vcc, -1, v51
s_cbranch_vccnz L_A_F31
s_branch L_A_G31
L_A_F3012:
buffer_load_dwordx4 v[48:51], v4, s[4:7], s31 offen offset:3072 sc1
s_waitcnt vmcnt(3)
v_cmp_eq_u32 vcc, -1, v39
s_cbranch_vccnz L_A_F0123
L_A_G0123:
v_smfmac_f32_16x16x64_bf16 v[52:55], v[36:39], a[0:7], v3
v_smfmac_f32_16x16x64_bf16 v[56:59], v[36:39], a[8:15], v3
v_smfmac_f32_16x16x64_bf16 v[60:63], v[36:39], a[16:23], v3
s_waitcnt vmcnt(2)
v_cmp_eq_u32 vcc, -1, v43
v_smfmac_f32_16x16x64_bf16 v[64:67], v[36:39], a[24:31], v3
s_cbranch_vccnz L_A_F123
s_branch L_A_G123
L_A_F012:
buffer_load_dwordx4 v[36:39], v4, s[4:7], s31 offen offset:0 sc1
s_sub_u32 s15, s15, 1
s_cbranch_scc1 L_exit
s_waitcnt vmcnt(2)
v_cmp_eq_u32 vcc, -1, v43
s_cbranch_vccnz L_A_F120
L_A_G120:
v_smfmac_f32_16x16x64_bf16 v[52:55], v[40:43], a[48:55], v3
v_smfmac_f32_16x16x64_bf16 v[56:59], v[40:43], a[56:63], v3
v_smfmac_f32_16x16x64_bf16 v[60:63], v[40:43], a[64:71], v3
s_waitcnt vmcnt(1)
v_cmp_eq_u32 vcc, -1, v47
v_smfmac_f32_16x16x64_bf16 v[64:67], v[40:43], a[72:79], v3
s_cbranch_vccnz L_A_F20
s_branch L_A_G20
L_A_F013:
buffer_load_dwordx4 v[36:39], v4, s[4:7], s31 offen offset:0 sc1
s_sub_u32 s15, s15, 1
s_cbranch_scc1 L_exit
s_waitcnt vmcnt(2)
v_cmp_eq_u32 vcc, -1, v43
s_cbranch_vccnz L_A_F130
L_A_G130:
v_smfmac_f32_16x16x64_bf16 v[52:55], v[40:43], a[48:55], v3
v_smfmac_f32_16x16x64_bf16 v[56:59], v[40:43], a[56:63], v3
v_smfmac_f32_16x16x64_bf16 v[60:63], v[40:43], a[64:71], v3
s_waitcnt vmcnt(1)
v_cmp_eq_u32 vcc, -1, v51
v_smfmac_f32_16x16x64_bf16 v[64:67], v[40:43], a[72:79], v3
s_cbranch_vccnz L_A_F30
s_branch L_A_G30
L_A_F10:
buffer_load_dwordx4 v[40:43], v4, s[4:7], s31 offen offset:1024 sc1
s_waitcnt vmcnt(1)
v_cmp_eq_u32 vcc, -1, v39
s_cbranch_vccnz L_A_F01
s_branch L_A_G01
L_A_F023:
buffer_load_dwordx4 v[36:39], v4, s[4:7], s31 offen offset:0 sc1
s_sub_u32 s15, s15, 1
s_cbranch_scc1 L_exit
s_waitcnt vmcnt(2)
v_cmp_eq_u32 vcc, -1, v47
s_cbranch_vccnz L_A_F230
s_branch L_A_G230
L_A_F20:
buffer_load_dwordx4 v[44:47], v4, s[4:7], s31 offen offset:2048 sc1
s_waitcnt vmcnt(1)
v_cmp_eq_u32 vcc, -1, v39
s_cbranch_vccnz L_A_F02
s_branch L_A_G02
L_A_F21:
buffer_load_dwordx4 v[44:47], v4, s[4:7], s31 offen offset:2048 sc1
s_waitcnt vmcnt(1)
v_cmp_eq_u32 vcc, -1, v43
s_cbranch_vccnz L_A_F12
s_branch L_A_G12
L_A_F120:
buffer_load_dwordx4 v[40:43], v4, s[4:7], s31 offen offset:1024 sc1
s_waitcnt vmcnt(2)
v_cmp_eq_u32 vcc, -1, v47
s_cbranch_vccnz L_A_F201
L_A_G201:
v_smfmac_f32_16x16x64_bf16 v[52:55], v[44:47], a[96:103], v3
v_smfmac_f32_16x16x64_bf16 v[56:59], v[44:47], a[104:111], v3
v_smfmac_f32_16x16x64_bf16 v[60:63], v[44:47], a[112:119], v3
s_waitcnt vmcnt(1)
v_cmp_eq_u32 vcc, -1, v39
v_smfmac_f32_16x16x64_bf16 v[64:67], v[44:47], a[120:127], v3
s_cbranch_vccnz L_A_F01
s_branch L_A_G01
L_A_F130:
buffer_load_dwordx4 v[40:43], v4, s[4:7], s31 offen offset:1024 sc1
s_waitcnt vmcnt(2)
v_cmp_eq_u32 vcc, -1, v51
s_cbranch_vccnz L_A_F301
s_branch L_A_G301
L_A_F201:
buffer_load_dwordx4 v[44:47], v4, s[4:7], s31 offen offset:2048 sc1
s_waitcnt vmcnt(2)
v_cmp_eq_u32 vcc, -1, v39
s_cbranch_vccnz L_A_F012
s_branch L_A_G012
L_A_redo:
buffer_load_dwordx4 v[36:39], v4, s[4:7], s31 offen offset:0 sc1
buffer_load_dwordx4 v[40:43], v4, s[4:7], s31 offen offset:1024 sc1
buffer_load_dwordx4 v[44:47], v4, s[4:7], s31 offen offset:2048 sc1
buffer_load_dwordx4 v[48:51], v4, s[4:7], s31 offen offset:3072 sc1
s_sub_u32 s15, s15, 1
s_cbranch_scc1 L_exit
s_waitcnt vmcnt(0)
v_max3_u32 v224, v36, v37, v38
v_max_u32 v224, v224, v39
v_max3_u32 v224, v224, v40, v41
v_max3_u32 v224, v224, v42, v43
v_max3_u32 v224, v224, v44, v45
v_max3_u32 v224, v224, v46, v47
v_max3_u32 v224, v224, v48, v49
v_max3_u32 v224, v224, v50, v51
v_cmp_eq_u32 vcc, -1, v224
s_cbranch_vccnz L_A_redo
v_mov_b32 v52, 0
v_mov_b32 v53, 0
v_mov_b32 v54, 0
v_mov_b32 v55, 0
v_mov_b32 v56, 0
v_mov_b32 v57, 0
v_mov_b32 v58, 0
v_mov_b32 v59, 0
v_mov_b32 v60, 0
v_mov_b32 v61, 0
v_mov_b32 v62, 0
v_mov_b32 v63, 0
v_mov_b32 v64, 0
v_mov_b32 v65, 0
v_mov_b32 v66, 0
v_mov_b32 v67, 0
v_smfmac_f32_16x16x64_bf16 v[52:55], v[36:39], a[0:7], v3
v_smfmac_f32_16x16x64_bf16 v[56:59], v[36:39], a[8:15], v3
v_smfmac_f32_16x16x64_bf16 v[60:63], v[36:39], a[16:23], v3
v_smfmac_f32_16x16x64_bf16 v[64:67], v[36:39], a[24:31], v3
v_smfmac_f32_16x16x64_bf16 v[52:55], v[40:43], a[48:55], v3
v_smfmac_f32_16x16x64_bf16 v[56:59], v[40:43], a[56:63], v3
v_smfmac_f32_16x16x64_bf16 v[60:63], v[40:43], a[64:71], v3
v_smfmac_f32_16x16x64_bf16 v[64:67], v[40:43], a[72:79], v3
v_smfmac_f32_16x16x64_bf16 v[52:55], v[44:47], a[96:103], v3
v_smfmac_f32_16x16x64_bf16 v[56:59], v[44:47], a[104:111], v3
v_smfmac_f32_16x16x64_bf16 v[60:63], v[44:47], a[112:119], v3
v_smfmac_f32_16x16x64_bf16 v[64:67], v[44:47], a[120:127], v3
v_smfmac_f32_16x16x64_bf16 v[52:55], v[48:51], a[144:151], v3
v_smfmac_f32_16x16x64_bf16 v[56:59], v[48:51], a[152:159], v3
v_smfmac_f32_16x16x64_bf16 v[60:63], v[48:51], a[160:167], v3
v_smfmac_f32_16x16x64_bf16 v[64:67], v[48:51], a[168:175], v3
v_add_f32 v156, v52, v53
v_add_f32 v158, v54, v55
v_add_f32 v157, v56, v57
v_add_f32 v159, v58, v59
ds_write_b128 v6, v[156:159] offset:0
v_add_f32 v244, v60, v61
v_add_f32 v246, v62, v63
    s_nop 0
v_add_f32 v245, v64, v65
v_add_f32 v247, v66, v67
ds_write_b128 v6, v[244:247] offset:4096
s_cmp_eq_u32 s12, 1
s_cbranch_scc1 L_w1A_ok
s_cmp_eq_u32 s12, 0
s_cbranch_scc1 L_w0A_ok
s_branch L_w2A_ok
L_C_F0123:
buffer_load_dwordx4 v[36:39], v5, s[4:7], s31 offen offset:0 sc1
s_sub_u32 s15, s15, 1
s_cbranch_scc1 L_exit
s_waitcnt vmcnt(3)
v_cmp_eq_u32 vcc, -1, v43
s_cbranch_vccnz L_C_F1230
L_C_G1230:
v_smfmac_f32_16x16x64_bf16 v[76:79], v[40:43], a[208:215], v3
v_smfmac_f32_16x16x64_bf16 v[80:83], v[40:43], a[216:223], v3
s_waitcnt vmcnt(2)
v_cmp_eq_u32 vcc, -1, v47
s_cbranch_vccnz L_C_F230
L_C_G230:
v_smfmac_f32_16x16x64_bf16 v[76:79], v[44:47], a[224:231], v3
v_smfmac_f32_16x16x64_bf16 v[80:83], v[44:47], a[232:239], v3
s_waitcnt vmcnt(1)
v_cmp_eq_u32 vcc, -1, v51
s_cbranch_vccnz L_C_F30
L_C_G30:
v_smfmac_f32_16x16x64_bf16 v[76:79], v[48:51], a[240:247], v3
v_smfmac_f32_16x16x64_bf16 v[80:83], v[48:51], a[248:255], v3
s_waitcnt vmcnt(0)
v_cmp_eq_u32 vcc, -1, v39
s_cbranch_vccnz L_C_F0
L_C_G0:
v_smfmac_f32_16x16x64_bf16 v[76:79], v[36:39], a[192:199], v3
v_smfmac_f32_16x16x64_bf16 v[80:83], v[36:39], a[200:207], v3
s_cmp_eq_u32 s12, 1
s_cbranch_scc1 L_w1C_done
s_cmp_eq_u32 s12, 0
s_cbranch_scc1 L_w0C_done
s_branch L_w2C_done
L_C_F123:
buffer_load_dwordx4 v[40:43], v5, s[4:7], s31 offen offset:1024 sc1
s_sub_u32 s15, s15, 1
s_cbranch_scc1 L_exit
s_waitcnt vmcnt(2)
v_cmp_eq_u32 vcc, -1, v47
s_cbranch_vccnz L_C_F231
L_C_G231:
v_smfmac_f32_16x16x64_bf16 v[76:79], v[44:47], a[224:231], v3
v_smfmac_f32_16x16x64_bf16 v[80:83], v[44:47], a[232:239], v3
s_waitcnt vmcnt(1)
v_cmp_eq_u32 vcc, -1, v51
s_cbranch_vccnz L_C_F31
L_C_G31:
v_smfmac_f32_16x16x64_bf16 v[76:79], v[48:51], a[240:247], v3
v_smfmac_f32_16x16x64_bf16 v[80:83], v[48:51], a[248:255], v3
s_waitcnt vmcnt(0)
v_cmp_eq_u32 vcc, -1, v43
s_cbranch_vccnz L_C_F1
L_C_G1:
v_smfmac_f32_16x16x64_bf16 v[76:79], v[40:43], a[208:215], v3
v_smfmac_f32_16x16x64_bf16 v[80:83], v[40:43], a[216:223], v3
s_cmp_eq_u32 s12, 1
s_cbranch_scc1 L_w1C_done
s_cmp_eq_u32 s12, 0
s_cbranch_scc1 L_w0C_done
s_branch L_w2C_done
L_C_F23:
buffer_load_dwordx4 v[44:47], v5, s[4:7], s31 offen offset:2048 sc1
s_sub_u32 s15, s15, 1
s_cbranch_scc1 L_exit
s_waitcnt vmcnt(1)
v_cmp_eq_u32 vcc, -1, v51
s_cbranch_vccnz L_C_F32
L_C_G32:
v_smfmac_f32_16x16x64_bf16 v[76:79], v[48:51], a[240:247], v3
v_smfmac_f32_16x16x64_bf16 v[80:83], v[48:51], a[248:255], v3
s_waitcnt vmcnt(0)
v_cmp_eq_u32 vcc, -1, v47
s_cbranch_vccnz L_C_F2
L_C_G2:
v_smfmac_f32_16x16x64_bf16 v[76:79], v[44:47], a[224:231], v3
v_smfmac_f32_16x16x64_bf16 v[80:83], v[44:47], a[232:239], v3
s_cmp_eq_u32 s12, 1
s_cbranch_scc1 L_w1C_done
s_cmp_eq_u32 s12, 0
s_cbranch_scc1 L_w0C_done
s_branch L_w2C_done
L_C_F3:
buffer_load_dwordx4 v[48:51], v5, s[4:7], s31 offen offset:3072 sc1
s_nop 14
L_C_L3:
buffer_load_dwordx4 v[48:51], v5, s[4:7], s31 offen offset:3072 sc1
s_sub_u32 s15, s15, 1
s_cbranch_scc1 L_exit
s_waitcnt vmcnt(1)
v_cmp_eq_u32 vcc, -1, v51
s_cbranch_vccnz L_C_L3
L_C_G3:
v_smfmac_f32_16x16x64_bf16 v[76:79], v[48:51], a[240:247], v3
v_smfmac_f32_16x16x64_bf16 v[80:83], v[48:51], a[248:255], v3
s_cmp_eq_u32 s12, 1
s_cbranch_scc1 L_w1C_done
s_cmp_eq_u32 s12, 0
s_cbranch_scc1 L_w0C_done
s_branch L_w2C_done
L_C_F1230:
buffer_load_dwordx4 v[40:43], v5, s[4:7], s31 offen offset:1024 sc1
s_waitcnt vmcnt(3)
v_cmp_eq_u32 vcc, -1, v47
s_cbranch_vccnz L_C_F2301
L_C_G2301:
v_smfmac_f32_16x16x64_bf16 v[76:79], v[44:47], a[224:231], v3
v_smfmac_f32_16x16x64_bf16 v[80:83], v[44:47], a[232:239], v3
s_waitcnt vmcnt(2)
v_cmp_eq_u32 vcc, -1, v51
s_cbranch_vccnz L_C_F301
L_C_G301:
v_smfmac_f32_16x16x64_bf16 v[76:79], v[48:51], a[240:247], v3
v_smfmac_f32_16x16x64_bf16 v[80:83], v[48:51], a[248:255], v3
s_waitcnt vmcnt(1)
v_cmp_eq_u32 vcc, -1, v39
s_cbranch_vccnz L_C_F01
L_C_G01:
v_smfmac_f32_16x16x64_bf16 v[76:79], v[36:39], a[192:199], v3
v_smfmac_f32_16x16x64_bf16 v[80:83], v[36:39], a[200:207], v3
s_waitcnt vmcnt(0)
v_cmp_eq_u32 vcc, -1, v43
s_cbranch_vccnz L_C_F1
s_branch L_C_G1
L_C_F230:
buffer_load_dwordx4 v[44:47], v5, s[4:7], s31 offen offset:2048 sc1
s_waitcnt vmcnt(2)
v_cmp_eq_u32 vcc, -1, v51
s_cbranch_vccnz L_C_F302
L_C_G302:
v_smfmac_f32_16x16x64_bf16 v[76:79], v[48:51], a[240:247], v3
v_smfmac_f32_16x16x64_bf16 v[80:83], v[48:51], a[248:255], v3
s_waitcnt vmcnt(1)
v_cmp_eq_u32 vcc, -1, v39
s_cbranch_vccnz L_C_F02
L_C_G02:
v_smfmac_f32_16x16x64_bf16 v[76:79], v[36:39], a[192:199], v3
v_smfmac_f32_16x16x64_bf16 v[80:83], v[36:39], a[200:207], v3
s_waitcnt vmcnt(0)
v_cmp_eq_u32 vcc, -1, v47
s_cbranch_vccnz L_C_F2
s_branch L_C_G2
L_C_F30:
buffer_load_dwordx4 v[48:51], v5, s[4:7], s31 offen offset:3072 sc1
s_waitcnt vmcnt(1)
v_cmp_eq_u32 vcc, -1, v39
s_cbranch_vccnz L_C_F03
L_C_G03:
v_smfmac_f32_16x16x64_bf16 v[76:79], v[36:39], a[192:199], v3
v_smfmac_f32_16x16x64_bf16 v[80:83], v[36:39], a[200:207], v3
s_waitcnt vmcnt(0)
v_cmp_eq_u32 vcc, -1, v51
s_cbranch_vccnz L_C_F3
s_branch L_C_G3
L_C_F0:
buffer_load_dwordx4 v[36:39], v5, s[4:7], s31 offen offset:0 sc1
s_nop 14
L_C_L0:
buffer_load_dwordx4 v[36:39], v5, s[4:7], s31 offen offset:0 sc1
s_sub_u32 s15, s15, 1
s_cbranch_scc1 L_exit
s_waitcnt vmcnt(1)
v_cmp_eq_u32 vcc, -1, v39
s_cbranch_vccnz L_C_L0
s_branch L_C_G0
L_C_F231:
buffer_load_dwordx4 v[44:47], v5, s[4:7], s31 offen offset:2048 sc1
s_waitcnt vmcnt(2)
v_cmp_eq_u32 vcc, -1, v51
s_cbranch_vccnz L_C_F312
L_C_G312:
v_smfmac_f32_16x16x64_bf16 v[76:79], v[48:51], a[240:247], v3
v_smfmac_f32_16x16x64_bf16 v[80:83], v[48:51], a[248:255], v3
s_waitcnt vmcnt(1)
v_cmp_eq_u32 vcc, -1, v43
s_cbranch_vccnz L_C_F12
L_C_G12:
v_smfmac_f32_16x16x64_bf16 v[76:79], v[40:43], a[208:215], v3
v_smfmac_f32_16x16x64_bf16 v[80:83], v[40:43], a[216:223], v3
s_waitcnt vmcnt(0)
v_cmp_eq_u32 vcc, -1, v47
s_cbranch_vccnz L_C_F2
s_branch L_C_G2
L_C_F31:
buffer_load_dwordx4 v[48:51], v5, s[4:7], s31 offen offset:3072 sc1
s_waitcnt vmcnt(1)
v_cmp_eq_u32 vcc, -1, v43
s_cbranch_vccnz L_C_F13
L_C_G13:
v_smfmac_f32_16x16x64_bf16 v[76:79], v[40:43], a[208:215], v3
v_smfmac_f32_16x16x64_bf16 v[80:83], v[40:43], a[216:223], v3
s_waitcnt vmcnt(0)
v_cmp_eq_u32 vcc, -1, v51
s_cbranch_vccnz L_C_F3
s_branch L_C_G3
L_C_F1:
buffer_load_dwordx4 v[40:43], v5, s[4:7], s31 offen offset:1024 sc1
s_nop 14
L_C_L1:
buffer_load_dwordx4 v[40:43], v5, s[4:7], s31 offen offset:1024 sc1
s_sub_u32 s15, s15, 1
s_cbranch_scc1 L_exit
s_waitcnt vmcnt(1)
v_cmp_eq_u32 vcc, -1, v43
s_cbranch_vccnz L_C_L1
s_branch L_C_G1
L_C_F32:
buffer_load_dwordx4 v[48:51], v5, s[4:7], s31 offen offset:3072 sc1
s_waitcnt vmcnt(1)
v_cmp_eq_u32 vcc, -1, v47
s_cbranch_vccnz L_C_F23
L_C_G23:
v_smfmac_f32_16x16x64_bf16 v[76:79], v[44:47], a[224:231], v3
v_smfmac_f32_16x16x64_bf16 v[80:83], v[44:47], a[232:239], v3
s_waitcnt vmcnt(0)
v_cmp_eq_u32 vcc, -1, v51
s_cbranch_vccnz L_C_F3
s_branch L_C_G3
L_C_F2:
buffer_load_dwordx4 v[44:47], v5, s[4:7], s31 offen offset:2048 sc1
s_nop 14
L_C_L2:
buffer_load_dwordx4 v[44:47], v5, s[4:7], s31 offen offset:2048 sc1
s_sub_u32 s15, s15, 1
s_cbranch_scc1 L_exit
s_waitcnt vmcnt(1)
v_cmp_eq_u32 vcc, -1, v47
s_cbranch_vccnz L_C_L2
s_branch L_C_G2
L_C_F2301:
buffer_load_dwordx4 v[44:47], v5, s[4:7], s31 offen offset:2048 sc1
s_waitcnt vmcnt(3)
v_cmp_eq_u32 vcc, -1, v51
s_cbranch_vccnz L_C_F3012
L_C_G3012:
v_smfmac_f32_16x16x64_bf16 v[76:79], v[48:51], a[240:247], v3
v_smfmac_f32_16x16x64_bf16 v[80:83], v[48:51], a[248:255], v3
s_waitcnt vmcnt(2)
v_cmp_eq_u32 vcc, -1, v39
s_cbranch_vccnz L_C_F012
L_C_G012:
v_smfmac_f32_16x16x64_bf16 v[76:79], v[36:39], a[192:199], v3
v_smfmac_f32_16x16x64_bf16 v[80:83], v[36:39], a[200:207], v3
s_waitcnt vmcnt(1)
v_cmp_eq_u32 vcc, -1, v43
s_cbranch_vccnz L_C_F12
s_branch L_C_G12
L_C_F301:
buffer_load_dwordx4 v[48:51], v5, s[4:7], s31 offen offset:3072 sc1
s_waitcnt vmcnt(2)
v_cmp_eq_u32 vcc, -1, v39
s_cbranch_vccnz L_C_F013
L_C_G013:
v_smfmac_f32_16x16x64_bf16 v[76:79], v[36:39], a[192:199], v3
v_smfmac_f32_16x16x64_bf16 v[80:83], v[36:39], a[200:207], v3
s_waitcnt vmcnt(1)
v_cmp_eq_u32 vcc, -1, v43
s_cbranch_vccnz L_C_F13
s_branch L_C_G13
L_C_F01:
buffer_load_dwordx4 v[36:39], v5, s[4:7], s31 offen offset:0 sc1
s_sub_u32 s15, s15, 1
s_cbranch_scc1 L_exit
s_waitcnt vmcnt(1)
v_cmp_eq_u32 vcc, -1, v43
s_cbranch_vccnz L_C_F10
L_C_G10:
v_smfmac_f32_16x16x64_bf16 v[76:79], v[40:43], a[208:215], v3
v_smfmac_f32_16x16x64_bf16 v[80:83], v[40:43], a[216:223], v3
s_waitcnt vmcnt(0)
v_cmp_eq_u32 vcc, -1, v39
s_cbranch_vccnz L_C_F0
s_branch L_C_G0
L_C_F302:
buffer_load_dwordx4 v[48:51], v5, s[4:7], s31 offen offset:3072 sc1
s_waitcnt vmcnt(2)
v_cmp_eq_u32 vcc, -1, v39
s_cbranch_vccnz L_C_F023
L_C_G023:
v_smfmac_f32_16x16x64_bf16 v[76:79], v[36:39], a[192:199], v3
v_smfmac_f32_16x16x64_bf16 v[80:83], v[36:39], a[200:207], v3
s_waitcnt vmcnt(1)
v_cmp_eq_u32 vcc, -1, v47
s_cbranch_vccnz L_C_F23
s_branch L_C_G23
L_C_F02:
buffer_load_dwordx4 v[36:39], v5, s[4:7], s31 offen offset:0 sc1
s_sub_u32 s15, s15, 1
s_cbranch_scc1 L_exit
s_waitcnt vmcnt(1)
v_cmp_eq_u32 vcc, -1, v47
s_cbranch_vccnz L_C_F20
L_C_G20:
v_smfmac_f32_16x16x64_bf16 v[76:79], v[44:47], a[224:231], v3
v_smfmac_f32_16x16x64_bf16 v[80:83], v[44:47], a[232:239], v3
s_waitcnt vmcnt(0)
v_cmp_eq_u32 vcc, -1, v39
s_cbranch_vccnz L_C_F0
s_branch L_C_G0
L_C_F03:
buffer_load_dwordx4 v[36:39], v5, s[4:7], s31 offen offset:0 sc1
s_sub_u32 s15, s15, 1
s_cbranch_scc1 L_exit
s_waitcnt vmcnt(1)
v_cmp_eq_u32 vcc, -1, v51
s_cbranch_vccnz L_C_F30
s_branch L_C_G30
L_C_F312:
buffer_load_dwordx4 v[48:51], v5, s[4:7], s31 offen offset:3072 sc1
s_waitcnt vmcnt(2)
v_cmp_eq_u32 vcc, -1, v43
s_cbranch_vccnz L_C_F123
L_C_G123:
v_smfmac_f32_16x16x64_bf16 v[76:79], v[40:43], a[208:215], v3
v_smfmac_f32_16x16x64_bf16 v[80:83], v[40:43], a[216:223], v3
s_waitcnt vmcnt(1)
v_cmp_eq_u32 vcc, -1, v47
s_cbranch_vccnz L_C_F23
s_branch L_C_G23
L_C_F12:
buffer_load_dwordx4 v[40:43], v5, s[4:7], s31 offen offset:1024 sc1
s_sub_u32 s15, s15, 1
s_cbranch_scc1 L_exit
s_waitcnt vmcnt(1)
v_cmp_eq_u32 vcc, -1, v47
s_cbranch_vccnz L_C_F21
L_C_G21:
v_smfmac_f32_16x16x64_bf16 v[76:79], v[44:47], a[224:231], v3
v_smfmac_f32_16x16x64_bf16 v[80:83], v[44:47], a[232:239], v3
s_waitcnt vmcnt(0)
v_cmp_eq_u32 vcc, -1, v43
s_cbranch_vccnz L_C_F1
s_branch L_C_G1
L_C_F13:
buffer_load_dwordx4 v[40:43], v5, s[4:7], s31 offen offset:1024 sc1
s_sub_u32 s15, s15, 1
s_cbranch_scc1 L_exit
s_waitcnt vmcnt(1)
v_cmp_eq_u32 vcc, -1, v51
s_cbranch_vccnz L_C_F31
s_branch L_C_G31
L_C_F3012:
buffer_load_dwordx4 v[48:51], v5, s[4:7], s31 offen offset:3072 sc1
s_waitcnt vmcnt(3)
v_cmp_eq_u32 vcc, -1, v39
s_cbranch_vccnz L_C_F0123
L_C_G0123:
v_smfmac_f32_16x16x64_bf16 v[76:79], v[36:39], a[192:199], v3
v_smfmac_f32_16x16x64_bf16 v[80:83], v[36:39], a[200:207], v3
s_waitcnt vmcnt(2)
v_cmp_eq_u32 vcc, -1, v43
s_cbranch_vccnz L_C_F123
s_branch L_C_G123
L_C_F012:
buffer_load_dwordx4 v[36:39], v5, s[4:7], s31 offen offset:0 sc1
s_sub_u32 s15, s15, 1
s_cbranch_scc1 L_exit
s_waitcnt vmcnt(2)
v_cmp_eq_u32 vcc, -1, v43
s_cbranch_vccnz L_C_F120
L_C_G120:
v_smfmac_f32_16x16x64_bf16 v[76:79], v[40:43], a[208:215], v3
v_smfmac_f32_16x16x64_bf16 v[80:83], v[40:43], a[216:223], v3
s_waitcnt vmcnt(1)
v_cmp_eq_u32 vcc, -1, v47
s_cbranch_vccnz L_C_F20
s_branch L_C_G20
L_C_F013:
buffer_load_dwordx4 v[36:39], v5, s[4:7], s31 offen offset:0 sc1
s_sub_u32 s15, s15, 1
s_cbranch_scc1 L_exit
s_waitcnt vmcnt(2)
v_cmp_eq_u32 vcc, -1, v43
s_cbranch_vccnz L_C_F130
L_C_G130:
v_smfmac_f32_16x16x64_bf16 v[76:79], v[40:43], a[208:215], v3
v_smfmac_f32_16x16x64_bf16 v[80:83], v[40:43], a[216:223], v3
s_waitcnt vmcnt(1)
v_cmp_eq_u32 vcc, -1, v51
s_cbranch_vccnz L_C_F30
s_branch L_C_G30
L_C_F10:
buffer_load_dwordx4 v[40:43], v5, s[4:7], s31 offen offset:1024 sc1
s_waitcnt vmcnt(1)
v_cmp_eq_u32 vcc, -1, v39
s_cbranch_vccnz L_C_F01
s_branch L_C_G01
L_C_F023:
buffer_load_dwordx4 v[36:39], v5, s[4:7], s31 offen offset:0 sc1
s_sub_u32 s15, s15, 1
s_cbranch_scc1 L_exit
s_waitcnt vmcnt(2)
v_cmp_eq_u32 vcc, -1, v47
s_cbranch_vccnz L_C_F230
s_branch L_C_G230
L_C_F20:
buffer_load_dwordx4 v[44:47], v5, s[4:7], s31 offen offset:2048 sc1
s_waitcnt vmcnt(1)
v_cmp_eq_u32 vcc, -1, v39
s_cbranch_vccnz L_C_F02
s_branch L_C_G02
L_C_F21:
buffer_load_dwordx4 v[44:47], v5, s[4:7], s31 offen offset:2048 sc1
s_waitcnt vmcnt(1)
v_cmp_eq_u32 vcc, -1, v43
s_cbranch_vccnz L_C_F12
s_branch L_C_G12
L_C_F120:
buffer_load_dwordx4 v[40:43], v5, s[4:7], s31 offen offset:1024 sc1
s_waitcnt vmcnt(2)
v_cmp_eq_u32 vcc, -1, v47
s_cbranch_vccnz L_C_F201
L_C_G201:
v_smfmac_f32_16x16x64_bf16 v[76:79], v[44:47], a[224:231], v3
v_smfmac_f32_16x16x64_bf16 v[80:83], v[44:47], a[232:239], v3
s_waitcnt vmcnt(1)
v_cmp_eq_u32 vcc, -1, v39
s_cbranch_vccnz L_C_F01
s_branch L_C_G01
L_C_F130:
buffer_load_dwordx4 v[40:43], v5, s[4:7], s31 offen offset:1024 sc1
s_waitcnt vmcnt(2)
v_cmp_eq_u32 vcc, -1, v51
s_cbranch_vccnz L_C_F301
s_branch L_C_G301
L_C_F201:
buffer_load_dwordx4 v[44:47], v5, s[4:7], s31 offen offset:2048 sc1
s_waitcnt vmcnt(2)
v_cmp_eq_u32 vcc, -1, v39
s_cbranch_vccnz L_C_F012
s_branch L_C_G012
L_C_redo:
buffer_load_dwordx4 v[36:39], v5, s[4:7], s31 offen offset:0 sc1
buffer_load_dwordx4 v[40:43], v5, s[4:7], s31 offen offset:1024 sc1
buffer_load_dwordx4 v[44:47], v5, s[4:7], s31 offen offset:2048 sc1
buffer_load_dwordx4 v[48:51], v5, s[4:7], s31 offen offset:3072 sc1
s_sub_u32 s15, s15, 1
s_cbranch_scc1 L_exit
s_waitcnt vmcnt(0)
v_max3_u32 v224, v36, v37, v38
v_max_u32 v224, v224, v39
v_max3_u32 v224, v224, v40, v41
v_max3_u32 v224, v224, v42, v43
v_max3_u32 v224, v224, v44, v45
v_max3_u32 v224, v224, v46, v47
v_max3_u32 v224, v224, v48, v49
v_max3_u32 v224, v224, v50, v51
v_cmp_eq_u32 vcc, -1, v224
s_cbranch_vccnz L_C_redo
v_mov_b32 v76, 0
v_mov_b32 v77, 0
v_mov_b32 v78, 0
v_mov_b32 v79, 0
v_mov_b32 v80, 0
v_mov_b32 v81, 0
v_mov_b32 v82, 0
v_mov_b32 v83, 0
v_smfmac_f32_16x16x64_bf16 v[76:79], v[36:39], a[192:199], v3
    s_nop 0
v_smfmac_f32_16x16x64_bf16 v[80:83], v[36:39], a[200:207], v3
v_smfmac_f32_16x16x64_bf16 v[76:79], v[40:43], a[208:215], v3
v_smfmac_f32_16x16x64_bf16 v[80:83], v[40:43], a[216:223], v3
v_smfmac_f32_16x16x64_bf16 v[76:79], v[44:47], a[224:231], v3
v_smfmac_f32_16x16x64_bf16 v[80:83], v[44:47], a[232:239], v3
v_smfmac_f32_16x16x64_bf16 v[76:79], v[48:51], a[240:247], v3
v_smfmac_f32_16x16x64_bf16 v[80:83], v[48:51], a[248:255], v3
    s_nop 3
v_add_f32 v156, v76, v77
v_add_f32 v158, v78, v79
    s_nop 1
v_add_f32 v157, v80, v81
v_add_f32 v159, v82, v83
ds_write_b128 v6, v[156:159] offset:12288
s_cmp_eq_u32 s12, 1
s_cbranch_scc1 L_w1C_ok
s_cmp_eq_u32 s12, 0
s_cbranch_scc1 L_w0C_ok
s_branch L_w2C_ok
L_gemm:
s_load_dwordx2 s[28:29], s[0:1], 0
s_load_dwordx8 s[40:47], s[0:1], 16
s_sub_u32 s62, s13, 128
s_lshr_b32 s23, s62, 5
s_mul_i32 s23, s23, 24
s_and_b32 s19, s62, 31
s_sub_u32 s20, s19, 24
s_cmp_lt_u32 s19, 24
s_cselect_b32 s20, s19, s20
s_cselect_b32 s21, 1, 2
s_lshl_b32 s21, s21, 10
s_add_u32 s20, s20, s23
s_lshr_b32 s22, s20, 5
s_and_b32 s20, s20, 31
s_lshl_b32 s20, s20, 5
s_add_u32 s22, s22, s20
s_add_u32 s86, s22, s21
s_and_b32 s20, s19, 15
s_add_u32 s20, s20, 8
s_cmp_lt_u32 s19, 16
s_cselect_b32 s21, 4, 0x800
s_add_u32 s20, s20, s23
s_lshr_b32 s22, s20, 5
s_and_b32 s20, s20, 31
s_lshl_b32 s20, s20, 5
s_add_u32 s22, s22, s20
s_add_u32 s87, s22, s21
s_add_u32 s24, s19, 0
s_mul_i32 s21, s24, 2731
s_lshr_b32 s21, s21, 16
s_mul_i32 s20, s21, 24
s_sub_u32 s20, s24, s20
s_add_u32 s21, s21, 2
s_lshl_b32 s21, s21, 2
s_add_u32 s20, s20, s23
s_lshr_b32 s22, s20, 5
s_and_b32 s20, s20, 31
s_lshl_b32 s20, s20, 5
s_add_u32 s22, s22, s20
s_add_u32 s88, s22, s21
s_add_u32 s24, s19, 32
s_mul_i32 s21, s24, 2731
s_lshr_b32 s21, s21, 16
s_mul_i32 s20, s21, 24
s_sub_u32 s20, s24, s20
s_add_u32 s21, s21, 2
s_lshl_b32 s21, s21, 2
s_add_u32 s20, s20, s23
s_lshr_b32 s22, s20, 5
s_and_b32 s20, s20, 31
s_lshl_b32 s20, s20, 5
s_add_u32 s22, s22, s20
s_add_u32 s89, s22, s21
s_add_u32 s24, s19, 64
s_mul_i32 s21, s24, 2731
s_lshr_b32 s21, s21, 16
s_mul_i32 s20, s21, 24
s_sub_u32 s20, s24, s20
s_add_u32 s21, s21, 2
s_lshl_b32 s21, s21, 2
s_add_u32 s20, s20, s23
s_lshr_b32 s22, s20, 5
s_and_b32 s20, s20, 31
s_lshl_b32 s20, s20, 5
s_add_u32 s22, s22, s20
s_add_u32 s90, s22, s21
s_add_u32 s24, s19, 96
s_mul_i32 s21, s24, 2731
s_lshr_b32 s21, s21, 16
s_mul_i32 s20, s21, 24
s_sub_u32 s20, s24, s20
s_add_u32 s21, s21, 2
s_lshl_b32 s21, s21, 2
s_add_u32 s20, s20, s23
s_lshr_b32 s22, s20, 5
s_and_b32 s20, s20, 31
s_lshl_b32 s20, s20, 5
s_add_u32 s22, s22, s20
s_add_u32 s91, s22, s21
s_add_u32 s24, s19, 128
s_mul_i32 s21, s24, 2731
s_lshr_b32 s21, s21, 16
s_mul_i32 s20, s21, 24
s_sub_u32 s20, s24, s20
s_add_u32 s21, s21, 2
s_lshl_b32 s21, s21, 2
s_add_u32 s20, s20, s23
s_lshr_b32 s22, s20, 5
s_and_b32 s20, s20, 31
s_lshl_b32 s20, s20, 5
s_add_u32 s22, s22, s20
s_add_u32 s92, s22, s21
s_cmp_lt_u32 s19, 16
s_cbranch_scc1 L_g_descd
s_mov_b32 s92, s91
s_mov_b32 s91, s90
s_mov_b32 s90, s89
s_mov_b32 s89, s88
s_sub_u32 s20, s19, 16
s_lshr_b32 s20, s20, 1
s_and_b32 s21, s19, 1
s_add_u32 s21, s21, 1
s_lshl_b32 s21, s21, 10
s_add_u32 s21, s21, 4
s_add_u32 s20, s20, s23
s_lshr_b32 s22, s20, 5
s_and_b32 s20, s20, 31
s_lshl_b32 s20, s20, 5
s_add_u32 s22, s22, s20
s_add_u32 s88, s22, s21
L_g_descd:
s_waitcnt lgkmcnt(0)
s_mov_b32 s32, s28
s_mov_b32 s33, s29
s_mov_b32 s34, 0x400000
s_mov_b32 s35, 0x20000
s_mov_b32 s36, s40
s_mov_b32 s37, s41
s_mov_b32 s38, 0x800000
s_mov_b32 s39, 0x20000
v_lshrrev_b32 v80, 3, v0
v_lshrrev_b32 v81, 4, v0
v_and_b32 v82, 7, v0
s_lshl_b32 s18, s12, 17
v_add_u32 v83, 0, v81
v_xor_b32 v83, v83, v82
v_lshlrev_b32 v83, 4, v83
v_lshl_add_u32 v83, v80, 11, v83
v_add_u32 v83, 0, v83
v_add_u32 v4, s18, v83
v_add_u32 v83, 4, v81
v_xor_b32 v83, v83, v82
v_lshlrev_b32 v83, 4, v83
v_lshl_add_u32 v83, v80, 11, v83
v_add_u32 v83, 15360, v83
v_add_u32 v5, s18, v83
v_add_u32 v83, 0, v81
v_xor_b32 v83, v83, v82
v_lshlrev_b32 v83, 4, v83
v_lshl_add_u32 v83, v80, 11, v83
v_add_u32 v83, 30720, v83
v_add_u32 v6, s18, v83
v_add_u32 v83, 4, v81
v_xor_b32 v83, v83, v82
v_lshlrev_b32 v83, 4, v83
v_lshl_add_u32 v83, v80, 11, v83
v_add_u32 v83, 46080, v83
v_add_u32 v7, s18, v83
v_add_u32 v83, 0, v81
v_xor_b32 v83, v83, v82
v_lshlrev_b32 v83, 4, v83
v_lshl_add_u32 v83, v80, 11, v83
v_add_u32 v83, 65536, v83
v_add_u32 v8, s18, v83
v_add_u32 v83, 4, v81
v_xor_b32 v83, v83, v82
v_lshlrev_b32 v83, 4, v83
v_lshl_add_u32 v83, v80, 11, v83
v_add_u32 v83, 80896, v83
v_add_u32 v9, s18, v83
v_add_u32 v83, 0, v81
v_xor_b32 v83, v83, v82
v_lshlrev_b32 v83, 4, v83
v_lshl_add_u32 v83, v80, 11, v83
v_add_u32 v83, 96256, v83
v_add_u32 v10, s18, v83
v_add_u32 v83, 4, v81
v_xor_b32 v83, v83, v82
v_lshlrev_b32 v83, 4, v83
v_lshl_add_u32 v83, v80, 11, v83
v_add_u32 v83, 111616, v83
v_add_u32 v11, s18, v83
v_and_b32 v82, 15, v0
v_lshlrev_b32 v83, 2, v81
v_xor_b32 v83, v83, v82
v_lshlrev_b32 v83, 4, v83
v_lshl_add_u32 v83, v81, 13, v83
v_add_u32 v83, s18, v83
v_add_u32 v12, 0, v83
v_add_u32 v13, 31744, v83
v_xor_b32 v83, 32, v83
v_add_u32 v14, 63488, v83
v_add_u32 v15, 95232, v83
s_lshl_b32 s64, s12, 13
s_lshl_b32 s65, s12, 12
s_add_u32 s65, s65, 32768
s_lshl_b32 s93, s12, 16
s_lshr_b32 s64, s64, 1
v_subrev_u32 v4, s93, v4
v_subrev_u32 v5, s93, v5
v_subrev_u32 v6, s93, v6
v_subrev_u32 v7, s93, v7
s_mov_b32 s56, s86
s_mov_b32 s86, s87
s_mov_b32 s87, s88
s_mov_b32 s88, s89
s_mov_b32 s89, s90
s_mov_b32 s90, s91
s_mov_b32 s91, s92
s_mov_b32 s55, s56
s_and_b32 s18, s56, 3
s_cmp_eq_u32 s18, 1
s_cselect_b32 s36, s42, s40
s_cselect_b32 s37, s43, s41
s_cmp_eq_u32 s18, 2
s_cselect_b32 s36, s44, s36
s_cselect_b32 s37, s45, s37
s_bfe_u32 s51, s56, 0x30002
s_lshl_b32 s51, s51, 19
s_bfe_u32 s52, s56, 0x50005
s_lshl_b32 s52, s52, 8
s_lshr_b32 s18, s56, 11
s_lshl_b32 s18, s18, 18
s_add_u32 s51, s51, s18
s_mov_b32 s50, 0
s_mov_b32 s53, 0
s_mov_b32 s54, s64
s_mov_b32 s59, 0
s_mov_b32 s61, 0x8180000
s_mov_b32 s63, 1
s_sub_u32 s65, s65, 16384
s_add_u32 m0, s54, 0
    s_nop 0
buffer_load_dwordx4 v4, s[32:35], s51 offen offset:0 lds
buffer_load_dwordx4 v5, s[32:35], s51 offen offset:1024 lds
buffer_load_dwordx4 v6, s[32:35], s51 offen offset:2048 lds
buffer_load_dwordx4 v7, s[32:35], s51 offen offset:3072 lds
s_add_u32 m0, s53, s65
    s_nop 0
buffer_load_dwordx4 v12, s[36:39], s52 offen offset:0  lds
buffer_load_dwordx4 v13, s[36:39], s52 offen offset:1024  lds
buffer_load_dwordx4 v14, s[36:39], s52 offen offset:2048  lds
buffer_load_dwordx4 v15, s[36:39], s52 offen offset:3072  lds
s_add_u32 s53, s53, 32768
s_cmp_eq_u32 s53, 131072
s_cselect_b32 s53, 0, s53
s_add_u32 s54, s53, s64
s_add_u32 s51, s51, 128
s_add_u32 s52, s52, 0x80000
s_add_u32 s50, s50, 1
s_cmp_eq_u32 s50, 16
s_cbranch_scc1 L_g_adv1_n
L_g_adv1_d:
s_add_u32 m0, s54, 0
    s_nop 0
buffer_load_dwordx4 v4, s[32:35], s51 offen offset:0 lds
buffer_load_dwordx4 v5, s[32:35], s51 offen offset:1024 lds
buffer_load_dwordx4 v6, s[32:35], s51 offen offset:2048 lds
buffer_load_dwordx4 v7, s[32:35], s51 offen offset:3072 lds
s_add_u32 m0, s53, s65
    s_nop 0
buffer_load_dwordx4 v12, s[36:39], s52 offen offset:0  lds
buffer_load_dwordx4 v13, s[36:39], s52 offen offset:1024  lds
buffer_load_dwordx4 v14, s[36:39], s52 offen offset:2048  lds
buffer_load_dwordx4 v15, s[36:39], s52 offen offset:3072  lds
s_add_u32 s53, s53, 32768
s_cmp_eq_u32 s53, 131072
s_cselect_b32 s53, 0, s53
s_add_u32 s54, s53, s64
s_add_u32 s51, s51, 128
s_add_u32 s52, s52, 0x80000
s_add_u32 s50, s50, 1
s_cmp_eq_u32 s50, 16
s_cbranch_scc1 L_g_adv2_n
L_g_adv2_d:
s_add_u32 m0, s54, 0
    s_nop 0
buffer_load_dwordx4 v4, s[32:35], s51 offen offset:0 lds
buffer_load_dwordx4 v5, s[32:35], s51 offen offset:1024 lds
buffer_load_dwordx4 v6, s[32:35], s51 offen offset:2048 lds
buffer_load_dwordx4 v7, s[32:35], s51 offen offset:3072 lds
s_add_u32 m0, s53, s65
    s_nop 0
buffer_load_dwordx4 v12, s[36:39], s52 offen offset:0  lds
buffer_load_dwordx4 v13, s[36:39], s52 offen offset:1024  lds
buffer_load_dwordx4 v14, s[36:39], s52 offen offset:2048  lds
buffer_load_dwordx4 v15, s[36:39], s52 offen offset:3072  lds
s_add_u32 s53, s53, 32768
s_cmp_eq_u32 s53, 131072
s_cselect_b32 s53, 0, s53
s_add_u32 s54, s53, s64
s_add_u32 s51, s51, 128
s_add_u32 s52, s52, 0x80000
s_add_u32 s50, s50, 1
s_cmp_eq_u32 s50, 16
s_cbranch_scc1 L_g_adv3_n
L_g_adv3_d:
s_add_u32 m0, s54, 0
    s_nop 0
buffer_load_dwordx4 v4, s[32:35], s51 offen offset:0 lds
buffer_load_dwordx4 v5, s[32:35], s51 offen offset:1024 lds
buffer_load_dwordx4 v6, s[32:35], s51 offen offset:2048 lds
v_and_b32 v80, 15, v0
v_lshrrev_b32 v81, 4, v0
v_lshrrev_b32 v82, 1, v80
s_lshr_b32 s49, s12, 1
s_lshl_b32 s48, s49, 13
v_add_u32 v83, 0, v81
v_xor_b32 v83, v83, v82
v_lshlrev_b32 v83, 4, v83
v_lshl_add_u32 v83, v80, 7, v83
v_add_u32 v22, s48, v83
v_add_u32 v83, 4, v81
v_xor_b32 v83, v83, v82
v_lshlrev_b32 v83, 4, v83
v_lshl_add_u32 v83, v80, 7, v83
v_add_u32 v23, s48, v83
v_bfe_u32 v80, v0, 2, 2
v_and_b32 v82, 3, v0
v_and_b32 v83, 1, v81
v_lshlrev_b32 v83, 1, v83
v_lshl_add_u32 v83, v80, 2, v83
v_lshrrev_b32 v84, 1, v82
v_xor_b32 v83, v83, v84
v_lshl_add_u32 v84, v81, 3, v80
v_lshlrev_b32 v84, 8, v84
v_and_b32 v82, 1, v82
v_lshl_add_u32 v84, v82, 3, v84
v_add_u32 v84, 16384, v84
s_and_b32 s18, s12, 1
s_lshl_b32 s18, s18, 3
s_add_u32 s19, s18, 0
v_xor_b32 v85, s19, v83
v_lshl_add_u32 v24, v85, 4, v84
s_add_u32 s19, s18, 2
v_xor_b32 v85, s19, v83
v_lshl_add_u32 v25, v85, 4, v84
s_add_u32 s19, s18, 4
v_xor_b32 v85, s19, v83
v_lshl_add_u32 v26, v85, 4, v84
s_add_u32 s19, s18, 6
v_xor_b32 v85, s19, v83
v_lshl_add_u32 v27, v85, 4, v84
s_lshl_b32 s18, s49, 21
s_and_b32 s19, s12, 1
s_lshl_b32 s19, s19, 12
s_add_u32 s18, s18, s19
v_lshlrev_b32 v80, 4, v0
v_add_u32 v28, s18, v80
v_mov_b32 v29, 1
v_lshlrev_b32 v2, 9, v0
s_mov_b32 s66, 0x7f000000
s_mov_b32 s67, 0x7f000000
s_mov_b32 s68, 0x7f000000
s_mov_b32 s57, 0
v_add_u32 v16, s57, v22
v_add_u32 v17, s57, v23
v_add_u32 v18, s57, v24
v_add_u32 v19, s57, v25
v_add_u32 v20, s57, v26
v_add_u32 v21, s57, v27
s_waitcnt vmcnt(19)
s_barrier
ds_read_b64_tr_b16 v[32:33], v18 offset:0
ds_read_b64_tr_b16 v[34:35], v18 offset:1024
ds_read_b128 v[64:67], v16 offset:0
ds_read_b64_tr_b16 v[36:37], v19 offset:0
ds_read_b64_tr_b16 v[38:39], v19 offset:1024
ds_read_b64_tr_b16 v[40:41], v20 offset:0
ds_read_b64_tr_b16 v[42:43], v20 offset:1024
ds_read_b64_tr_b16 v[44:45], v21 offset:0
ds_read_b64_tr_b16 v[46:47], v21 offset:1024
ds_read_b128 v[68:71], v16 offset:2048
ds_read_b128 v[72:75], v16 offset:4096
s_cmp_eq_u32 s12, 0
s_cbranch_scc0 L_arv_gemm
s_cmp_eq_u32 s3, 0
s_cbranch_scc0 L_arv_gemm
s_load_dwordx2 s[28:29], s[0:1], 112
s_waitcnt lgkmcnt(0)
s_mov_b32 s8, s28
s_mov_b32 s9, s29
s_mov_b32 s10, 0x100
s_mov_b32 s11, 0x20000
s_lshl_b32 s18, s16, 5
v_mov_b32 v80, s18
s_lshl_b32 s18, s98, 12
s_add_u32 s18, s18, 1
v_mov_b32 v81, s18
s_mov_b64 exec, 1
buffer_atomic_add v81, v80, s[8:11], 0 offen offset:4
s_mov_b64 exec, -1
L_arv_gemm:
s_mov_b32 s3, 1
L_g_half:
s_bitcmp1_b32 s55, 1
s_cbranch_scc1 L_g_Vh_first
.p2align 6
L_g_Kh_first:
s_waitcnt lgkmcnt(1)
v_mfma_f32_16x16x32_bf16 v[128:131], v[32:35], v[64:67], 0
ds_read_b128 v[76:79], v16 offset:6144
v_mfma_f32_16x16x32_bf16 v[132:135], v[36:39], v[64:67], 0
ds_read_b64_tr_b16 v[48:49], v18 offset:8192
ds_read_b64_tr_b16 v[50:51], v18 offset:9216
v_mfma_f32_16x16x32_bf16 v[136:139], v[40:43], v[64:67], 0
buffer_load_dwordx4 v7, s[32:35], s51 offen offset:3072 lds
v_mfma_f32_16x16x32_bf16 v[140:143], v[44:47], v[64:67], 0
s_add_u32 m0, s53, s65
ds_read_b64_tr_b16 v[52:53], v19 offset:8192
v_mfma_f32_16x16x32_bf16 v[144:147], v[32:35], v[68:71], 0
ds_read_b128 v[64:67], v17 offset:0
v_mfma_f32_16x16x32_bf16 v[148:151], v[36:39], v[68:71], 0
buffer_load_dwordx4 v12, s[36:39], s52 offen offset:0  lds
v_mfma_f32_16x16x32_bf16 v[152:155], v[40:43], v[68:71], 0
ds_read_b64_tr_b16 v[54:55], v19 offset:9216
v_mfma_f32_16x16x32_bf16 v[156:159], v[44:47], v[68:71], 0
buffer_load_dwordx4 v13, s[36:39], s52 offen offset:1024  lds
s_waitcnt lgkmcnt(5)
v_mfma_f32_16x16x32_bf16 v[160:163], v[32:35], v[72:75], 0
ds_read_b128 v[68:71], v17 offset:2048
v_mfma_f32_16x16x32_bf16 v[164:167], v[36:39], v[72:75], 0
ds_read_b64_tr_b16 v[56:57], v20 offset:8192
v_mfma_f32_16x16x32_bf16 v[168:171], v[40:43], v[72:75], 0
buffer_load_dwordx4 v14, s[36:39], s52 offen offset:2048  lds
v_mfma_f32_16x16x32_bf16 v[172:175], v[44:47], v[72:75], 0
ds_read_b64_tr_b16 v[58:59], v20 offset:9216
ds_read_b64_tr_b16 v[60:61], v21 offset:8192
v_mfma_f32_16x16x32_bf16 v[176:179], v[32:35], v[76:79], 0
ds_read_b128 v[72:75], v17 offset:4096
ds_read_b64_tr_b16 v[62:63], v21 offset:9216
v_mfma_f32_16x16x32_bf16 v[180:183], v[36:39], v[76:79], 0
buffer_load_dwordx4 v15, s[36:39], s52 offen offset:3072  lds
v_mfma_f32_16x16x32_bf16 v[184:187], v[40:43], v[76:79], 0
s_add_u32 s57, s57, 32768
s_add_u32 s53, s53, 32768
s_add_u32 s52, s52, 0x80000
v_mfma_f32_16x16x32_bf16 v[188:191], v[44:47], v[76:79], 0
s_cmp_eq_u32 s57, 131072
s_cselect_b32 s57, 0, s57
s_waitcnt lgkmcnt(0)
v_mfma_f32_16x16x32_bf16 v[128:131], v[48:51], v[64:67], v[128:131]
ds_read_b128 v[76:79], v17 offset:6144
v_add_u32 v19, s57, v25
s_cmp_eq_u32 s53, 131072
s_cselect_b32 s53, 0, s53
v_mfma_f32_16x16x32_bf16 v[132:135], v[52:55], v[64:67], v[132:135]
v_add_u32 v16, s57, v22
v_add_u32 v20, s57, v26
v_mfma_f32_16x16x32_bf16 v[136:139], v[56:59], v[64:67], v[136:139]
v_add_u32 v18, s57, v24
v_add_u32 v21, s57, v27
v_mfma_f32_16x16x32_bf16 v[140:143], v[60:63], v[64:67], v[140:143]
s_cmp_eq_u32 s59, 0
s_cbranch_scc1 L_g_Khf_w
s_waitcnt vmcnt(5)
L_g_Khf_w:
s_waitcnt vmcnt(16) lgkmcnt(0)
s_barrier
v_mfma_f32_16x16x32_bf16 v[144:147], v[48:51], v[68:71], v[144:147]
ds_read_b64_tr_b16 v[32:33], v18 offset:0
s_add_u32 s54, s53, s64
v_mfma_f32_16x16x32_bf16 v[148:151], v[52:55], v[68:71], v[148:151]
ds_read_b64_tr_b16 v[34:35], v18 offset:1024
s_add_u32 s51, s51, 128
v_mfma_f32_16x16x32_bf16 v[152:155], v[56:59], v[68:71], v[152:155]
ds_read_b128 v[64:67], v16 offset:0
s_add_u32 s50, s50, 1
v_mfma_f32_16x16x32_bf16 v[156:159], v[60:63], v[68:71], v[156:159]
ds_read_b64_tr_b16 v[36:37], v19 offset:0
v_mfma_f32_16x16x32_bf16 v[160:163], v[48:51], v[72:75], v[160:163]
ds_read_b64_tr_b16 v[38:39], v19 offset:1024
s_cmp_eq_u32 s50, 16
s_cbranch_scc1 L_g_adv4_n
L_g_adv4_d:
v_mfma_f32_16x16x32_bf16 v[164:167], v[52:55], v[72:75], v[164:167]
ds_read_b64_tr_b16 v[40:41], v20 offset:0
s_add_u32 m0, s54, 0
v_mfma_f32_16x16x32_bf16 v[168:171], v[56:59], v[72:75], v[168:171]
ds_read_b64_tr_b16 v[42:43], v20 offset:1024
v_mfma_f32_16x16x32_bf16 v[172:175], v[60:63], v[72:75], v[172:175]
ds_read_b64_tr_b16 v[44:45], v21 offset:0
buffer_load_dwordx4 v4, s[32:35], s51 offen offset:0 lds
v_mfma_f32_16x16x32_bf16 v[176:179], v[48:51], v[76:79], v[176:179]
ds_read_b64_tr_b16 v[46:47], v21 offset:1024
ds_read_b128 v[68:71], v16 offset:2048
v_mfma_f32_16x16x32_bf16 v[180:183], v[52:55], v[76:79], v[180:183]
ds_read_b128 v[72:75], v16 offset:4096
v_mfma_f32_16x16x32_bf16 v[184:187], v[56:59], v[76:79], v[184:187]
v_add_u32 v17, s57, v23
buffer_load_dwordx4 v5, s[32:35], s51 offen offset:1024 lds
v_mfma_f32_16x16x32_bf16 v[188:191], v[60:63], v[76:79], v[188:191]
buffer_load_dwordx4 v6, s[32:35], s51 offen offset:2048 lds
s_cmp_eq_u32 s59, 0
s_cbranch_scc1 L_g_Kh_nf
s_cmp_eq_u32 s12, 0
s_cbranch_scc0 L_g_Kh_nf
s_mov_b32 exec_lo, s63
s_mov_b32 exec_hi, 0
buffer_store_dword v29, v2, s[4:7], s61 offen sc1
s_mov_b64 exec, -1
L_g_Kh_nf:
s_mov_b32 s58, 1
.p2align 6
L_g_Kh_loop:
s_waitcnt lgkmcnt(1)
v_mfma_f32_16x16x32_bf16 v[128:131], v[32:35], v[64:67], v[128:131]
ds_read_b128 v[76:79], v16 offset:6144
v_mfma_f32_16x16x32_bf16 v[132:135], v[36:39], v[64:67], v[132:135]
ds_read_b64_tr_b16 v[48:49], v18 offset:8192
ds_read_b64_tr_b16 v[50:51], v18 offset:9216
v_mfma_f32_16x16x32_bf16 v[136:139], v[40:43], v[64:67], v[136:139]
buffer_load_dwordx4 v7, s[32:35], s51 offen offset:3072 lds
v_mfma_f32_16x16x32_bf16 v[140:143], v[44:47], v[64:67], v[140:143]
s_add_u32 m0, s53, s65
ds_read_b64_tr_b16 v[52:53], v19 offset:8192
v_mfma_f32_16x16x32_bf16 v[144:147], v[32:35], v[68:71], v[144:147]
ds_read_b128 v[64:67], v17 offset:0
s_add_u32 s58, s58, 1
v_mfma_f32_16x16x32_bf16 v[148:151], v[36:39], v[68:71], v[148:151]
buffer_load_dwordx4 v12, s[36:39], s52 offen offset:0  lds
v_mfma_f32_16x16x32_bf16 v[152:155], v[40:43], v[68:71], v[152:155]
ds_read_b64_tr_b16 v[54:55], v19 offset:9216
v_mfma_f32_16x16x32_bf16 v[156:159], v[44:47], v[68:71], v[156:159]
buffer_load_dwordx4 v13, s[36:39], s52 offen offset:1024  lds
s_waitcnt lgkmcnt(5)
v_mfma_f32_16x16x32_bf16 v[160:163], v[32:35], v[72:75], v[160:163]
ds_read_b128 v[68:71], v17 offset:2048
v_mfma_f32_16x16x32_bf16 v[164:167], v[36:39], v[72:75], v[164:167]
ds_read_b64_tr_b16 v[56:57], v20 offset:8192
v_mfma_f32_16x16x32_bf16 v[168:171], v[40:43], v[72:75], v[168:171]
buffer_load_dwordx4 v14, s[36:39], s52 offen offset:2048  lds
v_mfma_f32_16x16x32_bf16 v[172:175], v[44:47], v[72:75], v[172:175]
ds_read_b64_tr_b16 v[58:59], v20 offset:9216
ds_read_b64_tr_b16 v[60:61], v21 offset:8192
v_mfma_f32_16x16x32_bf16 v[176:179], v[32:35], v[76:79], v[176:179]
ds_read_b128 v[72:75], v17 offset:4096
ds_read_b64_tr_b16 v[62:63], v21 offset:9216
v_mfma_f32_16x16x32_bf16 v[180:183], v[36:39], v[76:79], v[180:183]
buffer_load_dwordx4 v15, s[36:39], s52 offen offset:3072  lds
v_mfma_f32_16x16x32_bf16 v[184:187], v[40:43], v[76:79], v[184:187]
s_add_u32 s57, s57, 32768
s_add_u32 s53, s53, 32768
s_add_u32 s52, s52, 0x80000
v_mfma_f32_16x16x32_bf16 v[188:191], v[44:47], v[76:79], v[188:191]
s_cmp_eq_u32 s57, 131072
s_cselect_b32 s57, 0, s57
s_waitcnt lgkmcnt(0)
v_mfma_f32_16x16x32_bf16 v[128:131], v[48:51], v[64:67], v[128:131]
ds_read_b128 v[76:79], v17 offset:6144
v_add_u32 v19, s57, v25
s_cmp_eq_u32 s53, 131072
s_cselect_b32 s53, 0, s53
v_mfma_f32_16x16x32_bf16 v[132:135], v[52:55], v[64:67], v[132:135]
v_add_u32 v16, s57, v22
v_add_u32 v20, s57, v26
v_mfma_f32_16x16x32_bf16 v[136:139], v[56:59], v[64:67], v[136:139]
v_add_u32 v18, s57, v24
v_add_u32 v21, s57, v27
v_mfma_f32_16x16x32_bf16 v[140:143], v[60:63], v[64:67], v[140:143]
s_waitcnt vmcnt(16) lgkmcnt(0)
s_barrier
v_mfma_f32_16x16x32_bf16 v[144:147], v[48:51], v[68:71], v[144:147]
ds_read_b64_tr_b16 v[32:33], v18 offset:0
s_add_u32 s54, s53, s64
v_mfma_f32_16x16x32_bf16 v[148:151], v[52:55], v[68:71], v[148:151]
ds_read_b64_tr_b16 v[34:35], v18 offset:1024
s_add_u32 s51, s51, 128
v_mfma_f32_16x16x32_bf16 v[152:155], v[56:59], v[68:71], v[152:155]
ds_read_b128 v[64:67], v16 offset:0
s_add_u32 s50, s50, 1
v_mfma_f32_16x16x32_bf16 v[156:159], v[60:63], v[68:71], v[156:159]
ds_read_b64_tr_b16 v[36:37], v19 offset:0
v_mfma_f32_16x16x32_bf16 v[160:163], v[48:51], v[72:75], v[160:163]
ds_read_b64_tr_b16 v[38:39], v19 offset:1024
s_cmp_eq_u32 s50, 16
s_cbranch_scc1 L_g_adv5_n
L_g_adv5_d:
v_mfma_f32_16x16x32_bf16 v[164:167], v[52:55], v[72:75], v[164:167]
ds_read_b64_tr_b16 v[40:41], v20 offset:0
s_add_u32 m0, s54, 0
v_mfma_f32_16x16x32_bf16 v[168:171], v[56:59], v[72:75], v[168:171]
ds_read_b64_tr_b16 v[42:43], v20 offset:1024
v_mfma_f32_16x16x32_bf16 v[172:175], v[60:63], v[72:75], v[172:175]
ds_read_b64_tr_b16 v[44:45], v21 offset:0
buffer_load_dwordx4 v4, s[32:35], s51 offen offset:0 lds
v_mfma_f32_16x16x32_bf16 v[176:179], v[48:51], v[76:79], v[176:179]
ds_read_b64_tr_b16 v[46:47], v21 offset:1024
ds_read_b128 v[68:71], v16 offset:2048
v_mfma_f32_16x16x32_bf16 v[180:183], v[52:55], v[76:79], v[180:183]
ds_read_b128 v[72:75], v16 offset:4096
v_mfma_f32_16x16x32_bf16 v[184:187], v[56:59], v[76:79], v[184:187]
v_add_u32 v17, s57, v23
buffer_load_dwordx4 v5, s[32:35], s51 offen offset:1024 lds
v_mfma_f32_16x16x32_bf16 v[188:191], v[60:63], v[76:79], v[188:191]
buffer_load_dwordx4 v6, s[32:35], s51 offen offset:2048 lds
s_bitcmp0_b32 0x11000, s58
s_cbranch_scc1 L_g_Kh_loop
s_cmp_eq_u32 s58, 16
s_cbranch_scc1 L_g_Kh_end
s_cmp_eq_u32 s59, 0
s_cbranch_scc0 L_g_Kh_loop
s_load_dwordx2 s[28:29], s[0:1], 112
s_waitcnt lgkmcnt(0)
s_mov_b32 s8, s28
s_mov_b32 s9, s29
s_mov_b32 s10, 0x100
s_mov_b32 s11, 0x20000
v_lshlrev_b32 v80, 2, v0
buffer_load_dword v81, v80, s[8:11], 0 offen sc1
s_branch L_g_Kh_loop
L_g_Kh_end:
s_cmp_eq_u32 s59, 0
s_cbranch_scc0 L_g_Kh_arr
s_branch L_arr_gemmKh_c
L_arr_gemmKh:
s_load_dwordx2 s[28:29], s[0:1], 112
s_waitcnt lgkmcnt(0)
s_mov_b32 s8, s28
s_mov_b32 s9, s29
s_mov_b32 s10, 0x100
s_mov_b32 s11, 0x20000
v_lshlrev_b32 v80, 2, v0
buffer_load_dword v81, v80, s[8:11], 0 offen sc1
s_waitcnt vmcnt(0)
L_arr_gemmKh_c:
v_readlane_b32 s18, v81, 1
v_readlane_b32 s19, v81, 9
v_readlane_b32 s20, v81, 17
v_readlane_b32 s21, v81, 25
v_readlane_b32 s22, v81, 33
v_readlane_b32 s23, v81, 41
v_readlane_b32 s24, v81, 49
v_readlane_b32 s25, v81, 57
s_add_u32 s18, s18, s19
s_add_u32 s18, s18, s20
s_add_u32 s18, s18, s21
s_add_u32 s18, s18, s22
s_add_u32 s18, s18, s23
s_add_u32 s18, s18, s24
s_add_u32 s18, s18, s25
s_and_b32 s19, s18, 0xfff
s_cmp_eq_u32 s19, 256
s_cbranch_scc1 L_arr_gemmKh_ok
s_sub_u32 s15, s15, 1
s_cbranch_scc1 L_exit
s_sleep 4
s_branch L_arr_gemmKh
L_arr_gemmKh_ok:
s_lshr_b32 s18, s18, 12
s_cmp_gt_u32 s18, 131072
s_cselect_b32 s99, 0x2000, 0
v_readlane_b32 s18, v81, 0
v_readlane_b32 s19, v81, 8
v_readlane_b32 s20, v81, 16
v_readlane_b32 s21, v81, 24
v_readlane_b32 s22, v81, 32
v_readlane_b32 s23, v81, 40
v_readlane_b32 s24, v81, 48
v_readlane_b32 s25, v81, 56
s_mov_b32 s14, 1
s_cmp_eq_u32 s18, 32
s_cselect_b32 s14, s14, 0
s_cmp_eq_u32 s19, 32
s_cselect_b32 s14, s14, 0
s_cmp_eq_u32 s20, 32
s_cselect_b32 s14, s14, 0
s_cmp_eq_u32 s21, 32
s_cselect_b32 s14, s14, 0
s_cmp_eq_u32 s22, 32
s_cselect_b32 s14, s14, 0
s_cmp_eq_u32 s23, 32
s_cselect_b32 s14, s14, 0
s_cmp_eq_u32 s24, 32
s_cselect_b32 s14, s14, 0
s_cmp_eq_u32 s25, 32
s_cselect_b32 s14, s14, 0
L_g_Kh_arr:
s_and_b32 s18, s55, 3
s_lshl_b32 s60, s18, 25
s_lshl_b32 s61, s18, 2
s_bfe_u32 s18, s55, 0x30002
s_lshl_b32 s19, s18, 22
s_add_u32 s60, s60, s19
s_lshl_b32 s19, s18, 10
s_add_u32 s61, s61, s19
s_bfe_u32 s18, s55, 0x50005
s_lshl_b32 s19, s18, 14
s_add_u32 s60, s60, s19
s_lshl_b32 s19, s18, 4
s_add_u32 s61, s61, s19
s_add_u32 s61, s61, 0x8180000
s_add_u32 s61, s61, s99
s_lshr_b32 s18, s55, 10
s_cmp_eq_u32 s18, 0
s_cselect_b32 s63, 3, s18
s_lshr_b32 s18, s18, 1
s_lshl_b32 s19, s18, 21
s_add_u32 s60, s60, s19
s_cmp_eq_u32 s63, 3
s_cselect_b32 s18, s49, s18
s_lshl_b32 s18, s18, 13
s_xor_b32 s18, s18, s99
s_add_u32 s60, s60, s18
s_lshl_b32 s18, s49, 20
v_subrev_u32 v30, s18, v28
v_cvt_pk_bf16_f32 v112, v128, v132
v_cvt_pk_bf16_f32 v113, v129, v133
v_cvt_pk_bf16_f32 v114, v130, v134
v_cvt_pk_bf16_f32 v115, v131, v135
buffer_store_dwordx4 v[112:115], v30, s[4:7], s60 offen offset:0 sc1
v_cvt_pk_bf16_f32 v116, v144, v148
v_cvt_pk_bf16_f32 v117, v145, v149
v_cvt_pk_bf16_f32 v118, v146, v150
v_cvt_pk_bf16_f32 v119, v147, v151
buffer_store_dwordx4 v[116:119], v30, s[4:7], s60 offen offset:1024 sc1
v_cvt_pk_bf16_f32 v120, v136, v140
v_cvt_pk_bf16_f32 v121, v137, v141
v_cvt_pk_bf16_f32 v122, v138, v142
v_cvt_pk_bf16_f32 v123, v139, v143
buffer_store_dwordx4 v[120:123], v30, s[4:7], s60 offen offset:2048 sc1
v_cvt_pk_bf16_f32 v124, v152, v156
v_cvt_pk_bf16_f32 v125, v153, v157
v_cvt_pk_bf16_f32 v126, v154, v158
v_cvt_pk_bf16_f32 v127, v155, v159
buffer_store_dwordx4 v[124:127], v30, s[4:7], s60 offen offset:3072 sc1
s_add_u32 s60, s60, 0x80000
v_cvt_pk_bf16_f32 v96, v160, v164
v_cvt_pk_bf16_f32 v97, v161, v165
v_cvt_pk_bf16_f32 v98, v162, v166
v_cvt_pk_bf16_f32 v99, v163, v167
buffer_store_dwordx4 v[96:99], v30, s[4:7], s60 offen offset:0 sc1
v_cvt_pk_bf16_f32 v100, v176, v180
v_cvt_pk_bf16_f32 v101, v177, v181
v_cvt_pk_bf16_f32 v102, v178, v182
v_cvt_pk_bf16_f32 v103, v179, v183
buffer_store_dwordx4 v[100:103], v30, s[4:7], s60 offen offset:1024 sc1
v_cvt_pk_bf16_f32 v104, v168, v172
v_cvt_pk_bf16_f32 v105, v169, v173
v_cvt_pk_bf16_f32 v106, v170, v174
v_cvt_pk_bf16_f32 v107, v171, v175
buffer_store_dwordx4 v[104:107], v30, s[4:7], s60 offen offset:2048 sc1
v_cvt_pk_bf16_f32 v108, v184, v188
v_cvt_pk_bf16_f32 v109, v185, v189
v_cvt_pk_bf16_f32 v110, v186, v190
v_cvt_pk_bf16_f32 v111, v187, v191
buffer_store_dwordx4 v[108:111], v30, s[4:7], s60 offen offset:3072 sc1
s_branch L_g_next
.p2align 6
L_g_Vh_first:
s_waitcnt lgkmcnt(1)
v_mfma_f32_16x16x32_bf16 v[128:131], v[64:67], v[32:35], 0
ds_read_b128 v[76:79], v16 offset:6144
v_mfma_f32_16x16x32_bf16 v[132:135], v[64:67], v[36:39], 0
ds_read_b64_tr_b16 v[48:49], v18 offset:8192
ds_read_b64_tr_b16 v[50:51], v18 offset:9216
v_mfma_f32_16x16x32_bf16 v[136:139], v[64:67], v[40:43], 0
buffer_load_dwordx4 v7, s[32:35], s51 offen offset:3072 lds
v_mfma_f32_16x16x32_bf16 v[140:143], v[64:67], v[44:47], 0
s_add_u32 m0, s53, s65
ds_read_b64_tr_b16 v[52:53], v19 offset:8192
v_mfma_f32_16x16x32_bf16 v[144:147], v[68:71], v[32:35], 0
ds_read_b128 v[64:67], v17 offset:0
v_mfma_f32_16x16x32_bf16 v[148:151], v[68:71], v[36:39], 0
buffer_load_dwordx4 v12, s[36:39], s52 offen offset:0  lds
v_mfma_f32_16x16x32_bf16 v[152:155], v[68:71], v[40:43], 0
ds_read_b64_tr_b16 v[54:55], v19 offset:9216
v_mfma_f32_16x16x32_bf16 v[156:159], v[68:71], v[44:47], 0
buffer_load_dwordx4 v13, s[36:39], s52 offen offset:1024  lds
s_waitcnt lgkmcnt(5)
v_mfma_f32_16x16x32_bf16 v[160:163], v[72:75], v[32:35], 0
ds_read_b128 v[68:71], v17 offset:2048
v_mfma_f32_16x16x32_bf16 v[164:167], v[72:75], v[36:39], 0
ds_read_b64_tr_b16 v[56:57], v20 offset:8192
v_mfma_f32_16x16x32_bf16 v[168:171], v[72:75], v[40:43], 0
buffer_load_dwordx4 v14, s[36:39], s52 offen offset:2048  lds
v_mfma_f32_16x16x32_bf16 v[172:175], v[72:75], v[44:47], 0
ds_read_b64_tr_b16 v[58:59], v20 offset:9216
ds_read_b64_tr_b16 v[60:61], v21 offset:8192
v_mfma_f32_16x16x32_bf16 v[176:179], v[76:79], v[32:35], 0
ds_read_b128 v[72:75], v17 offset:4096
ds_read_b64_tr_b16 v[62:63], v21 offset:9216
v_mfma_f32_16x16x32_bf16 v[180:183], v[76:79], v[36:39], 0
buffer_load_dwordx4 v15, s[36:39], s52 offen offset:3072  lds
v_mfma_f32_16x16x32_bf16 v[184:187], v[76:79], v[40:43], 0
s_add_u32 s57, s57, 32768
s_add_u32 s53, s53, 32768
s_add_u32 s52, s52, 0x80000
v_mfma_f32_16x16x32_bf16 v[188:191], v[76:79], v[44:47], 0
s_cmp_eq_u32 s57, 131072
s_cselect_b32 s57, 0, s57
s_waitcnt lgkmcnt(0)
v_mfma_f32_16x16x32_bf16 v[128:131], v[64:67], v[48:51], v[128:131]
ds_read_b128 v[76:79], v17 offset:6144
v_add_u32 v19, s57, v25
s_cmp_eq_u32 s53, 131072
s_cselect_b32 s53, 0, s53
v_mfma_f32_16x16x32_bf16 v[132:135], v[64:67], v[52:55], v[132:135]
v_add_u32 v16, s57, v22
v_add_u32 v20, s57, v26
v_mfma_f32_16x16x32_bf16 v[136:139], v[64:67], v[56:59], v[136:139]
v_add_u32 v18, s57, v24
v_add_u32 v21, s57, v27
v_mfma_f32_16x16x32_bf16 v[140:143], v[64:67], v[60:63], v[140:143]
s_cmp_eq_u32 s59, 0
s_cbranch_scc1 L_g_Vhf_w
s_waitcnt vmcnt(5)
L_g_Vhf_w:
s_waitcnt vmcnt(16) lgkmcnt(0)
s_barrier
v_mfma_f32_16x16x32_bf16 v[144:147], v[68:71], v[48:51], v[144:147]
ds_read_b64_tr_b16 v[32:33], v18 offset:0
s_add_u32 s54, s53, s64
v_mfma_f32_16x16x32_bf16 v[148:151], v[68:71], v[52:55], v[148:151]
ds_read_b64_tr_b16 v[34:35], v18 offset:1024
s_add_u32 s51, s51, 128
v_mfma_f32_16x16x32_bf16 v[152:155], v[68:71], v[56:59], v[152:155]
ds_read_b128 v[64:67], v16 offset:0
s_add_u32 s50, s50, 1
v_mfma_f32_16x16x32_bf16 v[156:159], v[68:71], v[60:63], v[156:159]
ds_read_b64_tr_b16 v[36:37], v19 offset:0
v_mfma_f32_16x16x32_bf16 v[160:163], v[72:75], v[48:51], v[160:163]
ds_read_b64_tr_b16 v[38:39], v19 offset:1024
s_cmp_eq_u32 s50, 16
s_cbranch_scc1 L_g_adv6_n
L_g_adv6_d:
v_mfma_f32_16x16x32_bf16 v[164:167], v[72:75], v[52:55], v[164:167]
ds_read_b64_tr_b16 v[40:41], v20 offset:0
s_add_u32 m0, s54, 0
v_mfma_f32_16x16x32_bf16 v[168:171], v[72:75], v[56:59], v[168:171]
ds_read_b64_tr_b16 v[42:43], v20 offset:1024
v_mfma_f32_16x16x32_bf16 v[172:175], v[72:75], v[60:63], v[172:175]
ds_read_b64_tr_b16 v[44:45], v21 offset:0
buffer_load_dwordx4 v4, s[32:35], s51 offen offset:0 lds
v_mfma_f32_16x16x32_bf16 v[176:179], v[76:79], v[48:51], v[176:179]
ds_read_b64_tr_b16 v[46:47], v21 offset:1024
ds_read_b128 v[68:71], v16 offset:2048
v_mfma_f32_16x16x32_bf16 v[180:183], v[76:79], v[52:55], v[180:183]
ds_read_b128 v[72:75], v16 offset:4096
v_mfma_f32_16x16x32_bf16 v[184:187], v[76:79], v[56:59], v[184:187]
v_add_u32 v17, s57, v23
buffer_load_dwordx4 v5, s[32:35], s51 offen offset:1024 lds
v_mfma_f32_16x16x32_bf16 v[188:191], v[76:79], v[60:63], v[188:191]
buffer_load_dwordx4 v6, s[32:35], s51 offen offset:2048 lds
s_cmp_eq_u32 s59, 0
s_cbranch_scc1 L_g_Vh_nf
s_cmp_eq_u32 s12, 0
s_cbranch_scc0 L_g_Vh_nf
s_mov_b32 exec_lo, s63
s_mov_b32 exec_hi, 0
buffer_store_dword v29, v2, s[4:7], s61 offen sc1
s_mov_b64 exec, -1
L_g_Vh_nf:
s_mov_b32 s58, 1
.p2align 6
L_g_Vh_loop:
s_waitcnt lgkmcnt(1)
v_mfma_f32_16x16x32_bf16 v[128:131], v[64:67], v[32:35], v[128:131]
ds_read_b128 v[76:79], v16 offset:6144
v_mfma_f32_16x16x32_bf16 v[132:135], v[64:67], v[36:39], v[132:135]
ds_read_b64_tr_b16 v[48:49], v18 offset:8192
ds_read_b64_tr_b16 v[50:51], v18 offset:9216
v_mfma_f32_16x16x32_bf16 v[136:139], v[64:67], v[40:43], v[136:139]
buffer_load_dwordx4 v7, s[32:35], s51 offen offset:3072 lds
v_mfma_f32_16x16x32_bf16 v[140:143], v[64:67], v[44:47], v[140:143]
s_add_u32 m0, s53, s65
ds_read_b64_tr_b16 v[52:53], v19 offset:8192
v_mfma_f32_16x16x32_bf16 v[144:147], v[68:71], v[32:35], v[144:147]
ds_read_b128 v[64:67], v17 offset:0
s_add_u32 s58, s58, 1
v_mfma_f32_16x16x32_bf16 v[148:151], v[68:71], v[36:39], v[148:151]
buffer_load_dwordx4 v12, s[36:39], s52 offen offset:0  lds
v_mfma_f32_16x16x32_bf16 v[152:155], v[68:71], v[40:43], v[152:155]
ds_read_b64_tr_b16 v[54:55], v19 offset:9216
v_mfma_f32_16x16x32_bf16 v[156:159], v[68:71], v[44:47], v[156:159]
buffer_load_dwordx4 v13, s[36:39], s52 offen offset:1024  lds
s_waitcnt lgkmcnt(5)
v_mfma_f32_16x16x32_bf16 v[160:163], v[72:75], v[32:35], v[160:163]
ds_read_b128 v[68:71], v17 offset:2048
v_mfma_f32_16x16x32_bf16 v[164:167], v[72:75], v[36:39], v[164:167]
ds_read_b64_tr_b16 v[56:57], v20 offset:8192
v_mfma_f32_16x16x32_bf16 v[168:171], v[72:75], v[40:43], v[168:171]
buffer_load_dwordx4 v14, s[36:39], s52 offen offset:2048  lds
v_mfma_f32_16x16x32_bf16 v[172:175], v[72:75], v[44:47], v[172:175]
ds_read_b64_tr_b16 v[58:59], v20 offset:9216
ds_read_b64_tr_b16 v[60:61], v21 offset:8192
v_mfma_f32_16x16x32_bf16 v[176:179], v[76:79], v[32:35], v[176:179]
ds_read_b128 v[72:75], v17 offset:4096
ds_read_b64_tr_b16 v[62:63], v21 offset:9216
v_mfma_f32_16x16x32_bf16 v[180:183], v[76:79], v[36:39], v[180:183]
buffer_load_dwordx4 v15, s[36:39], s52 offen offset:3072  lds
v_mfma_f32_16x16x32_bf16 v[184:187], v[76:79], v[40:43], v[184:187]
s_add_u32 s57, s57, 32768
s_add_u32 s53, s53, 32768
s_add_u32 s52, s52, 0x80000
v_mfma_f32_16x16x32_bf16 v[188:191], v[76:79], v[44:47], v[188:191]
s_cmp_eq_u32 s57, 131072
s_cselect_b32 s57, 0, s57
s_waitcnt lgkmcnt(0)
v_mfma_f32_16x16x32_bf16 v[128:131], v[64:67], v[48:51], v[128:131]
ds_read_b128 v[76:79], v17 offset:6144
v_add_u32 v19, s57, v25
s_cmp_eq_u32 s53, 131072
s_cselect_b32 s53, 0, s53
v_mfma_f32_16x16x32_bf16 v[132:135], v[64:67], v[52:55], v[132:135]
v_add_u32 v16, s57, v22
v_add_u32 v20, s57, v26
v_mfma_f32_16x16x32_bf16 v[136:139], v[64:67], v[56:59], v[136:139]
v_add_u32 v18, s57, v24
v_add_u32 v21, s57, v27
v_mfma_f32_16x16x32_bf16 v[140:143], v[64:67], v[60:63], v[140:143]
s_waitcnt vmcnt(16) lgkmcnt(0)
s_barrier
v_mfma_f32_16x16x32_bf16 v[144:147], v[68:71], v[48:51], v[144:147]
ds_read_b64_tr_b16 v[32:33], v18 offset:0
s_add_u32 s54, s53, s64
v_mfma_f32_16x16x32_bf16 v[148:151], v[68:71], v[52:55], v[148:151]
ds_read_b64_tr_b16 v[34:35], v18 offset:1024
s_add_u32 s51, s51, 128
v_mfma_f32_16x16x32_bf16 v[152:155], v[68:71], v[56:59], v[152:155]
ds_read_b128 v[64:67], v16 offset:0
s_add_u32 s50, s50, 1
v_mfma_f32_16x16x32_bf16 v[156:159], v[68:71], v[60:63], v[156:159]
ds_read_b64_tr_b16 v[36:37], v19 offset:0
v_mfma_f32_16x16x32_bf16 v[160:163], v[72:75], v[48:51], v[160:163]
ds_read_b64_tr_b16 v[38:39], v19 offset:1024
s_cmp_eq_u32 s50, 16
s_cbranch_scc1 L_g_adv7_n
L_g_adv7_d:
v_mfma_f32_16x16x32_bf16 v[164:167], v[72:75], v[52:55], v[164:167]
ds_read_b64_tr_b16 v[40:41], v20 offset:0
s_add_u32 m0, s54, 0
v_mfma_f32_16x16x32_bf16 v[168:171], v[72:75], v[56:59], v[168:171]
ds_read_b64_tr_b16 v[42:43], v20 offset:1024
v_mfma_f32_16x16x32_bf16 v[172:175], v[72:75], v[60:63], v[172:175]
ds_read_b64_tr_b16 v[44:45], v21 offset:0
buffer_load_dwordx4 v4, s[32:35], s51 offen offset:0 lds
v_mfma_f32_16x16x32_bf16 v[176:179], v[76:79], v[48:51], v[176:179]
ds_read_b64_tr_b16 v[46:47], v21 offset:1024
ds_read_b128 v[68:71], v16 offset:2048
v_mfma_f32_16x16x32_bf16 v[180:183], v[76:79], v[52:55], v[180:183]
ds_read_b128 v[72:75], v16 offset:4096
v_mfma_f32_16x16x32_bf16 v[184:187], v[76:79], v[56:59], v[184:187]
v_add_u32 v17, s57, v23
buffer_load_dwordx4 v5, s[32:35], s51 offen offset:1024 lds
v_mfma_f32_16x16x32_bf16 v[188:191], v[76:79], v[60:63], v[188:191]
buffer_load_dwordx4 v6, s[32:35], s51 offen offset:2048 lds
s_bitcmp0_b32 0x11000, s58
s_cbranch_scc1 L_g_Vh_loop
s_cmp_eq_u32 s58, 16
s_cbranch_scc1 L_g_Vh_end
s_cmp_eq_u32 s59, 0
s_cbranch_scc0 L_g_Vh_loop
s_load_dwordx2 s[28:29], s[0:1], 112
s_waitcnt lgkmcnt(0)
s_mov_b32 s8, s28
s_mov_b32 s9, s29
s_mov_b32 s10, 0x100
s_mov_b32 s11, 0x20000
v_lshlrev_b32 v80, 2, v0
buffer_load_dword v81, v80, s[8:11], 0 offen sc1
s_branch L_g_Vh_loop
L_g_Vh_end:
s_cmp_eq_u32 s59, 0
s_cbranch_scc0 L_g_Vh_arr
s_branch L_arr_gemmVh_c
L_arr_gemmVh:
s_load_dwordx2 s[28:29], s[0:1], 112
s_waitcnt lgkmcnt(0)
s_mov_b32 s8, s28
s_mov_b32 s9, s29
s_mov_b32 s10, 0x100
s_mov_b32 s11, 0x20000
v_lshlrev_b32 v80, 2, v0
buffer_load_dword v81, v80, s[8:11], 0 offen sc1
s_waitcnt vmcnt(0)
L_arr_gemmVh_c:
v_readlane_b32 s18, v81, 1
v_readlane_b32 s19, v81, 9
v_readlane_b32 s20, v81, 17
v_readlane_b32 s21, v81, 25
v_readlane_b32 s22, v81, 33
v_readlane_b32 s23, v81, 41
v_readlane_b32 s24, v81, 49
v_readlane_b32 s25, v81, 57
s_add_u32 s18, s18, s19
s_add_u32 s18, s18, s20
s_add_u32 s18, s18, s21
s_add_u32 s18, s18, s22
s_add_u32 s18, s18, s23
s_add_u32 s18, s18, s24
s_add_u32 s18, s18, s25
s_and_b32 s19, s18, 0xfff
s_cmp_eq_u32 s19, 256
s_cbranch_scc1 L_arr_gemmVh_ok
s_sub_u32 s15, s15, 1
s_cbranch_scc1 L_exit
s_sleep 4
s_branch L_arr_gemmVh
L_arr_gemmVh_ok:
s_lshr_b32 s18, s18, 12
s_cmp_gt_u32 s18, 131072
s_cselect_b32 s99, 0x2000, 0
v_readlane_b32 s18, v81, 0
v_readlane_b32 s19, v81, 8
v_readlane_b32 s20, v81, 16
v_readlane_b32 s21, v81, 24
v_readlane_b32 s22, v81, 32
v_readlane_b32 s23, v81, 40
v_readlane_b32 s24, v81, 48
v_readlane_b32 s25, v81, 56
s_mov_b32 s14, 1
s_cmp_eq_u32 s18, 32
s_cselect_b32 s14, s14, 0
s_cmp_eq_u32 s19, 32
s_cselect_b32 s14, s14, 0
s_cmp_eq_u32 s20, 32
s_cselect_b32 s14, s14, 0
s_cmp_eq_u32 s21, 32
s_cselect_b32 s14, s14, 0
s_cmp_eq_u32 s22, 32
s_cselect_b32 s14, s14, 0
s_cmp_eq_u32 s23, 32
s_cselect_b32 s14, s14, 0
s_cmp_eq_u32 s24, 32
s_cselect_b32 s14, s14, 0
s_cmp_eq_u32 s25, 32
s_cselect_b32 s14, s14, 0
L_g_Vh_arr:
s_and_b32 s18, s55, 3
s_lshl_b32 s60, s18, 25
s_lshl_b32 s61, s18, 2
s_bfe_u32 s18, s55, 0x30002
s_lshl_b32 s19, s18, 22
s_add_u32 s60, s60, s19
s_lshl_b32 s19, s18, 10
s_add_u32 s61, s61, s19
s_bfe_u32 s18, s55, 0x50005
s_lshl_b32 s19, s18, 14
s_add_u32 s60, s60, s19
s_lshl_b32 s19, s18, 4
s_add_u32 s61, s61, s19
s_add_u32 s61, s61, 0x8180000
s_add_u32 s61, s61, s99
s_lshr_b32 s18, s55, 10
s_cmp_eq_u32 s18, 0
s_cselect_b32 s63, 3, s18
s_lshr_b32 s18, s18, 1
s_lshl_b32 s19, s18, 21
s_add_u32 s60, s60, s19
s_cmp_eq_u32 s63, 3
s_cselect_b32 s18, s49, s18
s_lshl_b32 s18, s18, 13
s_xor_b32 s18, s18, s99
s_add_u32 s60, s60, s18
s_lshl_b32 s18, s49, 20
v_subrev_u32 v30, s18, v28
v_cvt_pk_bf16_f32 v112, v128, v129
v_cvt_pk_bf16_f32 v113, v130, v131
v_cvt_pk_bf16_f32 v114, v144, v145
v_cvt_pk_bf16_f32 v115, v146, v147
buffer_store_dwordx4 v[112:115], v30, s[4:7], s60 offen offset:0 sc1
v_cvt_pk_bf16_f32 v116, v132, v133
v_cvt_pk_bf16_f32 v117, v134, v135
v_cvt_pk_bf16_f32 v118, v148, v149
v_cvt_pk_bf16_f32 v119, v150, v151
buffer_store_dwordx4 v[116:119], v30, s[4:7], s60 offen offset:1024 sc1
v_cvt_pk_bf16_f32 v120, v136, v137
v_cvt_pk_bf16_f32 v121, v138, v139
v_cvt_pk_bf16_f32 v122, v152, v153
v_cvt_pk_bf16_f32 v123, v154, v155
buffer_store_dwordx4 v[120:123], v30, s[4:7], s60 offen offset:2048 sc1
v_cvt_pk_bf16_f32 v124, v140, v141
v_cvt_pk_bf16_f32 v125, v142, v143
v_cvt_pk_bf16_f32 v126, v156, v157
v_cvt_pk_bf16_f32 v127, v158, v159
buffer_store_dwordx4 v[124:127], v30, s[4:7], s60 offen offset:3072 sc1
s_add_u32 s60, s60, 0x80000
v_cvt_pk_bf16_f32 v96, v160, v161
v_cvt_pk_bf16_f32 v97, v162, v163
v_cvt_pk_bf16_f32 v98, v176, v177
v_cvt_pk_bf16_f32 v99, v178, v179
buffer_store_dwordx4 v[96:99], v30, s[4:7], s60 offen offset:0 sc1
v_cvt_pk_bf16_f32 v100, v164, v165
v_cvt_pk_bf16_f32 v101, v166, v167
v_cvt_pk_bf16_f32 v102, v180, v181
v_cvt_pk_bf16_f32 v103, v182, v183
buffer_store_dwordx4 v[100:103], v30, s[4:7], s60 offen offset:1024 sc1
v_cvt_pk_bf16_f32 v104, v168, v169
v_cvt_pk_bf16_f32 v105, v170, v171
v_cvt_pk_bf16_f32 v106, v184, v185
v_cvt_pk_bf16_f32 v107, v186, v187
buffer_store_dwordx4 v[104:107], v30, s[4:7], s60 offen offset:2048 sc1
v_cvt_pk_bf16_f32 v108, v172, v173
v_cvt_pk_bf16_f32 v109, v174, v175
v_cvt_pk_bf16_f32 v110, v188, v189
v_cvt_pk_bf16_f32 v111, v190, v191
buffer_store_dwordx4 v[108:111], v30, s[4:7], s60 offen offset:3072 sc1
s_branch L_g_next
.p2align 6
L_g_K_first:
s_waitcnt lgkmcnt(1)
v_mfma_f32_16x16x32_bf16 v[128:131], v[32:35], v[64:67], 0
ds_read_b128 v[76:79], v16 offset:6144
v_mfma_f32_16x16x32_bf16 v[132:135], v[36:39], v[64:67], 0
ds_read_b64_tr_b16 v[48:49], v18 offset:8192
v_mfma_f32_16x16x32_bf16 v[136:139], v[40:43], v[64:67], 0
buffer_store_dwordx4 v[80:83], v28, s[4:7], s66 offen offset:0 sc1
v_mfma_f32_16x16x32_bf16 v[140:143], v[44:47], v[64:67], 0
ds_read_b64_tr_b16 v[50:51], v18 offset:9216
v_mfma_f32_16x16x32_bf16 v[144:147], v[32:35], v[68:71], 0
ds_read_b128 v[64:67], v16 offset:8192
v_mfma_f32_16x16x32_bf16 v[148:151], v[36:39], v[68:71], 0
buffer_load_dwordx4 v7, s[32:35], s51 offen offset:3072 lds
v_mfma_f32_16x16x32_bf16 v[152:155], v[40:43], v[68:71], 0
ds_read_b64_tr_b16 v[52:53], v19 offset:8192
v_mfma_f32_16x16x32_bf16 v[156:159], v[44:47], v[68:71], 0
buffer_store_dwordx4 v[84:87], v28, s[4:7], s66 offen offset:1024 sc1
s_waitcnt lgkmcnt(4)
v_mfma_f32_16x16x32_bf16 v[160:163], v[32:35], v[72:75], 0
ds_read_b128 v[68:71], v16 offset:10240
v_mfma_f32_16x16x32_bf16 v[164:167], v[36:39], v[72:75], 0
s_add_u32 m0, s54, 4096
v_mfma_f32_16x16x32_bf16 v[168:171], v[40:43], v[72:75], 0
buffer_load_dwordx4 v8, s[32:35], s51 offen offset:0 lds
v_mfma_f32_16x16x32_bf16 v[172:175], v[44:47], v[72:75], 0
ds_read_b64_tr_b16 v[54:55], v19 offset:9216
v_mfma_f32_16x16x32_bf16 v[176:179], v[32:35], v[76:79], 0
ds_read_b128 v[72:75], v16 offset:12288
v_mfma_f32_16x16x32_bf16 v[180:183], v[36:39], v[76:79], 0
buffer_store_dwordx4 v[88:91], v28, s[4:7], s66 offen offset:2048 sc1
v_mfma_f32_16x16x32_bf16 v[184:187], v[40:43], v[76:79], 0
ds_read_b64_tr_b16 v[56:57], v20 offset:8192
v_mfma_f32_16x16x32_bf16 v[188:191], v[44:47], v[76:79], 0
s_waitcnt lgkmcnt(3)
v_mfma_f32_16x16x32_bf16 v[192:195], v[32:35], v[64:67], 0
ds_read_b128 v[76:79], v16 offset:14336
v_mfma_f32_16x16x32_bf16 v[196:199], v[36:39], v[64:67], 0
buffer_load_dwordx4 v9, s[32:35], s51 offen offset:1024 lds
v_mfma_f32_16x16x32_bf16 v[200:203], v[40:43], v[64:67], 0
ds_read_b64_tr_b16 v[58:59], v20 offset:9216
ds_read_b64_tr_b16 v[60:61], v21 offset:8192
v_mfma_f32_16x16x32_bf16 v[204:207], v[44:47], v[64:67], 0
buffer_store_dwordx4 v[92:95], v28, s[4:7], s66 offen offset:3072 sc1
v_mfma_f32_16x16x32_bf16 v[208:211], v[32:35], v[68:71], 0
ds_read_b128 v[64:67], v17 offset:0
v_mfma_f32_16x16x32_bf16 v[212:215], v[36:39], v[68:71], 0
buffer_load_dwordx4 v10, s[32:35], s51 offen offset:2048 lds
v_mfma_f32_16x16x32_bf16 v[216:219], v[40:43], v[68:71], 0
ds_read_b64_tr_b16 v[62:63], v21 offset:9216
v_mfma_f32_16x16x32_bf16 v[220:223], v[44:47], v[68:71], 0
s_waitcnt lgkmcnt(4)
v_mfma_f32_16x16x32_bf16 v[224:227], v[32:35], v[72:75], 0
ds_read_b128 v[68:71], v17 offset:2048
v_mfma_f32_16x16x32_bf16 v[228:231], v[36:39], v[72:75], 0
buffer_store_dwordx4 v[96:99], v28, s[4:7], s67 offen offset:0 sc1
v_mfma_f32_16x16x32_bf16 v[232:235], v[40:43], v[72:75], 0
v_mfma_f32_16x16x32_bf16 v[236:239], v[44:47], v[72:75], 0
buffer_load_dwordx4 v11, s[32:35], s51 offen offset:3072 lds
v_mfma_f32_16x16x32_bf16 v[240:243], v[32:35], v[76:79], 0
ds_read_b128 v[72:75], v17 offset:4096
v_mfma_f32_16x16x32_bf16 v[244:247], v[36:39], v[76:79], 0
v_mfma_f32_16x16x32_bf16 v[248:251], v[40:43], v[76:79], 0
buffer_store_dwordx4 v[100:103], v28, s[4:7], s67 offen offset:1024 sc1
v_mfma_f32_16x16x32_bf16 v[252:255], v[44:47], v[76:79], 0
s_add_u32 m0, s53, s65
s_waitcnt lgkmcnt(1)
v_mfma_f32_16x16x32_bf16 v[128:131], v[48:51], v[64:67], v[128:131]
ds_read_b128 v[76:79], v17 offset:6144
v_mfma_f32_16x16x32_bf16 v[132:135], v[52:55], v[64:67], v[132:135]
buffer_load_dwordx4 v12, s[36:39], s52 offen offset:0  lds
v_mfma_f32_16x16x32_bf16 v[136:139], v[56:59], v[64:67], v[136:139]
s_add_u32 s57, s57, 49152
v_mfma_f32_16x16x32_bf16 v[140:143], v[60:63], v[64:67], v[140:143]
buffer_load_dwordx4 v13, s[36:39], s52 offen offset:1024  lds
v_mfma_f32_16x16x32_bf16 v[144:147], v[48:51], v[68:71], v[144:147]
ds_read_b128 v[64:67], v17 offset:8192
v_mfma_f32_16x16x32_bf16 v[148:151], v[52:55], v[68:71], v[148:151]
s_cmp_eq_u32 s57, 147456
s_cselect_b32 s57, 0, s57
v_mfma_f32_16x16x32_bf16 v[152:155], v[56:59], v[68:71], v[152:155]
buffer_load_dwordx4 v14, s[36:39], s52 offen offset:2048  lds
v_mfma_f32_16x16x32_bf16 v[156:159], v[60:63], v[68:71], v[156:159]
s_waitcnt lgkmcnt(1)
v_mfma_f32_16x16x32_bf16 v[160:163], v[48:51], v[72:75], v[160:163]
ds_read_b128 v[68:71], v17 offset:10240
v_mfma_f32_16x16x32_bf16 v[164:167], v[52:55], v[72:75], v[164:167]
buffer_load_dwordx4 v15, s[36:39], s52 offen offset:3072  lds
v_mfma_f32_16x16x32_bf16 v[168:171], v[56:59], v[72:75], v[168:171]
v_add_u32 v16, s57, v22
s_add_u32 s53, s53, 49152
v_mfma_f32_16x16x32_bf16 v[172:175], v[60:63], v[72:75], v[172:175]
v_add_u32 v18, s57, v24
s_add_u32 s51, s51, 128
v_mfma_f32_16x16x32_bf16 v[176:179], v[48:51], v[76:79], v[176:179]
ds_read_b128 v[72:75], v17 offset:12288
s_add_u32 s52, s52, 0x80000
v_mfma_f32_16x16x32_bf16 v[180:183], v[52:55], v[76:79], v[180:183]
v_add_u32 v19, s57, v25
s_add_u32 s50, s50, 1
v_mfma_f32_16x16x32_bf16 v[184:187], v[56:59], v[76:79], v[184:187]
v_add_u32 v20, s57, v26
v_mfma_f32_16x16x32_bf16 v[188:191], v[60:63], v[76:79], v[188:191]
s_waitcnt lgkmcnt(1)
v_mfma_f32_16x16x32_bf16 v[192:195], v[48:51], v[64:67], v[192:195]
ds_read_b128 v[76:79], v17 offset:14336
v_mfma_f32_16x16x32_bf16 v[196:199], v[52:55], v[64:67], v[196:199]
v_add_u32 v21, s57, v27
v_mfma_f32_16x16x32_bf16 v[200:203], v[56:59], v[64:67], v[200:203]
s_cmp_eq_u32 s53, 147456
s_cselect_b32 s53, 0, s53
v_mfma_f32_16x16x32_bf16 v[204:207], v[60:63], v[64:67], v[204:207]
s_waitcnt vmcnt(18) lgkmcnt(0)
s_barrier
v_mfma_f32_16x16x32_bf16 v[208:211], v[48:51], v[68:71], v[208:211]
ds_read_b64_tr_b16 v[32:33], v18 offset:0
s_add_u32 s54, s53, s64
v_mfma_f32_16x16x32_bf16 v[212:215], v[52:55], v[68:71], v[212:215]
ds_read_b64_tr_b16 v[34:35], v18 offset:1024
s_cmp_eq_u32 s50, 16
s_cbranch_scc1 L_g_adv8_n
L_g_adv8_d:
v_mfma_f32_16x16x32_bf16 v[216:219], v[56:59], v[68:71], v[216:219]
ds_read_b128 v[64:67], v16 offset:0
s_add_u32 m0, s54, 0
v_mfma_f32_16x16x32_bf16 v[220:223], v[60:63], v[68:71], v[220:223]
ds_read_b64_tr_b16 v[36:37], v19 offset:0
v_mfma_f32_16x16x32_bf16 v[224:227], v[48:51], v[72:75], v[224:227]
ds_read_b64_tr_b16 v[38:39], v19 offset:1024
v_mfma_f32_16x16x32_bf16 v[228:231], v[52:55], v[72:75], v[228:231]
ds_read_b64_tr_b16 v[40:41], v20 offset:0
v_mfma_f32_16x16x32_bf16 v[232:235], v[56:59], v[72:75], v[232:235]
ds_read_b64_tr_b16 v[42:43], v20 offset:1024
v_mfma_f32_16x16x32_bf16 v[236:239], v[60:63], v[72:75], v[236:239]
ds_read_b64_tr_b16 v[44:45], v21 offset:0
buffer_load_dwordx4 v4, s[32:35], s51 offen offset:0 lds
v_mfma_f32_16x16x32_bf16 v[240:243], v[48:51], v[76:79], v[240:243]
ds_read_b64_tr_b16 v[46:47], v21 offset:1024
ds_read_b128 v[68:71], v16 offset:2048
v_mfma_f32_16x16x32_bf16 v[244:247], v[52:55], v[76:79], v[244:247]
ds_read_b128 v[72:75], v16 offset:4096
v_mfma_f32_16x16x32_bf16 v[248:251], v[56:59], v[76:79], v[248:251]
v_add_u32 v17, s57, v23
buffer_load_dwordx4 v5, s[32:35], s51 offen offset:1024 lds
v_mfma_f32_16x16x32_bf16 v[252:255], v[60:63], v[76:79], v[252:255]
buffer_load_dwordx4 v6, s[32:35], s51 offen offset:2048 lds
s_waitcnt lgkmcnt(1)
v_mfma_f32_16x16x32_bf16 v[128:131], v[32:35], v[64:67], v[128:131]
ds_read_b128 v[76:79], v16 offset:6144
v_mfma_f32_16x16x32_bf16 v[132:135], v[36:39], v[64:67], v[132:135]
ds_read_b64_tr_b16 v[48:49], v18 offset:8192
v_mfma_f32_16x16x32_bf16 v[136:139], v[40:43], v[64:67], v[136:139]
buffer_store_dwordx4 v[104:107], v28, s[4:7], s67 offen offset:2048 sc1
v_mfma_f32_16x16x32_bf16 v[140:143], v[44:47], v[64:67], v[140:143]
ds_read_b64_tr_b16 v[50:51], v18 offset:9216
v_mfma_f32_16x16x32_bf16 v[144:147], v[32:35], v[68:71], v[144:147]
ds_read_b128 v[64:67], v16 offset:8192
v_mfma_f32_16x16x32_bf16 v[148:151], v[36:39], v[68:71], v[148:151]
buffer_load_dwordx4 v7, s[32:35], s51 offen offset:3072 lds
v_mfma_f32_16x16x32_bf16 v[152:155], v[40:43], v[68:71], v[152:155]
ds_read_b64_tr_b16 v[52:53], v19 offset:8192
v_mfma_f32_16x16x32_bf16 v[156:159], v[44:47], v[68:71], v[156:159]
buffer_store_dwordx4 v[108:111], v28, s[4:7], s67 offen offset:3072 sc1
s_waitcnt lgkmcnt(4)
v_mfma_f32_16x16x32_bf16 v[160:163], v[32:35], v[72:75], v[160:163]
ds_read_b128 v[68:71], v16 offset:10240
v_mfma_f32_16x16x32_bf16 v[164:167], v[36:39], v[72:75], v[164:167]
s_add_u32 m0, s54, 4096
v_mfma_f32_16x16x32_bf16 v[168:171], v[40:43], v[72:75], v[168:171]
buffer_load_dwordx4 v8, s[32:35], s51 offen offset:0 lds
v_mfma_f32_16x16x32_bf16 v[172:175], v[44:47], v[72:75], v[172:175]
ds_read_b64_tr_b16 v[54:55], v19 offset:9216
v_mfma_f32_16x16x32_bf16 v[176:179], v[32:35], v[76:79], v[176:179]
ds_read_b128 v[72:75], v16 offset:12288
v_mfma_f32_16x16x32_bf16 v[180:183], v[36:39], v[76:79], v[180:183]
buffer_store_dwordx4 v[112:115], v28, s[4:7], s68 offen offset:0 sc1
v_mfma_f32_16x16x32_bf16 v[184:187], v[40:43], v[76:79], v[184:187]
ds_read_b64_tr_b16 v[56:57], v20 offset:8192
v_mfma_f32_16x16x32_bf16 v[188:191], v[44:47], v[76:79], v[188:191]
s_waitcnt lgkmcnt(3)
v_mfma_f32_16x16x32_bf16 v[192:195], v[32:35], v[64:67], v[192:195]
ds_read_b128 v[76:79], v16 offset:14336
v_mfma_f32_16x16x32_bf16 v[196:199], v[36:39], v[64:67], v[196:199]
buffer_load_dwordx4 v9, s[32:35], s51 offen offset:1024 lds
v_mfma_f32_16x16x32_bf16 v[200:203], v[40:43], v[64:67], v[200:203]
ds_read_b64_tr_b16 v[58:59], v20 offset:9216
ds_read_b64_tr_b16 v[60:61], v21 offset:8192
v_mfma_f32_16x16x32_bf16 v[204:207], v[44:47], v[64:67], v[204:207]
buffer_store_dwordx4 v[116:119], v28, s[4:7], s68 offen offset:1024 sc1
v_mfma_f32_16x16x32_bf16 v[208:211], v[32:35], v[68:71], v[208:211]
ds_read_b128 v[64:67], v17 offset:0
v_mfma_f32_16x16x32_bf16 v[212:215], v[36:39], v[68:71], v[212:215]
buffer_load_dwordx4 v10, s[32:35], s51 offen offset:2048 lds
v_mfma_f32_16x16x32_bf16 v[216:219], v[40:43], v[68:71], v[216:219]
ds_read_b64_tr_b16 v[62:63], v21 offset:9216
v_mfma_f32_16x16x32_bf16 v[220:223], v[44:47], v[68:71], v[220:223]
s_waitcnt lgkmcnt(4)
v_mfma_f32_16x16x32_bf16 v[224:227], v[32:35], v[72:75], v[224:227]
ds_read_b128 v[68:71], v17 offset:2048
v_mfma_f32_16x16x32_bf16 v[228:231], v[36:39], v[72:75], v[228:231]
buffer_store_dwordx4 v[120:123], v28, s[4:7], s68 offen offset:2048 sc1
v_mfma_f32_16x16x32_bf16 v[232:235], v[40:43], v[72:75], v[232:235]
v_mfma_f32_16x16x32_bf16 v[236:239], v[44:47], v[72:75], v[236:239]
buffer_load_dwordx4 v11, s[32:35], s51 offen offset:3072 lds
v_mfma_f32_16x16x32_bf16 v[240:243], v[32:35], v[76:79], v[240:243]
ds_read_b128 v[72:75], v17 offset:4096
v_mfma_f32_16x16x32_bf16 v[244:247], v[36:39], v[76:79], v[244:247]
v_mfma_f32_16x16x32_bf16 v[248:251], v[40:43], v[76:79], v[248:251]
buffer_store_dwordx4 v[124:127], v28, s[4:7], s68 offen offset:3072 sc1
v_mfma_f32_16x16x32_bf16 v[252:255], v[44:47], v[76:79], v[252:255]
s_add_u32 m0, s53, s65
s_waitcnt lgkmcnt(1)
v_mfma_f32_16x16x32_bf16 v[128:131], v[48:51], v[64:67], v[128:131]
ds_read_b128 v[76:79], v17 offset:6144
v_mfma_f32_16x16x32_bf16 v[132:135], v[52:55], v[64:67], v[132:135]
buffer_load_dwordx4 v12, s[36:39], s52 offen offset:0  lds
v_mfma_f32_16x16x32_bf16 v[136:139], v[56:59], v[64:67], v[136:139]
s_add_u32 s57, s57, 49152
v_mfma_f32_16x16x32_bf16 v[140:143], v[60:63], v[64:67], v[140:143]
buffer_load_dwordx4 v13, s[36:39], s52 offen offset:1024  lds
v_mfma_f32_16x16x32_bf16 v[144:147], v[48:51], v[68:71], v[144:147]
ds_read_b128 v[64:67], v17 offset:8192
v_mfma_f32_16x16x32_bf16 v[148:151], v[52:55], v[68:71], v[148:151]
s_cmp_eq_u32 s57, 147456
s_cselect_b32 s57, 0, s57
v_mfma_f32_16x16x32_bf16 v[152:155], v[56:59], v[68:71], v[152:155]
buffer_load_dwordx4 v14, s[36:39], s52 offen offset:2048  lds
v_mfma_f32_16x16x32_bf16 v[156:159], v[60:63], v[68:71], v[156:159]
s_waitcnt lgkmcnt(1)
v_mfma_f32_16x16x32_bf16 v[160:163], v[48:51], v[72:75], v[160:163]
ds_read_b128 v[68:71], v17 offset:10240
v_mfma_f32_16x16x32_bf16 v[164:167], v[52:55], v[72:75], v[164:167]
buffer_load_dwordx4 v15, s[36:39], s52 offen offset:3072  lds
v_mfma_f32_16x16x32_bf16 v[168:171], v[56:59], v[72:75], v[168:171]
v_add_u32 v16, s57, v22
s_add_u32 s53, s53, 49152
v_mfma_f32_16x16x32_bf16 v[172:175], v[60:63], v[72:75], v[172:175]
v_add_u32 v18, s57, v24
s_add_u32 s51, s51, 128
v_mfma_f32_16x16x32_bf16 v[176:179], v[48:51], v[76:79], v[176:179]
ds_read_b128 v[72:75], v17 offset:12288
s_add_u32 s52, s52, 0x80000
v_mfma_f32_16x16x32_bf16 v[180:183], v[52:55], v[76:79], v[180:183]
v_add_u32 v19, s57, v25
s_add_u32 s50, s50, 1
v_mfma_f32_16x16x32_bf16 v[184:187], v[56:59], v[76:79], v[184:187]
v_add_u32 v20, s57, v26
v_mfma_f32_16x16x32_bf16 v[188:191], v[60:63], v[76:79], v[188:191]
s_waitcnt lgkmcnt(1)
v_mfma_f32_16x16x32_bf16 v[192:195], v[48:51], v[64:67], v[192:195]
ds_read_b128 v[76:79], v17 offset:14336
v_mfma_f32_16x16x32_bf16 v[196:199], v[52:55], v[64:67], v[196:199]
v_add_u32 v21, s57, v27
v_mfma_f32_16x16x32_bf16 v[200:203], v[56:59], v[64:67], v[200:203]
s_cmp_eq_u32 s53, 147456
s_cselect_b32 s53, 0, s53
v_mfma_f32_16x16x32_bf16 v[204:207], v[60:63], v[64:67], v[204:207]
s_waitcnt vmcnt(18) lgkmcnt(0)
s_barrier
v_mfma_f32_16x16x32_bf16 v[208:211], v[48:51], v[68:71], v[208:211]
ds_read_b64_tr_b16 v[32:33], v18 offset:0
s_add_u32 s54, s53, s64
v_mfma_f32_16x16x32_bf16 v[212:215], v[52:55], v[68:71], v[212:215]
ds_read_b64_tr_b16 v[34:35], v18 offset:1024
s_cmp_eq_u32 s50, 16
s_cbranch_scc1 L_g_adv9_n
L_g_adv9_d:
v_mfma_f32_16x16x32_bf16 v[216:219], v[56:59], v[68:71], v[216:219]
ds_read_b128 v[64:67], v16 offset:0
s_add_u32 m0, s54, 0
v_mfma_f32_16x16x32_bf16 v[220:223], v[60:63], v[68:71], v[220:223]
ds_read_b64_tr_b16 v[36:37], v19 offset:0
v_mfma_f32_16x16x32_bf16 v[224:227], v[48:51], v[72:75], v[224:227]
ds_read_b64_tr_b16 v[38:39], v19 offset:1024
v_mfma_f32_16x16x32_bf16 v[228:231], v[52:55], v[72:75], v[228:231]
ds_read_b64_tr_b16 v[40:41], v20 offset:0
v_mfma_f32_16x16x32_bf16 v[232:235], v[56:59], v[72:75], v[232:235]
ds_read_b64_tr_b16 v[42:43], v20 offset:1024
v_mfma_f32_16x16x32_bf16 v[236:239], v[60:63], v[72:75], v[236:239]
ds_read_b64_tr_b16 v[44:45], v21 offset:0
buffer_load_dwordx4 v4, s[32:35], s51 offen offset:0 lds
v_mfma_f32_16x16x32_bf16 v[240:243], v[48:51], v[76:79], v[240:243]
ds_read_b64_tr_b16 v[46:47], v21 offset:1024
ds_read_b128 v[68:71], v16 offset:2048
v_mfma_f32_16x16x32_bf16 v[244:247], v[52:55], v[76:79], v[244:247]
ds_read_b128 v[72:75], v16 offset:4096
v_mfma_f32_16x16x32_bf16 v[248:251], v[56:59], v[76:79], v[248:251]
v_add_u32 v17, s57, v23
buffer_load_dwordx4 v5, s[32:35], s51 offen offset:1024 lds
v_mfma_f32_16x16x32_bf16 v[252:255], v[60:63], v[76:79], v[252:255]
buffer_load_dwordx4 v6, s[32:35], s51 offen offset:2048 lds
s_mov_b32 s58, 2
.p2align 6
L_g_K_loop:
s_waitcnt lgkmcnt(1)
v_mfma_f32_16x16x32_bf16 v[128:131], v[32:35], v[64:67], v[128:131]
ds_read_b128 v[76:79], v16 offset:6144
v_mfma_f32_16x16x32_bf16 v[132:135], v[36:39], v[64:67], v[132:135]
ds_read_b64_tr_b16 v[48:49], v18 offset:8192
v_mfma_f32_16x16x32_bf16 v[136:139], v[40:43], v[64:67], v[136:139]
buffer_load_dwordx4 v7, s[32:35], s51 offen offset:3072 lds
v_mfma_f32_16x16x32_bf16 v[140:143], v[44:47], v[64:67], v[140:143]
s_add_u32 m0, s54, 4096
v_mfma_f32_16x16x32_bf16 v[144:147], v[32:35], v[68:71], v[144:147]
ds_read_b128 v[64:67], v16 offset:8192
v_mfma_f32_16x16x32_bf16 v[148:151], v[36:39], v[68:71], v[148:151]
ds_read_b64_tr_b16 v[50:51], v18 offset:9216
v_mfma_f32_16x16x32_bf16 v[152:155], v[40:43], v[68:71], v[152:155]
buffer_load_dwordx4 v8, s[32:35], s51 offen offset:0 lds
v_mfma_f32_16x16x32_bf16 v[156:159], v[44:47], v[68:71], v[156:159]
s_waitcnt lgkmcnt(3)
v_mfma_f32_16x16x32_bf16 v[160:163], v[32:35], v[72:75], v[160:163]
ds_read_b128 v[68:71], v16 offset:10240
v_mfma_f32_16x16x32_bf16 v[164:167], v[36:39], v[72:75], v[164:167]
ds_read_b64_tr_b16 v[52:53], v19 offset:8192
v_mfma_f32_16x16x32_bf16 v[168:171], v[40:43], v[72:75], v[168:171]
ds_read_b64_tr_b16 v[54:55], v19 offset:9216
v_mfma_f32_16x16x32_bf16 v[172:175], v[44:47], v[72:75], v[172:175]
buffer_load_dwordx4 v9, s[32:35], s51 offen offset:1024 lds
v_mfma_f32_16x16x32_bf16 v[176:179], v[32:35], v[76:79], v[176:179]
ds_read_b128 v[72:75], v16 offset:12288
v_mfma_f32_16x16x32_bf16 v[180:183], v[36:39], v[76:79], v[180:183]
ds_read_b64_tr_b16 v[56:57], v20 offset:8192
v_mfma_f32_16x16x32_bf16 v[184:187], v[40:43], v[76:79], v[184:187]
s_add_u32 s58, s58, 1
v_mfma_f32_16x16x32_bf16 v[188:191], v[44:47], v[76:79], v[188:191]
s_waitcnt lgkmcnt(4)
v_mfma_f32_16x16x32_bf16 v[192:195], v[32:35], v[64:67], v[192:195]
ds_read_b128 v[76:79], v16 offset:14336
v_mfma_f32_16x16x32_bf16 v[196:199], v[36:39], v[64:67], v[196:199]
buffer_load_dwordx4 v10, s[32:35], s51 offen offset:2048 lds
v_mfma_f32_16x16x32_bf16 v[200:203], v[40:43], v[64:67], v[200:203]
ds_read_b64_tr_b16 v[58:59], v20 offset:9216
v_mfma_f32_16x16x32_bf16 v[204:207], v[44:47], v[64:67], v[204:207]
ds_read_b64_tr_b16 v[60:61], v21 offset:8192
v_mfma_f32_16x16x32_bf16 v[208:211], v[32:35], v[68:71], v[208:211]
ds_read_b128 v[64:67], v17 offset:0
v_mfma_f32_16x16x32_bf16 v[212:215], v[36:39], v[68:71], v[212:215]
buffer_load_dwordx4 v11, s[32:35], s51 offen offset:3072 lds
v_mfma_f32_16x16x32_bf16 v[216:219], v[40:43], v[68:71], v[216:219]
s_add_u32 m0, s53, s65
ds_read_b64_tr_b16 v[62:63], v21 offset:9216
v_mfma_f32_16x16x32_bf16 v[220:223], v[44:47], v[68:71], v[220:223]
s_waitcnt lgkmcnt(4)
v_mfma_f32_16x16x32_bf16 v[224:227], v[32:35], v[72:75], v[224:227]
ds_read_b128 v[68:71], v17 offset:2048
v_mfma_f32_16x16x32_bf16 v[228:231], v[36:39], v[72:75], v[228:231]
buffer_load_dwordx4 v12, s[36:39], s52 offen offset:0  lds
v_mfma_f32_16x16x32_bf16 v[232:235], v[40:43], v[72:75], v[232:235]
v_mfma_f32_16x16x32_bf16 v[236:239], v[44:47], v[72:75], v[236:239]
v_mfma_f32_16x16x32_bf16 v[240:243], v[32:35], v[76:79], v[240:243]
ds_read_b128 v[72:75], v17 offset:4096
v_mfma_f32_16x16x32_bf16 v[244:247], v[36:39], v[76:79], v[244:247]
v_mfma_f32_16x16x32_bf16 v[248:251], v[40:43], v[76:79], v[248:251]
buffer_load_dwordx4 v13, s[36:39], s52 offen offset:1024  lds
v_mfma_f32_16x16x32_bf16 v[252:255], v[44:47], v[76:79], v[252:255]
s_waitcnt lgkmcnt(1)
v_mfma_f32_16x16x32_bf16 v[128:131], v[48:51], v[64:67], v[128:131]
ds_read_b128 v[76:79], v17 offset:6144
v_mfma_f32_16x16x32_bf16 v[132:135], v[52:55], v[64:67], v[132:135]
s_add_u32 s57, s57, 49152
v_mfma_f32_16x16x32_bf16 v[136:139], v[56:59], v[64:67], v[136:139]
buffer_load_dwordx4 v14, s[36:39], s52 offen offset:2048  lds
v_mfma_f32_16x16x32_bf16 v[140:143], v[60:63], v[64:67], v[140:143]
s_cmp_eq_u32 s57, 147456
s_cselect_b32 s57, 0, s57
v_mfma_f32_16x16x32_bf16 v[144:147], v[48:51], v[68:71], v[144:147]
ds_read_b128 v[64:67], v17 offset:8192
v_mfma_f32_16x16x32_bf16 v[148:151], v[52:55], v[68:71], v[148:151]
v_add_u32 v16, s57, v22
v_mfma_f32_16x16x32_bf16 v[152:155], v[56:59], v[68:71], v[152:155]
v_add_u32 v18, s57, v24
v_mfma_f32_16x16x32_bf16 v[156:159], v[60:63], v[68:71], v[156:159]
buffer_load_dwordx4 v15, s[36:39], s52 offen offset:3072  lds
s_waitcnt lgkmcnt(1)
v_mfma_f32_16x16x32_bf16 v[160:163], v[48:51], v[72:75], v[160:163]
ds_read_b128 v[68:71], v17 offset:10240
s_add_u32 s52, s52, 0x80000
v_mfma_f32_16x16x32_bf16 v[164:167], v[52:55], v[72:75], v[164:167]
v_add_u32 v19, s57, v25
s_add_u32 s50, s50, 1
v_mfma_f32_16x16x32_bf16 v[168:171], v[56:59], v[72:75], v[168:171]
v_add_u32 v20, s57, v26
v_mfma_f32_16x16x32_bf16 v[172:175], v[60:63], v[72:75], v[172:175]
v_add_u32 v21, s57, v27
v_mfma_f32_16x16x32_bf16 v[176:179], v[48:51], v[76:79], v[176:179]
ds_read_b128 v[72:75], v17 offset:12288
v_mfma_f32_16x16x32_bf16 v[180:183], v[52:55], v[76:79], v[180:183]
s_add_u32 s53, s53, 49152
v_mfma_f32_16x16x32_bf16 v[184:187], v[56:59], v[76:79], v[184:187]
s_cmp_eq_u32 s53, 147456
s_cselect_b32 s53, 0, s53
v_mfma_f32_16x16x32_bf16 v[188:191], v[60:63], v[76:79], v[188:191]
s_waitcnt lgkmcnt(1)
v_mfma_f32_16x16x32_bf16 v[192:195], v[48:51], v[64:67], v[192:195]
ds_read_b128 v[76:79], v17 offset:14336
v_mfma_f32_16x16x32_bf16 v[196:199], v[52:55], v[64:67], v[196:199]
s_add_u32 s54, s53, s64
v_mfma_f32_16x16x32_bf16 v[200:203], v[56:59], v[64:67], v[200:203]
s_add_u32 s51, s51, 128
v_mfma_f32_16x16x32_bf16 v[204:207], v[60:63], v[64:67], v[204:207]
s_waitcnt vmcnt(12) lgkmcnt(0)
s_barrier
v_mfma_f32_16x16x32_bf16 v[208:211], v[48:51], v[68:71], v[208:211]
ds_read_b64_tr_b16 v[32:33], v18 offset:0
s_cmp_eq_u32 s50, 16
s_cbranch_scc1 L_g_adv10_n
L_g_adv10_d:
v_mfma_f32_16x16x32_bf16 v[212:215], v[52:55], v[68:71], v[212:215]
ds_read_b64_tr_b16 v[34:35], v18 offset:1024
s_add_u32 m0, s54, 0
v_mfma_f32_16x16x32_bf16 v[216:219], v[56:59], v[68:71], v[216:219]
ds_read_b128 v[64:67], v16 offset:0
v_mfma_f32_16x16x32_bf16 v[220:223], v[60:63], v[68:71], v[220:223]
ds_read_b64_tr_b16 v[36:37], v19 offset:0
v_mfma_f32_16x16x32_bf16 v[224:227], v[48:51], v[72:75], v[224:227]
ds_read_b64_tr_b16 v[38:39], v19 offset:1024
v_mfma_f32_16x16x32_bf16 v[228:231], v[52:55], v[72:75], v[228:231]
ds_read_b64_tr_b16 v[40:41], v20 offset:0
v_mfma_f32_16x16x32_bf16 v[232:235], v[56:59], v[72:75], v[232:235]
ds_read_b64_tr_b16 v[42:43], v20 offset:1024
v_mfma_f32_16x16x32_bf16 v[236:239], v[60:63], v[72:75], v[236:239]
ds_read_b64_tr_b16 v[44:45], v21 offset:0
buffer_load_dwordx4 v4, s[32:35], s51 offen offset:0 lds
v_mfma_f32_16x16x32_bf16 v[240:243], v[48:51], v[76:79], v[240:243]
ds_read_b64_tr_b16 v[46:47], v21 offset:1024
ds_read_b128 v[68:71], v16 offset:2048
v_mfma_f32_16x16x32_bf16 v[244:247], v[52:55], v[76:79], v[244:247]
ds_read_b128 v[72:75], v16 offset:4096
v_mfma_f32_16x16x32_bf16 v[248:251], v[56:59], v[76:79], v[248:251]
v_add_u32 v17, s57, v23
buffer_load_dwordx4 v5, s[32:35], s51 offen offset:1024 lds
v_mfma_f32_16x16x32_bf16 v[252:255], v[60:63], v[76:79], v[252:255]
buffer_load_dwordx4 v6, s[32:35], s51 offen offset:2048 lds
s_bitcmp0_b32 0x10008, s58
s_cbranch_scc1 L_g_K_loop
s_cmp_eq_u32 s58, 16
s_cbranch_scc1 L_g_K_end
s_cmp_eq_u32 s59, 0
s_cbranch_scc1 L_g_K_nf
s_cmp_eq_u32 s12, 0
s_cbranch_scc0 L_g_K_nf
s_mov_b32 exec_lo, s63
s_mov_b32 exec_hi, 0
buffer_store_dword v29, v2, s[4:7], s61 offen sc1
s_mov_b64 exec, -1
L_g_K_nf:
s_branch L_g_K_loop
L_g_K_end:
s_and_b32 s18, s55, 3
s_lshl_b32 s60, s18, 25
s_lshl_b32 s61, s18, 2
s_bfe_u32 s18, s55, 0x30002
s_lshl_b32 s19, s18, 22
s_add_u32 s60, s60, s19
s_lshl_b32 s19, s18, 10
s_add_u32 s61, s61, s19
s_bfe_u32 s18, s55, 0x50005
s_lshl_b32 s19, s18, 14
s_add_u32 s60, s60, s19
s_lshl_b32 s19, s18, 4
s_add_u32 s61, s61, s19
s_add_u32 s61, s61, 0x8180000
s_add_u32 s61, s61, s99
s_lshr_b32 s18, s55, 10
s_cmp_eq_u32 s18, 0
s_cselect_b32 s63, 3, s18
s_lshr_b32 s18, s18, 1
s_lshl_b32 s19, s18, 21
s_add_u32 s60, s60, s19
s_cmp_eq_u32 s63, 3
s_cselect_b32 s18, s49, s18
s_lshl_b32 s18, s18, 13
s_xor_b32 s18, s18, s99
s_add_u32 s60, s60, s18
v_cvt_pk_bf16_f32 v112, v128, v132
v_cvt_pk_bf16_f32 v113, v129, v133
v_cvt_pk_bf16_f32 v114, v130, v134
v_cvt_pk_bf16_f32 v115, v131, v135
buffer_store_dwordx4 v[112:115], v28, s[4:7], s60 offen offset:0 sc1
v_cvt_pk_bf16_f32 v116, v144, v148
v_cvt_pk_bf16_f32 v117, v145, v149
v_cvt_pk_bf16_f32 v118, v146, v150
v_cvt_pk_bf16_f32 v119, v147, v151
buffer_store_dwordx4 v[116:119], v28, s[4:7], s60 offen offset:1024 sc1
v_cvt_pk_bf16_f32 v120, v136, v140
v_cvt_pk_bf16_f32 v121, v137, v141
v_cvt_pk_bf16_f32 v122, v138, v142
v_cvt_pk_bf16_f32 v123, v139, v143
buffer_store_dwordx4 v[120:123], v28, s[4:7], s60 offen offset:2048 sc1
v_cvt_pk_bf16_f32 v124, v152, v156
v_cvt_pk_bf16_f32 v125, v153, v157
v_cvt_pk_bf16_f32 v126, v154, v158
v_cvt_pk_bf16_f32 v127, v155, v159
buffer_store_dwordx4 v[124:127], v28, s[4:7], s60 offen offset:3072 sc1
s_add_u32 s66, s60, 0x80000
v_cvt_pk_bf16_f32 v80, v160, v164
v_cvt_pk_bf16_f32 v81, v161, v165
v_cvt_pk_bf16_f32 v82, v162, v166
v_cvt_pk_bf16_f32 v83, v163, v167
v_cvt_pk_bf16_f32 v84, v176, v180
v_cvt_pk_bf16_f32 v85, v177, v181
v_cvt_pk_bf16_f32 v86, v178, v182
v_cvt_pk_bf16_f32 v87, v179, v183
v_cvt_pk_bf16_f32 v88, v168, v172
v_cvt_pk_bf16_f32 v89, v169, v173
v_cvt_pk_bf16_f32 v90, v170, v174
v_cvt_pk_bf16_f32 v91, v171, v175
v_cvt_pk_bf16_f32 v92, v184, v188
v_cvt_pk_bf16_f32 v93, v185, v189
v_cvt_pk_bf16_f32 v94, v186, v190
v_cvt_pk_bf16_f32 v95, v187, v191
s_add_u32 s67, s60, 0x100000
v_cvt_pk_bf16_f32 v96, v192, v196
v_cvt_pk_bf16_f32 v97, v193, v197
v_cvt_pk_bf16_f32 v98, v194, v198
v_cvt_pk_bf16_f32 v99, v195, v199
v_cvt_pk_bf16_f32 v100, v208, v212
v_cvt_pk_bf16_f32 v101, v209, v213
v_cvt_pk_bf16_f32 v102, v210, v214
v_cvt_pk_bf16_f32 v103, v211, v215
v_cvt_pk_bf16_f32 v104, v200, v204
v_cvt_pk_bf16_f32 v105, v201, v205
v_cvt_pk_bf16_f32 v106, v202, v206
v_cvt_pk_bf16_f32 v107, v203, v207
v_cvt_pk_bf16_f32 v108, v216, v220
v_cvt_pk_bf16_f32 v109, v217, v221
v_cvt_pk_bf16_f32 v110, v218, v222
v_cvt_pk_bf16_f32 v111, v219, v223
s_add_u32 s68, s60, 0x180000
v_cvt_pk_bf16_f32 v112, v224, v228
v_cvt_pk_bf16_f32 v113, v225, v229
v_cvt_pk_bf16_f32 v114, v226, v230
v_cvt_pk_bf16_f32 v115, v227, v231
v_cvt_pk_bf16_f32 v116, v240, v244
v_cvt_pk_bf16_f32 v117, v241, v245
v_cvt_pk_bf16_f32 v118, v242, v246
v_cvt_pk_bf16_f32 v119, v243, v247
v_cvt_pk_bf16_f32 v120, v232, v236
v_cvt_pk_bf16_f32 v121, v233, v237
v_cvt_pk_bf16_f32 v122, v234, v238
v_cvt_pk_bf16_f32 v123, v235, v239
v_cvt_pk_bf16_f32 v124, v248, v252
v_cvt_pk_bf16_f32 v125, v249, v253
v_cvt_pk_bf16_f32 v126, v250, v254
v_cvt_pk_bf16_f32 v127, v251, v255
s_branch L_g_next
.p2align 6
L_g_V_first:
s_waitcnt lgkmcnt(1)
v_mfma_f32_16x16x32_bf16 v[128:131], v[64:67], v[32:35], 0
ds_read_b128 v[76:79], v16 offset:6144
v_mfma_f32_16x16x32_bf16 v[132:135], v[64:67], v[36:39], 0
ds_read_b64_tr_b16 v[48:49], v18 offset:8192
v_mfma_f32_16x16x32_bf16 v[136:139], v[64:67], v[40:43], 0
buffer_store_dwordx4 v[80:83], v28, s[4:7], s66 offen offset:0 sc1
v_mfma_f32_16x16x32_bf16 v[140:143], v[64:67], v[44:47], 0
ds_read_b64_tr_b16 v[50:51], v18 offset:9216
v_mfma_f32_16x16x32_bf16 v[144:147], v[68:71], v[32:35], 0
ds_read_b128 v[64:67], v16 offset:8192
v_mfma_f32_16x16x32_bf16 v[148:151], v[68:71], v[36:39], 0
buffer_load_dwordx4 v7, s[32:35], s51 offen offset:3072 lds
v_mfma_f32_16x16x32_bf16 v[152:155], v[68:71], v[40:43], 0
ds_read_b64_tr_b16 v[52:53], v19 offset:8192
v_mfma_f32_16x16x32_bf16 v[156:159], v[68:71], v[44:47], 0
buffer_store_dwordx4 v[84:87], v28, s[4:7], s66 offen offset:1024 sc1
s_waitcnt lgkmcnt(4)
v_mfma_f32_16x16x32_bf16 v[160:163], v[72:75], v[32:35], 0
ds_read_b128 v[68:71], v16 offset:10240
v_mfma_f32_16x16x32_bf16 v[164:167], v[72:75], v[36:39], 0
s_add_u32 m0, s54, 4096
v_mfma_f32_16x16x32_bf16 v[168:171], v[72:75], v[40:43], 0
buffer_load_dwordx4 v8, s[32:35], s51 offen offset:0 lds
v_mfma_f32_16x16x32_bf16 v[172:175], v[72:75], v[44:47], 0
ds_read_b64_tr_b16 v[54:55], v19 offset:9216
v_mfma_f32_16x16x32_bf16 v[176:179], v[76:79], v[32:35], 0
ds_read_b128 v[72:75], v16 offset:12288
v_mfma_f32_16x16x32_bf16 v[180:183], v[76:79], v[36:39], 0
buffer_store_dwordx4 v[88:91], v28, s[4:7], s66 offen offset:2048 sc1
v_mfma_f32_16x16x32_bf16 v[184:187], v[76:79], v[40:43], 0
ds_read_b64_tr_b16 v[56:57], v20 offset:8192
v_mfma_f32_16x16x32_bf16 v[188:191], v[76:79], v[44:47], 0
s_waitcnt lgkmcnt(3)
v_mfma_f32_16x16x32_bf16 v[192:195], v[64:67], v[32:35], 0
ds_read_b128 v[76:79], v16 offset:14336
v_mfma_f32_16x16x32_bf16 v[196:199], v[64:67], v[36:39], 0
buffer_load_dwordx4 v9, s[32:35], s51 offen offset:1024 lds
v_mfma_f32_16x16x32_bf16 v[200:203], v[64:67], v[40:43], 0
ds_read_b64_tr_b16 v[58:59], v20 offset:9216
ds_read_b64_tr_b16 v[60:61], v21 offset:8192
v_mfma_f32_16x16x32_bf16 v[204:207], v[64:67], v[44:47], 0
buffer_store_dwordx4 v[92:95], v28, s[4:7], s66 offen offset:3072 sc1
v_mfma_f32_16x16x32_bf16 v[208:211], v[68:71], v[32:35], 0
ds_read_b128 v[64:67], v17 offset:0
v_mfma_f32_16x16x32_bf16 v[212:215], v[68:71], v[36:39], 0
buffer_load_dwordx4 v10, s[32:35], s51 offen offset:2048 lds
v_mfma_f32_16x16x32_bf16 v[216:219], v[68:71], v[40:43], 0
ds_read_b64_tr_b16 v[62:63], v21 offset:9216
v_mfma_f32_16x16x32_bf16 v[220:223], v[68:71], v[44:47], 0
s_waitcnt lgkmcnt(4)
v_mfma_f32_16x16x32_bf16 v[224:227], v[72:75], v[32:35], 0
ds_read_b128 v[68:71], v17 offset:2048
v_mfma_f32_16x16x32_bf16 v[228:231], v[72:75], v[36:39], 0
buffer_store_dwordx4 v[96:99], v28, s[4:7], s67 offen offset:0 sc1
v_mfma_f32_16x16x32_bf16 v[232:235], v[72:75], v[40:43], 0
v_mfma_f32_16x16x32_bf16 v[236:239], v[72:75], v[44:47], 0
buffer_load_dwordx4 v11, s[32:35], s51 offen offset:3072 lds
v_mfma_f32_16x16x32_bf16 v[240:243], v[76:79], v[32:35], 0
ds_read_b128 v[72:75], v17 offset:4096
v_mfma_f32_16x16x32_bf16 v[244:247], v[76:79], v[36:39], 0
v_mfma_f32_16x16x32_bf16 v[248:251], v[76:79], v[40:43], 0
buffer_store_dwordx4 v[100:103], v28, s[4:7], s67 offen offset:1024 sc1
v_mfma_f32_16x16x32_bf16 v[252:255], v[76:79], v[44:47], 0
s_add_u32 m0, s53, s65
s_waitcnt lgkmcnt(1)
v_mfma_f32_16x16x32_bf16 v[128:131], v[64:67], v[48:51], v[128:131]
ds_read_b128 v[76:79], v17 offset:6144
v_mfma_f32_16x16x32_bf16 v[132:135], v[64:67], v[52:55], v[132:135]
buffer_load_dwordx4 v12, s[36:39], s52 offen offset:0  lds
v_mfma_f32_16x16x32_bf16 v[136:139], v[64:67], v[56:59], v[136:139]
s_add_u32 s57, s57, 49152
v_mfma_f32_16x16x32_bf16 v[140:143], v[64:67], v[60:63], v[140:143]
buffer_load_dwordx4 v13, s[36:39], s52 offen offset:1024  lds
v_mfma_f32_16x16x32_bf16 v[144:147], v[68:71], v[48:51], v[144:147]
ds_read_b128 v[64:67], v17 offset:8192
v_mfma_f32_16x16x32_bf16 v[148:151], v[68:71], v[52:55], v[148:151]
s_cmp_eq_u32 s57, 147456
s_cselect_b32 s57, 0, s57
v_mfma_f32_16x16x32_bf16 v[152:155], v[68:71], v[56:59], v[152:155]
buffer_load_dwordx4 v14, s[36:39], s52 offen offset:2048  lds
v_mfma_f32_16x16x32_bf16 v[156:159], v[68:71], v[60:63], v[156:159]
s_waitcnt lgkmcnt(1)
v_mfma_f32_16x16x32_bf16 v[160:163], v[72:75], v[48:51], v[160:163]
ds_read_b128 v[68:71], v17 offset:10240
v_mfma_f32_16x16x32_bf16 v[164:167], v[72:75], v[52:55], v[164:167]
buffer_load_dwordx4 v15, s[36:39], s52 offen offset:3072  lds
v_mfma_f32_16x16x32_bf16 v[168:171], v[72:75], v[56:59], v[168:171]
v_add_u32 v16, s57, v22
s_add_u32 s53, s53, 49152
v_mfma_f32_16x16x32_bf16 v[172:175], v[72:75], v[60:63], v[172:175]
v_add_u32 v18, s57, v24
s_add_u32 s51, s51, 128
v_mfma_f32_16x16x32_bf16 v[176:179], v[76:79], v[48:51], v[176:179]
ds_read_b128 v[72:75], v17 offset:12288
s_add_u32 s52, s52, 0x80000
v_mfma_f32_16x16x32_bf16 v[180:183], v[76:79], v[52:55], v[180:183]
v_add_u32 v19, s57, v25
s_add_u32 s50, s50, 1
v_mfma_f32_16x16x32_bf16 v[184:187], v[76:79], v[56:59], v[184:187]
v_add_u32 v20, s57, v26
v_mfma_f32_16x16x32_bf16 v[188:191], v[76:79], v[60:63], v[188:191]
s_waitcnt lgkmcnt(1)
v_mfma_f32_16x16x32_bf16 v[192:195], v[64:67], v[48:51], v[192:195]
ds_read_b128 v[76:79], v17 offset:14336
v_mfma_f32_16x16x32_bf16 v[196:199], v[64:67], v[52:55], v[196:199]
v_add_u32 v21, s57, v27
v_mfma_f32_16x16x32_bf16 v[200:203], v[64:67], v[56:59], v[200:203]
s_cmp_eq_u32 s53, 147456
s_cselect_b32 s53, 0, s53
v_mfma_f32_16x16x32_bf16 v[204:207], v[64:67], v[60:63], v[204:207]
s_waitcnt vmcnt(18) lgkmcnt(0)
s_barrier
v_mfma_f32_16x16x32_bf16 v[208:211], v[68:71], v[48:51], v[208:211]
ds_read_b64_tr_b16 v[32:33], v18 offset:0
s_add_u32 s54, s53, s64
v_mfma_f32_16x16x32_bf16 v[212:215], v[68:71], v[52:55], v[212:215]
ds_read_b64_tr_b16 v[34:35], v18 offset:1024
s_cmp_eq_u32 s50, 16
s_cbranch_scc1 L_g_adv11_n
L_g_adv11_d:
v_mfma_f32_16x16x32_bf16 v[216:219], v[68:71], v[56:59], v[216:219]
ds_read_b128 v[64:67], v16 offset:0
s_add_u32 m0, s54, 0
v_mfma_f32_16x16x32_bf16 v[220:223], v[68:71], v[60:63], v[220:223]
ds_read_b64_tr_b16 v[36:37], v19 offset:0
v_mfma_f32_16x16x32_bf16 v[224:227], v[72:75], v[48:51], v[224:227]
ds_read_b64_tr_b16 v[38:39], v19 offset:1024
v_mfma_f32_16x16x32_bf16 v[228:231], v[72:75], v[52:55], v[228:231]
ds_read_b64_tr_b16 v[40:41], v20 offset:0
v_mfma_f32_16x16x32_bf16 v[232:235], v[72:75], v[56:59], v[232:235]
ds_read_b64_tr_b16 v[42:43], v20 offset:1024
v_mfma_f32_16x16x32_bf16 v[236:239], v[72:75], v[60:63], v[236:239]
ds_read_b64_tr_b16 v[44:45], v21 offset:0
buffer_load_dwordx4 v4, s[32:35], s51 offen offset:0 lds
v_mfma_f32_16x16x32_bf16 v[240:243], v[76:79], v[48:51], v[240:243]
ds_read_b64_tr_b16 v[46:47], v21 offset:1024
ds_read_b128 v[68:71], v16 offset:2048
v_mfma_f32_16x16x32_bf16 v[244:247], v[76:79], v[52:55], v[244:247]
ds_read_b128 v[72:75], v16 offset:4096
v_mfma_f32_16x16x32_bf16 v[248:251], v[76:79], v[56:59], v[248:251]
v_add_u32 v17, s57, v23
buffer_load_dwordx4 v5, s[32:35], s51 offen offset:1024 lds
v_mfma_f32_16x16x32_bf16 v[252:255], v[76:79], v[60:63], v[252:255]
buffer_load_dwordx4 v6, s[32:35], s51 offen offset:2048 lds
s_waitcnt lgkmcnt(1)
v_mfma_f32_16x16x32_bf16 v[128:131], v[64:67], v[32:35], v[128:131]
ds_read_b128 v[76:79], v16 offset:6144
v_mfma_f32_16x16x32_bf16 v[132:135], v[64:67], v[36:39], v[132:135]
ds_read_b64_tr_b16 v[48:49], v18 offset:8192
v_mfma_f32_16x16x32_bf16 v[136:139], v[64:67], v[40:43], v[136:139]
buffer_store_dwordx4 v[104:107], v28, s[4:7], s67 offen offset:2048 sc1
v_mfma_f32_16x16x32_bf16 v[140:143], v[64:67], v[44:47], v[140:143]
ds_read_b64_tr_b16 v[50:51], v18 offset:9216
v_mfma_f32_16x16x32_bf16 v[144:147], v[68:71], v[32:35], v[144:147]
ds_read_b128 v[64:67], v16 offset:8192
v_mfma_f32_16x16x32_bf16 v[148:151], v[68:71], v[36:39], v[148:151]
buffer_load_dwordx4 v7, s[32:35], s51 offen offset:3072 lds
v_mfma_f32_16x16x32_bf16 v[152:155], v[68:71], v[40:43], v[152:155]
ds_read_b64_tr_b16 v[52:53], v19 offset:8192
v_mfma_f32_16x16x32_bf16 v[156:159], v[68:71], v[44:47], v[156:159]
buffer_store_dwordx4 v[108:111], v28, s[4:7], s67 offen offset:3072 sc1
s_waitcnt lgkmcnt(4)
v_mfma_f32_16x16x32_bf16 v[160:163], v[72:75], v[32:35], v[160:163]
ds_read_b128 v[68:71], v16 offset:10240
v_mfma_f32_16x16x32_bf16 v[164:167], v[72:75], v[36:39], v[164:167]
s_add_u32 m0, s54, 4096
v_mfma_f32_16x16x32_bf16 v[168:171], v[72:75], v[40:43], v[168:171]
buffer_load_dwordx4 v8, s[32:35], s51 offen offset:0 lds
v_mfma_f32_16x16x32_bf16 v[172:175], v[72:75], v[44:47], v[172:175]
ds_read_b64_tr_b16 v[54:55], v19 offset:9216
v_mfma_f32_16x16x32_bf16 v[176:179], v[76:79], v[32:35], v[176:179]
ds_read_b128 v[72:75], v16 offset:12288
v_mfma_f32_16x16x32_bf16 v[180:183], v[76:79], v[36:39], v[180:183]
buffer_store_dwordx4 v[112:115], v28, s[4:7], s68 offen offset:0 sc1
v_mfma_f32_16x16x32_bf16 v[184:187], v[76:79], v[40:43], v[184:187]
ds_read_b64_tr_b16 v[56:57], v20 offset:8192
v_mfma_f32_16x16x32_bf16 v[188:191], v[76:79], v[44:47], v[188:191]
s_waitcnt lgkmcnt(3)
v_mfma_f32_16x16x32_bf16 v[192:195], v[64:67], v[32:35], v[192:195]
ds_read_b128 v[76:79], v16 offset:14336
v_mfma_f32_16x16x32_bf16 v[196:199], v[64:67], v[36:39], v[196:199]
buffer_load_dwordx4 v9, s[32:35], s51 offen offset:1024 lds
v_mfma_f32_16x16x32_bf16 v[200:203], v[64:67], v[40:43], v[200:203]
ds_read_b64_tr_b16 v[58:59], v20 offset:9216
ds_read_b64_tr_b16 v[60:61], v21 offset:8192
v_mfma_f32_16x16x32_bf16 v[204:207], v[64:67], v[44:47], v[204:207]
buffer_store_dwordx4 v[116:119], v28, s[4:7], s68 offen offset:1024 sc1
v_mfma_f32_16x16x32_bf16 v[208:211], v[68:71], v[32:35], v[208:211]
ds_read_b128 v[64:67], v17 offset:0
v_mfma_f32_16x16x32_bf16 v[212:215], v[68:71], v[36:39], v[212:215]
buffer_load_dwordx4 v10, s[32:35], s51 offen offset:2048 lds
v_mfma_f32_16x16x32_bf16 v[216:219], v[68:71], v[40:43], v[216:219]
ds_read_b64_tr_b16 v[62:63], v21 offset:9216
v_mfma_f32_16x16x32_bf16 v[220:223], v[68:71], v[44:47], v[220:223]
s_waitcnt lgkmcnt(4)
v_mfma_f32_16x16x32_bf16 v[224:227], v[72:75], v[32:35], v[224:227]
ds_read_b128 v[68:71], v17 offset:2048
v_mfma_f32_16x16x32_bf16 v[228:231], v[72:75], v[36:39], v[228:231]
buffer_store_dwordx4 v[120:123], v28, s[4:7], s68 offen offset:2048 sc1
v_mfma_f32_16x16x32_bf16 v[232:235], v[72:75], v[40:43], v[232:235]
v_mfma_f32_16x16x32_bf16 v[236:239], v[72:75], v[44:47], v[236:239]
buffer_load_dwordx4 v11, s[32:35], s51 offen offset:3072 lds
v_mfma_f32_16x16x32_bf16 v[240:243], v[76:79], v[32:35], v[240:243]
ds_read_b128 v[72:75], v17 offset:4096
v_mfma_f32_16x16x32_bf16 v[244:247], v[76:79], v[36:39], v[244:247]
v_mfma_f32_16x16x32_bf16 v[248:251], v[76:79], v[40:43], v[248:251]
buffer_store_dwordx4 v[124:127], v28, s[4:7], s68 offen offset:3072 sc1
v_mfma_f32_16x16x32_bf16 v[252:255], v[76:79], v[44:47], v[252:255]
s_add_u32 m0, s53, s65
s_waitcnt lgkmcnt(1)
v_mfma_f32_16x16x32_bf16 v[128:131], v[64:67], v[48:51], v[128:131]
ds_read_b128 v[76:79], v17 offset:6144
v_mfma_f32_16x16x32_bf16 v[132:135], v[64:67], v[52:55], v[132:135]
buffer_load_dwordx4 v12, s[36:39], s52 offen offset:0  lds
v_mfma_f32_16x16x32_bf16 v[136:139], v[64:67], v[56:59], v[136:139]
s_add_u32 s57, s57, 49152
v_mfma_f32_16x16x32_bf16 v[140:143], v[64:67], v[60:63], v[140:143]
buffer_load_dwordx4 v13, s[36:39], s52 offen offset:1024  lds
v_mfma_f32_16x16x32_bf16 v[144:147], v[68:71], v[48:51], v[144:147]
ds_read_b128 v[64:67], v17 offset:8192
v_mfma_f32_16x16x32_bf16 v[148:151], v[68:71], v[52:55], v[148:151]
s_cmp_eq_u32 s57, 147456
s_cselect_b32 s57, 0, s57
v_mfma_f32_16x16x32_bf16 v[152:155], v[68:71], v[56:59], v[152:155]
buffer_load_dwordx4 v14, s[36:39], s52 offen offset:2048  lds
v_mfma_f32_16x16x32_bf16 v[156:159], v[68:71], v[60:63], v[156:159]
s_waitcnt lgkmcnt(1)
v_mfma_f32_16x16x32_bf16 v[160:163], v[72:75], v[48:51], v[160:163]
ds_read_b128 v[68:71], v17 offset:10240
v_mfma_f32_16x16x32_bf16 v[164:167], v[72:75], v[52:55], v[164:167]
buffer_load_dwordx4 v15, s[36:39], s52 offen offset:3072  lds
v_mfma_f32_16x16x32_bf16 v[168:171], v[72:75], v[56:59], v[168:171]
v_add_u32 v16, s57, v22
s_add_u32 s53, s53, 49152
v_mfma_f32_16x16x32_bf16 v[172:175], v[72:75], v[60:63], v[172:175]
v_add_u32 v18, s57, v24
s_add_u32 s51, s51, 128
v_mfma_f32_16x16x32_bf16 v[176:179], v[76:79], v[48:51], v[176:179]
ds_read_b128 v[72:75], v17 offset:12288
s_add_u32 s52, s52, 0x80000
v_mfma_f32_16x16x32_bf16 v[180:183], v[76:79], v[52:55], v[180:183]
v_add_u32 v19, s57, v25
s_add_u32 s50, s50, 1
v_mfma_f32_16x16x32_bf16 v[184:187], v[76:79], v[56:59], v[184:187]
v_add_u32 v20, s57, v26
v_mfma_f32_16x16x32_bf16 v[188:191], v[76:79], v[60:63], v[188:191]
s_waitcnt lgkmcnt(1)
v_mfma_f32_16x16x32_bf16 v[192:195], v[64:67], v[48:51], v[192:195]
ds_read_b128 v[76:79], v17 offset:14336
v_mfma_f32_16x16x32_bf16 v[196:199], v[64:67], v[52:55], v[196:199]
v_add_u32 v21, s57, v27
v_mfma_f32_16x16x32_bf16 v[200:203], v[64:67], v[56:59], v[200:203]
s_cmp_eq_u32 s53, 147456
s_cselect_b32 s53, 0, s53
v_mfma_f32_16x16x32_bf16 v[204:207], v[64:67], v[60:63], v[204:207]
s_waitcnt vmcnt(18) lgkmcnt(0)
s_barrier
v_mfma_f32_16x16x32_bf16 v[208:211], v[68:71], v[48:51], v[208:211]
ds_read_b64_tr_b16 v[32:33], v18 offset:0
s_add_u32 s54, s53, s64
v_mfma_f32_16x16x32_bf16 v[212:215], v[68:71], v[52:55], v[212:215]
ds_read_b64_tr_b16 v[34:35], v18 offset:1024
s_cmp_eq_u32 s50, 16
s_cbranch_scc1 L_g_adv12_n
L_g_adv12_d:
v_mfma_f32_16x16x32_bf16 v[216:219], v[68:71], v[56:59], v[216:219]
ds_read_b128 v[64:67], v16 offset:0
s_add_u32 m0, s54, 0
v_mfma_f32_16x16x32_bf16 v[220:223], v[68:71], v[60:63], v[220:223]
ds_read_b64_tr_b16 v[36:37], v19 offset:0
v_mfma_f32_16x16x32_bf16 v[224:227], v[72:75], v[48:51], v[224:227]
ds_read_b64_tr_b16 v[38:39], v19 offset:1024
v_mfma_f32_16x16x32_bf16 v[228:231], v[72:75], v[52:55], v[228:231]
ds_read_b64_tr_b16 v[40:41], v20 offset:0
v_mfma_f32_16x16x32_bf16 v[232:235], v[72:75], v[56:59], v[232:235]
ds_read_b64_tr_b16 v[42:43], v20 offset:1024
v_mfma_f32_16x16x32_bf16 v[236:239], v[72:75], v[60:63], v[236:239]
ds_read_b64_tr_b16 v[44:45], v21 offset:0
buffer_load_dwordx4 v4, s[32:35], s51 offen offset:0 lds
v_mfma_f32_16x16x32_bf16 v[240:243], v[76:79], v[48:51], v[240:243]
ds_read_b64_tr_b16 v[46:47], v21 offset:1024
ds_read_b128 v[68:71], v16 offset:2048
v_mfma_f32_16x16x32_bf16 v[244:247], v[76:79], v[52:55], v[244:247]
ds_read_b128 v[72:75], v16 offset:4096
v_mfma_f32_16x16x32_bf16 v[248:251], v[76:79], v[56:59], v[248:251]
v_add_u32 v17, s57, v23
buffer_load_dwordx4 v5, s[32:35], s51 offen offset:1024 lds
v_mfma_f32_16x16x32_bf16 v[252:255], v[76:79], v[60:63], v[252:255]
buffer_load_dwordx4 v6, s[32:35], s51 offen offset:2048 lds
s_mov_b32 s58, 2
.p2align 6
L_g_V_loop:
s_waitcnt lgkmcnt(1)
v_mfma_f32_16x16x32_bf16 v[128:131], v[64:67], v[32:35], v[128:131]
ds_read_b128 v[76:79], v16 offset:6144
v_mfma_f32_16x16x32_bf16 v[132:135], v[64:67], v[36:39], v[132:135]
ds_read_b64_tr_b16 v[48:49], v18 offset:8192
v_mfma_f32_16x16x32_bf16 v[136:139], v[64:67], v[40:43], v[136:139]
buffer_load_dwordx4 v7, s[32:35], s51 offen offset:3072 lds
v_mfma_f32_16x16x32_bf16 v[140:143], v[64:67], v[44:47], v[140:143]
s_add_u32 m0, s54, 4096
v_mfma_f32_16x16x32_bf16 v[144:147], v[68:71], v[32:35], v[144:147]
ds_read_b128 v[64:67], v16 offset:8192
v_mfma_f32_16x16x32_bf16 v[148:151], v[68:71], v[36:39], v[148:151]
ds_read_b64_tr_b16 v[50:51], v18 offset:9216
v_mfma_f32_16x16x32_bf16 v[152:155], v[68:71], v[40:43], v[152:155]
buffer_load_dwordx4 v8, s[32:35], s51 offen offset:0 lds
v_mfma_f32_16x16x32_bf16 v[156:159], v[68:71], v[44:47], v[156:159]
s_waitcnt lgkmcnt(3)
v_mfma_f32_16x16x32_bf16 v[160:163], v[72:75], v[32:35], v[160:163]
ds_read_b128 v[68:71], v16 offset:10240
v_mfma_f32_16x16x32_bf16 v[164:167], v[72:75], v[36:39], v[164:167]
ds_read_b64_tr_b16 v[52:53], v19 offset:8192
v_mfma_f32_16x16x32_bf16 v[168:171], v[72:75], v[40:43], v[168:171]
ds_read_b64_tr_b16 v[54:55], v19 offset:9216
v_mfma_f32_16x16x32_bf16 v[172:175], v[72:75], v[44:47], v[172:175]
buffer_load_dwordx4 v9, s[32:35], s51 offen offset:1024 lds
v_mfma_f32_16x16x32_bf16 v[176:179], v[76:79], v[32:35], v[176:179]
ds_read_b128 v[72:75], v16 offset:12288
v_mfma_f32_16x16x32_bf16 v[180:183], v[76:79], v[36:39], v[180:183]
ds_read_b64_tr_b16 v[56:57], v20 offset:8192
v_mfma_f32_16x16x32_bf16 v[184:187], v[76:79], v[40:43], v[184:187]
s_add_u32 s58, s58, 1
v_mfma_f32_16x16x32_bf16 v[188:191], v[76:79], v[44:47], v[188:191]
s_waitcnt lgkmcnt(4)
v_mfma_f32_16x16x32_bf16 v[192:195], v[64:67], v[32:35], v[192:195]
ds_read_b128 v[76:79], v16 offset:14336
v_mfma_f32_16x16x32_bf16 v[196:199], v[64:67], v[36:39], v[196:199]
buffer_load_dwordx4 v10, s[32:35], s51 offen offset:2048 lds
v_mfma_f32_16x16x32_bf16 v[200:203], v[64:67], v[40:43], v[200:203]
ds_read_b64_tr_b16 v[58:59], v20 offset:9216
v_mfma_f32_16x16x32_bf16 v[204:207], v[64:67], v[44:47], v[204:207]
ds_read_b64_tr_b16 v[60:61], v21 offset:8192
v_mfma_f32_16x16x32_bf16 v[208:211], v[68:71], v[32:35], v[208:211]
ds_read_b128 v[64:67], v17 offset:0
v_mfma_f32_16x16x32_bf16 v[212:215], v[68:71], v[36:39], v[212:215]
buffer_load_dwordx4 v11, s[32:35], s51 offen offset:3072 lds
v_mfma_f32_16x16x32_bf16 v[216:219], v[68:71], v[40:43], v[216:219]
s_add_u32 m0, s53, s65
ds_read_b64_tr_b16 v[62:63], v21 offset:9216
v_mfma_f32_16x16x32_bf16 v[220:223], v[68:71], v[44:47], v[220:223]
s_waitcnt lgkmcnt(4)
v_mfma_f32_16x16x32_bf16 v[224:227], v[72:75], v[32:35], v[224:227]
ds_read_b128 v[68:71], v17 offset:2048
v_mfma_f32_16x16x32_bf16 v[228:231], v[72:75], v[36:39], v[228:231]
buffer_load_dwordx4 v12, s[36:39], s52 offen offset:0  lds
v_mfma_f32_16x16x32_bf16 v[232:235], v[72:75], v[40:43], v[232:235]
v_mfma_f32_16x16x32_bf16 v[236:239], v[72:75], v[44:47], v[236:239]
v_mfma_f32_16x16x32_bf16 v[240:243], v[76:79], v[32:35], v[240:243]
ds_read_b128 v[72:75], v17 offset:4096
v_mfma_f32_16x16x32_bf16 v[244:247], v[76:79], v[36:39], v[244:247]
v_mfma_f32_16x16x32_bf16 v[248:251], v[76:79], v[40:43], v[248:251]
buffer_load_dwordx4 v13, s[36:39], s52 offen offset:1024  lds
v_mfma_f32_16x16x32_bf16 v[252:255], v[76:79], v[44:47], v[252:255]
s_waitcnt lgkmcnt(1)
v_mfma_f32_16x16x32_bf16 v[128:131], v[64:67], v[48:51], v[128:131]
ds_read_b128 v[76:79], v17 offset:6144
v_mfma_f32_16x16x32_bf16 v[132:135], v[64:67], v[52:55], v[132:135]
s_add_u32 s57, s57, 49152
v_mfma_f32_16x16x32_bf16 v[136:139], v[64:67], v[56:59], v[136:139]
buffer_load_dwordx4 v14, s[36:39], s52 offen offset:2048  lds
v_mfma_f32_16x16x32_bf16 v[140:143], v[64:67], v[60:63], v[140:143]
s_cmp_eq_u32 s57, 147456
s_cselect_b32 s57, 0, s57
v_mfma_f32_16x16x32_bf16 v[144:147], v[68:71], v[48:51], v[144:147]
ds_read_b128 v[64:67], v17 offset:8192
v_mfma_f32_16x16x32_bf16 v[148:151], v[68:71], v[52:55], v[148:151]
v_add_u32 v16, s57, v22
v_mfma_f32_16x16x32_bf16 v[152:155], v[68:71], v[56:59], v[152:155]
v_add_u32 v18, s57, v24
v_mfma_f32_16x16x32_bf16 v[156:159], v[68:71], v[60:63], v[156:159]
buffer_load_dwordx4 v15, s[36:39], s52 offen offset:3072  lds
s_waitcnt lgkmcnt(1)
v_mfma_f32_16x16x32_bf16 v[160:163], v[72:75], v[48:51], v[160:163]
ds_read_b128 v[68:71], v17 offset:10240
s_add_u32 s52, s52, 0x80000
v_mfma_f32_16x16x32_bf16 v[164:167], v[72:75], v[52:55], v[164:167]
v_add_u32 v19, s57, v25
s_add_u32 s50, s50, 1
v_mfma_f32_16x16x32_bf16 v[168:171], v[72:75], v[56:59], v[168:171]
v_add_u32 v20, s57, v26
v_mfma_f32_16x16x32_bf16 v[172:175], v[72:75], v[60:63], v[172:175]
v_add_u32 v21, s57, v27
v_mfma_f32_16x16x32_bf16 v[176:179], v[76:79], v[48:51], v[176:179]
ds_read_b128 v[72:75], v17 offset:12288
v_mfma_f32_16x16x32_bf16 v[180:183], v[76:79], v[52:55], v[180:183]
s_add_u32 s53, s53, 49152
v_mfma_f32_16x16x32_bf16 v[184:187], v[76:79], v[56:59], v[184:187]
s_cmp_eq_u32 s53, 147456
s_cselect_b32 s53, 0, s53
v_mfma_f32_16x16x32_bf16 v[188:191], v[76:79], v[60:63], v[188:191]
s_waitcnt lgkmcnt(1)
v_mfma_f32_16x16x32_bf16 v[192:195], v[64:67], v[48:51], v[192:195]
ds_read_b128 v[76:79], v17 offset:14336
v_mfma_f32_16x16x32_bf16 v[196:199], v[64:67], v[52:55], v[196:199]
s_add_u32 s54, s53, s64
v_mfma_f32_16x16x32_bf16 v[200:203], v[64:67], v[56:59], v[200:203]
s_add_u32 s51, s51, 128
v_mfma_f32_16x16x32_bf16 v[204:207], v[64:67], v[60:63], v[204:207]
s_waitcnt vmcnt(12) lgkmcnt(0)
s_barrier
v_mfma_f32_16x16x32_bf16 v[208:211], v[68:71], v[48:51], v[208:211]
ds_read_b64_tr_b16 v[32:33], v18 offset:0
s_cmp_eq_u32 s50, 16
s_cbranch_scc1 L_g_adv13_n
L_g_adv13_d:
v_mfma_f32_16x16x32_bf16 v[212:215], v[68:71], v[52:55], v[212:215]
ds_read_b64_tr_b16 v[34:35], v18 offset:1024
s_add_u32 m0, s54, 0
v_mfma_f32_16x16x32_bf16 v[216:219], v[68:71], v[56:59], v[216:219]
ds_read_b128 v[64:67], v16 offset:0
v_mfma_f32_16x16x32_bf16 v[220:223], v[68:71], v[60:63], v[220:223]
ds_read_b64_tr_b16 v[36:37], v19 offset:0
v_mfma_f32_16x16x32_bf16 v[224:227], v[72:75], v[48:51], v[224:227]
ds_read_b64_tr_b16 v[38:39], v19 offset:1024
v_mfma_f32_16x16x32_bf16 v[228:231], v[72:75], v[52:55], v[228:231]
ds_read_b64_tr_b16 v[40:41], v20 offset:0
v_mfma_f32_16x16x32_bf16 v[232:235], v[72:75], v[56:59], v[232:235]
ds_read_b64_tr_b16 v[42:43], v20 offset:1024
v_mfma_f32_16x16x32_bf16 v[236:239], v[72:75], v[60:63], v[236:239]
ds_read_b64_tr_b16 v[44:45], v21 offset:0
buffer_load_dwordx4 v4, s[32:35], s51 offen offset:0 lds
v_mfma_f32_16x16x32_bf16 v[240:243], v[76:79], v[48:51], v[240:243]
ds_read_b64_tr_b16 v[46:47], v21 offset:1024
ds_read_b128 v[68:71], v16 offset:2048
v_mfma_f32_16x16x32_bf16 v[244:247], v[76:79], v[52:55], v[244:247]
ds_read_b128 v[72:75], v16 offset:4096
v_mfma_f32_16x16x32_bf16 v[248:251], v[76:79], v[56:59], v[248:251]
v_add_u32 v17, s57, v23
buffer_load_dwordx4 v5, s[32:35], s51 offen offset:1024 lds
v_mfma_f32_16x16x32_bf16 v[252:255], v[76:79], v[60:63], v[252:255]
buffer_load_dwordx4 v6, s[32:35], s51 offen offset:2048 lds
s_bitcmp0_b32 0x10008, s58
s_cbranch_scc1 L_g_V_loop
s_cmp_eq_u32 s58, 16
s_cbranch_scc1 L_g_V_end
s_cmp_eq_u32 s59, 0
s_cbranch_scc1 L_g_V_nf
s_cmp_eq_u32 s12, 0
s_cbranch_scc0 L_g_V_nf
s_mov_b32 exec_lo, s63
s_mov_b32 exec_hi, 0
buffer_store_dword v29, v2, s[4:7], s61 offen sc1
s_mov_b64 exec, -1
L_g_V_nf:
s_branch L_g_V_loop
L_g_V_end:
s_and_b32 s18, s55, 3
s_lshl_b32 s60, s18, 25
s_lshl_b32 s61, s18, 2
s_bfe_u32 s18, s55, 0x30002
s_lshl_b32 s19, s18, 22
s_add_u32 s60, s60, s19
s_lshl_b32 s19, s18, 10
s_add_u32 s61, s61, s19
s_bfe_u32 s18, s55, 0x50005
s_lshl_b32 s19, s18, 14
s_add_u32 s60, s60, s19
s_lshl_b32 s19, s18, 4
s_add_u32 s61, s61, s19
s_add_u32 s61, s61, 0x8180000
s_add_u32 s61, s61, s99
s_lshr_b32 s18, s55, 10
s_cmp_eq_u32 s18, 0
s_cselect_b32 s63, 3, s18
s_lshr_b32 s18, s18, 1
s_lshl_b32 s19, s18, 21
s_add_u32 s60, s60, s19
s_cmp_eq_u32 s63, 3
s_cselect_b32 s18, s49, s18
s_lshl_b32 s18, s18, 13
s_xor_b32 s18, s18, s99
s_add_u32 s60, s60, s18
v_cvt_pk_bf16_f32 v112, v128, v129
v_cvt_pk_bf16_f32 v113, v130, v131
v_cvt_pk_bf16_f32 v114, v144, v145
v_cvt_pk_bf16_f32 v115, v146, v147
buffer_store_dwordx4 v[112:115], v28, s[4:7], s60 offen offset:0 sc1
v_cvt_pk_bf16_f32 v116, v132, v133
v_cvt_pk_bf16_f32 v117, v134, v135
v_cvt_pk_bf16_f32 v118, v148, v149
v_cvt_pk_bf16_f32 v119, v150, v151
buffer_store_dwordx4 v[116:119], v28, s[4:7], s60 offen offset:1024 sc1
v_cvt_pk_bf16_f32 v120, v136, v137
v_cvt_pk_bf16_f32 v121, v138, v139
v_cvt_pk_bf16_f32 v122, v152, v153
v_cvt_pk_bf16_f32 v123, v154, v155
buffer_store_dwordx4 v[120:123], v28, s[4:7], s60 offen offset:2048 sc1
v_cvt_pk_bf16_f32 v124, v140, v141
v_cvt_pk_bf16_f32 v125, v142, v143
v_cvt_pk_bf16_f32 v126, v156, v157
v_cvt_pk_bf16_f32 v127, v158, v159
buffer_store_dwordx4 v[124:127], v28, s[4:7], s60 offen offset:3072 sc1
s_add_u32 s66, s60, 0x80000
v_cvt_pk_bf16_f32 v80, v160, v161
v_cvt_pk_bf16_f32 v81, v162, v163
v_cvt_pk_bf16_f32 v82, v176, v177
v_cvt_pk_bf16_f32 v83, v178, v179
v_cvt_pk_bf16_f32 v84, v164, v165
v_cvt_pk_bf16_f32 v85, v166, v167
v_cvt_pk_bf16_f32 v86, v180, v181
v_cvt_pk_bf16_f32 v87, v182, v183
v_cvt_pk_bf16_f32 v88, v168, v169
v_cvt_pk_bf16_f32 v89, v170, v171
v_cvt_pk_bf16_f32 v90, v184, v185
v_cvt_pk_bf16_f32 v91, v186, v187
v_cvt_pk_bf16_f32 v92, v172, v173
v_cvt_pk_bf16_f32 v93, v174, v175
v_cvt_pk_bf16_f32 v94, v188, v189
v_cvt_pk_bf16_f32 v95, v190, v191
s_add_u32 s67, s60, 0x100000
v_cvt_pk_bf16_f32 v96, v192, v193
v_cvt_pk_bf16_f32 v97, v194, v195
v_cvt_pk_bf16_f32 v98, v208, v209
v_cvt_pk_bf16_f32 v99, v210, v211
v_cvt_pk_bf16_f32 v100, v196, v197
v_cvt_pk_bf16_f32 v101, v198, v199
v_cvt_pk_bf16_f32 v102, v212, v213
v_cvt_pk_bf16_f32 v103, v214, v215
v_cvt_pk_bf16_f32 v104, v200, v201
v_cvt_pk_bf16_f32 v105, v202, v203
v_cvt_pk_bf16_f32 v106, v216, v217
v_cvt_pk_bf16_f32 v107, v218, v219
v_cvt_pk_bf16_f32 v108, v204, v205
v_cvt_pk_bf16_f32 v109, v206, v207
v_cvt_pk_bf16_f32 v110, v220, v221
v_cvt_pk_bf16_f32 v111, v222, v223
s_add_u32 s68, s60, 0x180000
v_cvt_pk_bf16_f32 v112, v224, v225
v_cvt_pk_bf16_f32 v113, v226, v227
v_cvt_pk_bf16_f32 v114, v240, v241
v_cvt_pk_bf16_f32 v115, v242, v243
v_cvt_pk_bf16_f32 v116, v228, v229
v_cvt_pk_bf16_f32 v117, v230, v231
v_cvt_pk_bf16_f32 v118, v244, v245
v_cvt_pk_bf16_f32 v119, v246, v247
v_cvt_pk_bf16_f32 v120, v232, v233
v_cvt_pk_bf16_f32 v121, v234, v235
v_cvt_pk_bf16_f32 v122, v248, v249
v_cvt_pk_bf16_f32 v123, v250, v251
v_cvt_pk_bf16_f32 v124, v236, v237
v_cvt_pk_bf16_f32 v125, v238, v239
v_cvt_pk_bf16_f32 v126, v252, v253
v_cvt_pk_bf16_f32 v127, v254, v255
L_g_next:
s_cmp_le_u32 s59, 2
s_cbranch_scc0 L_g_next2
s_cmp_eq_u32 s63, 3
s_cbranch_scc0 L_g_next1
buffer_store_dwordx4 v[80:83], v28, s[4:7], s66 offen offset:0 sc1
buffer_store_dwordx4 v[84:87], v28, s[4:7], s66 offen offset:1024 sc1
buffer_store_dwordx4 v[88:91], v28, s[4:7], s66 offen offset:2048 sc1
buffer_store_dwordx4 v[92:95], v28, s[4:7], s66 offen offset:3072 sc1
buffer_store_dwordx4 v[96:99], v28, s[4:7], s67 offen offset:0 sc1
buffer_store_dwordx4 v[100:103], v28, s[4:7], s67 offen offset:1024 sc1
buffer_store_dwordx4 v[104:107], v28, s[4:7], s67 offen offset:2048 sc1
buffer_store_dwordx4 v[108:111], v28, s[4:7], s67 offen offset:3072 sc1
buffer_store_dwordx4 v[112:115], v28, s[4:7], s68 offen offset:0 sc1
buffer_store_dwordx4 v[116:119], v28, s[4:7], s68 offen offset:1024 sc1
buffer_store_dwordx4 v[120:123], v28, s[4:7], s68 offen offset:2048 sc1
buffer_store_dwordx4 v[124:127], v28, s[4:7], s68 offen offset:3072 sc1
s_mov_b32 s66, 0x7f000000
s_mov_b32 s67, 0x7f000000
s_mov_b32 s68, 0x7f000000
L_g_next1:
s_waitcnt vmcnt(0)
s_barrier
s_cmp_eq_u32 s12, 0
s_cbranch_scc0 L_g_next2
s_mov_b32 exec_lo, s63
s_mov_b32 exec_hi, 0
buffer_store_dword v29, v2, s[4:7], s61 offen sc1
s_mov_b64 exec, -1
L_g_next2:
s_add_u32 s59, s59, 1
s_mov_b32 s55, s56
s_cmp_eq_u32 s59, 7
s_cbranch_scc1 L_g_qkv_done
s_cmp_eq_u32 s63, 3
s_cbranch_scc1 L_g_disp
s_cmp_lt_u32 s55, 0x400
s_cbranch_scc0 L_g_half
s_waitcnt vmcnt(8) lgkmcnt(0)
s_barrier
L_g_restart:
s_and_b32 s18, s56, 3
s_cmp_eq_u32 s18, 1
s_cselect_b32 s36, s42, s40
s_cselect_b32 s37, s43, s41
s_cmp_eq_u32 s18, 2
s_cselect_b32 s36, s44, s36
s_cselect_b32 s37, s45, s37
s_bfe_u32 s51, s56, 0x30002
s_lshl_b32 s51, s51, 19
s_bfe_u32 s52, s56, 0x50005
s_lshl_b32 s52, s52, 8
s_lshr_b32 s18, s56, 11
s_lshl_b32 s18, s18, 18
s_add_u32 s51, s51, s18
v_add_u32 v4, s93, v4
v_add_u32 v5, s93, v5
v_add_u32 v6, s93, v6
v_add_u32 v7, s93, v7
s_lshl_b32 s64, s64, 1
s_add_u32 s65, s65, 16384
s_mov_b32 s50, 0
s_mov_b32 s53, 0
s_mov_b32 s54, s64
s_mov_b32 s57, 0
s_add_u32 m0, s54, 0
    s_nop 0
buffer_load_dwordx4 v4, s[32:35], s51 offen offset:0 lds
buffer_load_dwordx4 v5, s[32:35], s51 offen offset:1024 lds
buffer_load_dwordx4 v6, s[32:35], s51 offen offset:2048 lds
buffer_load_dwordx4 v7, s[32:35], s51 offen offset:3072 lds
s_add_u32 m0, s54, 4096
    s_nop 0
buffer_load_dwordx4 v8, s[32:35], s51 offen offset:0 lds
buffer_load_dwordx4 v9, s[32:35], s51 offen offset:1024 lds
buffer_load_dwordx4 v10, s[32:35], s51 offen offset:2048 lds
buffer_load_dwordx4 v11, s[32:35], s51 offen offset:3072 lds
s_add_u32 m0, s53, s65
    s_nop 0
buffer_load_dwordx4 v12, s[36:39], s52 offen offset:0  lds
buffer_load_dwordx4 v13, s[36:39], s52 offen offset:1024  lds
buffer_load_dwordx4 v14, s[36:39], s52 offen offset:2048  lds
buffer_load_dwordx4 v15, s[36:39], s52 offen offset:3072  lds
s_add_u32 s53, s53, 49152
s_cmp_eq_u32 s53, 147456
s_cselect_b32 s53, 0, s53
s_add_u32 s54, s53, s64
s_add_u32 s51, s51, 128
s_add_u32 s52, s52, 0x80000
s_add_u32 s50, s50, 1
s_cmp_eq_u32 s50, 16
s_cbranch_scc1 L_g_adv14_n
L_g_adv14_d:
s_add_u32 m0, s54, 0
    s_nop 0
buffer_load_dwordx4 v4, s[32:35], s51 offen offset:0 lds
buffer_load_dwordx4 v5, s[32:35], s51 offen offset:1024 lds
buffer_load_dwordx4 v6, s[32:35], s51 offen offset:2048 lds
buffer_load_dwordx4 v7, s[32:35], s51 offen offset:3072 lds
s_add_u32 m0, s54, 4096
    s_nop 0
buffer_load_dwordx4 v8, s[32:35], s51 offen offset:0 lds
buffer_load_dwordx4 v9, s[32:35], s51 offen offset:1024 lds
buffer_load_dwordx4 v10, s[32:35], s51 offen offset:2048 lds
buffer_load_dwordx4 v11, s[32:35], s51 offen offset:3072 lds
s_add_u32 m0, s53, s65
    s_nop 0
buffer_load_dwordx4 v12, s[36:39], s52 offen offset:0  lds
buffer_load_dwordx4 v13, s[36:39], s52 offen offset:1024  lds
buffer_load_dwordx4 v14, s[36:39], s52 offen offset:2048  lds
buffer_load_dwordx4 v15, s[36:39], s52 offen offset:3072  lds
s_add_u32 s53, s53, 49152
s_cmp_eq_u32 s53, 147456
s_cselect_b32 s53, 0, s53
s_add_u32 s54, s53, s64
s_add_u32 s51, s51, 128
s_add_u32 s52, s52, 0x80000
s_add_u32 s50, s50, 1
s_cmp_eq_u32 s50, 16
s_cbranch_scc1 L_g_adv15_n
L_g_adv15_d:
s_add_u32 m0, s54, 0
    s_nop 0
buffer_load_dwordx4 v4, s[32:35], s51 offen offset:0 lds
buffer_load_dwordx4 v5, s[32:35], s51 offen offset:1024 lds
buffer_load_dwordx4 v6, s[32:35], s51 offen offset:2048 lds
v_add_u32 v22, s48, v22
v_add_u32 v23, s48, v23
v_add_u32 v24, 16384, v24
v_add_u32 v25, 16384, v25
v_add_u32 v26, 16384, v26
v_add_u32 v27, 16384, v27
v_add_u32 v16, s57, v22
v_add_u32 v17, s57, v23
v_add_u32 v18, s57, v24
v_add_u32 v19, s57, v25
v_add_u32 v20, s57, v26
v_add_u32 v21, s57, v27
s_waitcnt vmcnt(15)
s_barrier
ds_read_b64_tr_b16 v[32:33], v18 offset:0
ds_read_b64_tr_b16 v[34:35], v18 offset:1024
ds_read_b128 v[64:67], v16 offset:0
ds_read_b64_tr_b16 v[36:37], v19 offset:0
ds_read_b64_tr_b16 v[38:39], v19 offset:1024
ds_read_b64_tr_b16 v[40:41], v20 offset:0
ds_read_b64_tr_b16 v[42:43], v20 offset:1024
ds_read_b64_tr_b16 v[44:45], v21 offset:0
ds_read_b64_tr_b16 v[46:47], v21 offset:1024
ds_read_b128 v[68:71], v16 offset:2048
ds_read_b128 v[72:75], v16 offset:4096
L_g_disp:
s_cmp_lt_u32 s55, 0x400
s_cbranch_scc0 L_g_half
s_bitcmp1_b32 s55, 1
s_cbranch_scc1 L_g_V_first
s_branch L_g_K_first
L_g_adv1_n:
s_mov_b32 s50, 0
s_mov_b32 s56, s86
s_mov_b32 s86, s87
s_mov_b32 s87, s88
s_mov_b32 s88, s89
s_mov_b32 s89, s90
s_mov_b32 s90, s91
s_mov_b32 s91, s92
s_and_b32 s18, s56, 3
s_cmp_eq_u32 s18, 1
s_cselect_b32 s36, s42, s40
s_cselect_b32 s37, s43, s41
s_cmp_eq_u32 s18, 2
s_cselect_b32 s36, s44, s36
s_cselect_b32 s37, s45, s37
s_bfe_u32 s51, s56, 0x30002
s_lshl_b32 s51, s51, 19
s_bfe_u32 s52, s56, 0x50005
s_lshl_b32 s52, s52, 8
s_lshr_b32 s18, s56, 11
s_lshl_b32 s18, s18, 18
s_add_u32 s51, s51, s18
s_cmp_lt_u32 s56, 0x400
s_cselect_b32 s51, 0x7f000000, s51
s_cselect_b32 s52, 0x7f000000, s52
s_branch L_g_adv1_d
L_g_adv2_n:
s_mov_b32 s50, 0
s_mov_b32 s56, s86
s_mov_b32 s86, s87
s_mov_b32 s87, s88
s_mov_b32 s88, s89
s_mov_b32 s89, s90
s_mov_b32 s90, s91
s_mov_b32 s91, s92
s_and_b32 s18, s56, 3
s_cmp_eq_u32 s18, 1
s_cselect_b32 s36, s42, s40
s_cselect_b32 s37, s43, s41
s_cmp_eq_u32 s18, 2
s_cselect_b32 s36, s44, s36
s_cselect_b32 s37, s45, s37
s_bfe_u32 s51, s56, 0x30002
s_lshl_b32 s51, s51, 19
s_bfe_u32 s52, s56, 0x50005
s_lshl_b32 s52, s52, 8
s_lshr_b32 s18, s56, 11
s_lshl_b32 s18, s18, 18
s_add_u32 s51, s51, s18
s_cmp_lt_u32 s56, 0x400
s_cselect_b32 s51, 0x7f000000, s51
s_cselect_b32 s52, 0x7f000000, s52
s_branch L_g_adv2_d
L_g_adv3_n:
s_mov_b32 s50, 0
s_mov_b32 s56, s86
s_mov_b32 s86, s87
s_mov_b32 s87, s88
s_mov_b32 s88, s89
s_mov_b32 s89, s90
s_mov_b32 s90, s91
s_mov_b32 s91, s92
s_and_b32 s18, s56, 3
s_cmp_eq_u32 s18, 1
s_cselect_b32 s36, s42, s40
s_cselect_b32 s37, s43, s41
s_cmp_eq_u32 s18, 2
s_cselect_b32 s36, s44, s36
s_cselect_b32 s37, s45, s37
s_bfe_u32 s51, s56, 0x30002
s_lshl_b32 s51, s51, 19
s_bfe_u32 s52, s56, 0x50005
s_lshl_b32 s52, s52, 8
s_lshr_b32 s18, s56, 11
s_lshl_b32 s18, s18, 18
s_add_u32 s51, s51, s18
s_cmp_lt_u32 s56, 0x400
s_cselect_b32 s51, 0x7f000000, s51
s_cselect_b32 s52, 0x7f000000, s52
s_branch L_g_adv3_d
L_g_adv4_n:
s_mov_b32 s50, 0
s_mov_b32 s56, s86
s_mov_b32 s86, s87
s_mov_b32 s87, s88
s_mov_b32 s88, s89
s_mov_b32 s89, s90
s_mov_b32 s90, s91
s_mov_b32 s91, s92
s_and_b32 s18, s56, 3
s_cmp_eq_u32 s18, 1
s_cselect_b32 s36, s42, s40
s_cselect_b32 s37, s43, s41
s_cmp_eq_u32 s18, 2
s_cselect_b32 s36, s44, s36
s_cselect_b32 s37, s45, s37
s_bfe_u32 s51, s56, 0x30002
s_lshl_b32 s51, s51, 19
s_bfe_u32 s52, s56, 0x50005
s_lshl_b32 s52, s52, 8
s_lshr_b32 s18, s56, 11
s_lshl_b32 s18, s18, 18
s_add_u32 s51, s51, s18
s_cmp_lt_u32 s56, 0x400
s_cselect_b32 s51, 0x7f000000, s51
s_cselect_b32 s52, 0x7f000000, s52
s_branch L_g_adv4_d
L_g_adv5_n:
s_mov_b32 s50, 0
s_mov_b32 s56, s86
s_mov_b32 s86, s87
s_mov_b32 s87, s88
s_mov_b32 s88, s89
s_mov_b32 s89, s90
s_mov_b32 s90, s91
s_mov_b32 s91, s92
s_and_b32 s18, s56, 3
s_cmp_eq_u32 s18, 1
s_cselect_b32 s36, s42, s40
s_cselect_b32 s37, s43, s41
s_cmp_eq_u32 s18, 2
s_cselect_b32 s36, s44, s36
s_cselect_b32 s37, s45, s37
s_bfe_u32 s51, s56, 0x30002
s_lshl_b32 s51, s51, 19
s_bfe_u32 s52, s56, 0x50005
s_lshl_b32 s52, s52, 8
s_lshr_b32 s18, s56, 11
s_lshl_b32 s18, s18, 18
s_add_u32 s51, s51, s18
s_cmp_lt_u32 s56, 0x400
s_cselect_b32 s51, 0x7f000000, s51
s_cselect_b32 s52, 0x7f000000, s52
s_branch L_g_adv5_d
L_g_adv6_n:
s_mov_b32 s50, 0
s_mov_b32 s56, s86
s_mov_b32 s86, s87
s_mov_b32 s87, s88
s_mov_b32 s88, s89
s_mov_b32 s89, s90
s_mov_b32 s90, s91
s_mov_b32 s91, s92
s_and_b32 s18, s56, 3
s_cmp_eq_u32 s18, 1
s_cselect_b32 s36, s42, s40
s_cselect_b32 s37, s43, s41
s_cmp_eq_u32 s18, 2
s_cselect_b32 s36, s44, s36
s_cselect_b32 s37, s45, s37
s_bfe_u32 s51, s56, 0x30002
s_lshl_b32 s51, s51, 19
s_bfe_u32 s52, s56, 0x50005
s_lshl_b32 s52, s52, 8
s_lshr_b32 s18, s56, 11
s_lshl_b32 s18, s18, 18
s_add_u32 s51, s51, s18
s_cmp_lt_u32 s56, 0x400
s_cselect_b32 s51, 0x7f000000, s51
s_cselect_b32 s52, 0x7f000000, s52
s_branch L_g_adv6_d
L_g_adv7_n:
s_mov_b32 s50, 0
s_mov_b32 s56, s86
s_mov_b32 s86, s87
s_mov_b32 s87, s88
s_mov_b32 s88, s89
s_mov_b32 s89, s90
s_mov_b32 s90, s91
s_mov_b32 s91, s92
s_and_b32 s18, s56, 3
s_cmp_eq_u32 s18, 1
s_cselect_b32 s36, s42, s40
s_cselect_b32 s37, s43, s41
s_cmp_eq_u32 s18, 2
s_cselect_b32 s36, s44, s36
s_cselect_b32 s37, s45, s37
s_bfe_u32 s51, s56, 0x30002
s_lshl_b32 s51, s51, 19
s_bfe_u32 s52, s56, 0x50005
s_lshl_b32 s52, s52, 8
s_lshr_b32 s18, s56, 11
s_lshl_b32 s18, s18, 18
s_add_u32 s51, s51, s18
s_cmp_lt_u32 s56, 0x400
s_cselect_b32 s51, 0x7f000000, s51
s_cselect_b32 s52, 0x7f000000, s52
s_branch L_g_adv7_d
L_g_adv8_n:
s_mov_b32 s50, 0
s_mov_b32 s56, s86
s_mov_b32 s86, s87
s_mov_b32 s87, s88
s_mov_b32 s88, s89
s_mov_b32 s89, s90
s_mov_b32 s90, s91
s_mov_b32 s91, s92
s_and_b32 s18, s56, 3
s_cmp_eq_u32 s18, 1
s_cselect_b32 s36, s42, s40
s_cselect_b32 s37, s43, s41
s_cmp_eq_u32 s18, 2
s_cselect_b32 s36, s44, s36
s_cselect_b32 s37, s45, s37
s_bfe_u32 s51, s56, 0x30002
s_lshl_b32 s51, s51, 19
s_bfe_u32 s52, s56, 0x50005
s_lshl_b32 s52, s52, 8
s_lshr_b32 s18, s56, 11
s_lshl_b32 s18, s18, 18
s_add_u32 s51, s51, s18
s_cmp_eq_u32 s59, 6
s_cselect_b32 s51, 0x7f000000, s51
s_cselect_b32 s52, 0x7f000000, s52
s_branch L_g_adv8_d
L_g_adv9_n:
s_mov_b32 s50, 0
s_mov_b32 s56, s86
s_mov_b32 s86, s87
s_mov_b32 s87, s88
s_mov_b32 s88, s89
s_mov_b32 s89, s90
s_mov_b32 s90, s91
s_mov_b32 s91, s92
s_and_b32 s18, s56, 3
s_cmp_eq_u32 s18, 1
s_cselect_b32 s36, s42, s40
s_cselect_b32 s37, s43, s41
s_cmp_eq_u32 s18, 2
s_cselect_b32 s36, s44, s36
s_cselect_b32 s37, s45, s37
s_bfe_u32 s51, s56, 0x30002
s_lshl_b32 s51, s51, 19
s_bfe_u32 s52, s56, 0x50005
s_lshl_b32 s52, s52, 8
s_lshr_b32 s18, s56, 11
s_lshl_b32 s18, s18, 18
s_add_u32 s51, s51, s18
s_cmp_eq_u32 s59, 6
s_cselect_b32 s51, 0x7f000000, s51
s_cselect_b32 s52, 0x7f000000, s52
s_branch L_g_adv9_d
L_g_adv10_n:
s_mov_b32 s50, 0
s_mov_b32 s56, s86
s_mov_b32 s86, s87
s_mov_b32 s87, s88
s_mov_b32 s88, s89
s_mov_b32 s89, s90
s_mov_b32 s90, s91
s_mov_b32 s91, s92
s_and_b32 s18, s56, 3
s_cmp_eq_u32 s18, 1
s_cselect_b32 s36, s42, s40
s_cselect_b32 s37, s43, s41
s_cmp_eq_u32 s18, 2
s_cselect_b32 s36, s44, s36
s_cselect_b32 s37, s45, s37
s_bfe_u32 s51, s56, 0x30002
s_lshl_b32 s51, s51, 19
s_bfe_u32 s52, s56, 0x50005
s_lshl_b32 s52, s52, 8
s_lshr_b32 s18, s56, 11
s_lshl_b32 s18, s18, 18
s_add_u32 s51, s51, s18
s_cmp_eq_u32 s59, 6
s_cselect_b32 s51, 0x7f000000, s51
s_cselect_b32 s52, 0x7f000000, s52
s_branch L_g_adv10_d
L_g_adv11_n:
s_mov_b32 s50, 0
s_mov_b32 s56, s86
s_mov_b32 s86, s87
s_mov_b32 s87, s88
s_mov_b32 s88, s89
s_mov_b32 s89, s90
s_mov_b32 s90, s91
s_mov_b32 s91, s92
s_and_b32 s18, s56, 3
s_cmp_eq_u32 s18, 1
s_cselect_b32 s36, s42, s40
s_cselect_b32 s37, s43, s41
s_cmp_eq_u32 s18, 2
s_cselect_b32 s36, s44, s36
s_cselect_b32 s37, s45, s37
s_bfe_u32 s51, s56, 0x30002
s_lshl_b32 s51, s51, 19
s_bfe_u32 s52, s56, 0x50005
s_lshl_b32 s52, s52, 8
s_lshr_b32 s18, s56, 11
s_lshl_b32 s18, s18, 18
s_add_u32 s51, s51, s18
s_cmp_eq_u32 s59, 6
s_cselect_b32 s51, 0x7f000000, s51
s_cselect_b32 s52, 0x7f000000, s52
s_branch L_g_adv11_d
L_g_adv12_n:
s_mov_b32 s50, 0
s_mov_b32 s56, s86
s_mov_b32 s86, s87
s_mov_b32 s87, s88
s_mov_b32 s88, s89
s_mov_b32 s89, s90
s_mov_b32 s90, s91
s_mov_b32 s91, s92
s_and_b32 s18, s56, 3
s_cmp_eq_u32 s18, 1
s_cselect_b32 s36, s42, s40
s_cselect_b32 s37, s43, s41
s_cmp_eq_u32 s18, 2
s_cselect_b32 s36, s44, s36
s_cselect_b32 s37, s45, s37
s_bfe_u32 s51, s56, 0x30002
s_lshl_b32 s51, s51, 19
s_bfe_u32 s52, s56, 0x50005
s_lshl_b32 s52, s52, 8
s_lshr_b32 s18, s56, 11
s_lshl_b32 s18, s18, 18
s_add_u32 s51, s51, s18
s_cmp_eq_u32 s59, 6
s_cselect_b32 s51, 0x7f000000, s51
s_cselect_b32 s52, 0x7f000000, s52
s_branch L_g_adv12_d
L_g_adv13_n:
s_mov_b32 s50, 0
s_mov_b32 s56, s86
s_mov_b32 s86, s87
s_mov_b32 s87, s88
s_mov_b32 s88, s89
s_mov_b32 s89, s90
s_mov_b32 s90, s91
s_mov_b32 s91, s92
s_and_b32 s18, s56, 3
s_cmp_eq_u32 s18, 1
s_cselect_b32 s36, s42, s40
s_cselect_b32 s37, s43, s41
s_cmp_eq_u32 s18, 2
s_cselect_b32 s36, s44, s36
s_cselect_b32 s37, s45, s37
s_bfe_u32 s51, s56, 0x30002
s_lshl_b32 s51, s51, 19
s_bfe_u32 s52, s56, 0x50005
s_lshl_b32 s52, s52, 8
s_lshr_b32 s18, s56, 11
s_lshl_b32 s18, s18, 18
s_add_u32 s51, s51, s18
s_cmp_eq_u32 s59, 6
s_cselect_b32 s51, 0x7f000000, s51
s_cselect_b32 s52, 0x7f000000, s52
s_branch L_g_adv13_d
L_g_adv14_n:
s_mov_b32 s50, 0
s_mov_b32 s56, s86
s_mov_b32 s86, s87
s_mov_b32 s87, s88
s_mov_b32 s88, s89
s_mov_b32 s89, s90
s_mov_b32 s90, s91
s_mov_b32 s91, s92
s_and_b32 s18, s56, 3
s_cmp_eq_u32 s18, 1
s_cselect_b32 s36, s42, s40
s_cselect_b32 s37, s43, s41
s_cmp_eq_u32 s18, 2
s_cselect_b32 s36, s44, s36
s_cselect_b32 s37, s45, s37
s_bfe_u32 s51, s56, 0x30002
s_lshl_b32 s51, s51, 19
s_bfe_u32 s52, s56, 0x50005
s_lshl_b32 s52, s52, 8
s_lshr_b32 s18, s56, 11
s_lshl_b32 s18, s18, 18
s_add_u32 s51, s51, s18
s_cmp_eq_u32 s59, 6
s_cselect_b32 s51, 0x7f000000, s51
s_cselect_b32 s52, 0x7f000000, s52
s_branch L_g_adv14_d
L_g_adv15_n:
s_mov_b32 s50, 0
s_mov_b32 s56, s86
s_mov_b32 s86, s87
s_mov_b32 s87, s88
s_mov_b32 s88, s89
s_mov_b32 s89, s90
s_mov_b32 s90, s91
s_mov_b32 s91, s92
s_and_b32 s18, s56, 3
s_cmp_eq_u32 s18, 1
s_cselect_b32 s36, s42, s40
s_cselect_b32 s37, s43, s41
s_cmp_eq_u32 s18, 2
s_cselect_b32 s36, s44, s36
s_cselect_b32 s37, s45, s37
s_bfe_u32 s51, s56, 0x30002
s_lshl_b32 s51, s51, 19
s_bfe_u32 s52, s56, 0x50005
s_lshl_b32 s52, s52, 8
s_lshr_b32 s18, s56, 11
s_lshl_b32 s18, s18, 18
s_add_u32 s51, s51, s18
s_cmp_eq_u32 s59, 6
s_cselect_b32 s51, 0x7f000000, s51
s_cselect_b32 s52, 0x7f000000, s52
s_branch L_g_adv15_d
L_g_qkv_done:
buffer_store_dwordx4 v[80:83], v28, s[4:7], s66 offen offset:0 sc1
buffer_store_dwordx4 v[84:87], v28, s[4:7], s66 offen offset:1024 sc1
buffer_store_dwordx4 v[88:91], v28, s[4:7], s66 offen offset:2048 sc1
buffer_store_dwordx4 v[92:95], v28, s[4:7], s66 offen offset:3072 sc1
buffer_store_dwordx4 v[96:99], v28, s[4:7], s67 offen offset:0 sc1
buffer_store_dwordx4 v[100:103], v28, s[4:7], s67 offen offset:1024 sc1
buffer_store_dwordx4 v[104:107], v28, s[4:7], s67 offen offset:2048 sc1
buffer_store_dwordx4 v[108:111], v28, s[4:7], s67 offen offset:3072 sc1
buffer_store_dwordx4 v[112:115], v28, s[4:7], s68 offen offset:0 sc1
buffer_store_dwordx4 v[116:119], v28, s[4:7], s68 offen offset:1024 sc1
buffer_store_dwordx4 v[120:123], v28, s[4:7], s68 offen offset:2048 sc1
buffer_store_dwordx4 v[124:127], v28, s[4:7], s68 offen offset:3072 sc1
s_waitcnt vmcnt(0) lgkmcnt(0)
s_barrier
s_cmp_eq_u32 s59, 0
s_cbranch_scc1 L_g_end_nf
s_cmp_eq_u32 s12, 0
s_cbranch_scc0 L_g_end_nf
s_mov_b32 exec_lo, s63
s_mov_b32 exec_hi, 0
buffer_store_dword v29, v2, s[4:7], s61 offen sc1
s_mov_b64 exec, -1
L_g_end_nf:
v_and_b32 v4, 15, v0
v_lshrrev_b32 v5, 4, v0
v_lshlrev_b32 v6, 4, v0
v_mov_b32 v7, 1
s_mov_b32 s50, 0x05040100
s_mov_b32 s51, 0x07060302
s_mov_b32 s59, 0xffff0000
s_mov_b32 s60, 0xbfb8aa3b
s_and_b32 s57, s62, 31
s_lshl_b32 s57, s57, 6
s_lshl_b32 s18, s12, 12
v_add_u32 v43, s18, v6
L_p_key:
s_mov_b32 s18, 0x8184000
s_mov_b32 s19, 0x8185000
buffer_load_dwordx4 v[64:67], v6, s[4:7], s18 offen offset:0 sc1
buffer_load_dwordx4 v[68:71], v6, s[4:7], s18 offen offset:1024 sc1
buffer_load_dwordx4 v[72:75], v6, s[4:7], s18 offen offset:2048 sc1
buffer_load_dwordx4 v[76:79], v6, s[4:7], s18 offen offset:3072 sc1
buffer_load_dwordx4 v[80:83], v6, s[4:7], s19 offen offset:0 sc1
buffer_load_dwordx4 v[84:87], v6, s[4:7], s19 offen offset:1024 sc1
buffer_load_dwordx4 v[88:91], v6, s[4:7], s19 offen offset:2048 sc1
buffer_load_dwordx4 v[92:95], v6, s[4:7], s19 offen offset:3072 sc1
s_waitcnt vmcnt(0)
v_max_u32 v8, v64, v65
v_max3_u32 v8, v8, v66, v67
v_max3_u32 v8, v8, v68, v69
v_max3_u32 v8, v8, v70, v71
v_max3_u32 v8, v8, v72, v73
v_max3_u32 v8, v8, v74, v75
v_max3_u32 v8, v8, v76, v77
v_max3_u32 v8, v8, v78, v79
v_max3_u32 v8, v8, v80, v81
v_max3_u32 v8, v8, v82, v83
v_max3_u32 v8, v8, v84, v85
v_max3_u32 v8, v8, v86, v87
v_max3_u32 v8, v8, v88, v89
v_max3_u32 v8, v8, v90, v91
v_max3_u32 v8, v8, v92, v93
v_max3_u32 v8, v8, v94, v95
    s_nop 1
v_max_u32_dpp v8, v8, v8 row_ror:1 row_mask:0xf bank_mask:0xf
    s_nop 1
v_max_u32_dpp v8, v8, v8 row_ror:2 row_mask:0xf bank_mask:0xf
    s_nop 1
v_max_u32_dpp v8, v8, v8 row_ror:4 row_mask:0xf bank_mask:0xf
    s_nop 1
v_max_u32_dpp v8, v8, v8 row_ror:8 row_mask:0xf bank_mask:0xf
v_mov_b32 v9, v8
    s_nop 1
v_permlane16_swap_b32 v8, v9
v_max_u32 v8, v8, v9
v_mov_b32 v9, v8
    s_nop 1
v_permlane32_swap_b32 v8, v9
v_max_u32 v8, v8, v9
    s_nop 0
v_readfirstlane_b32 s52, v8
    s_nop 0
s_cmp_eq_u32 s52, -1
s_cbranch_scc0 L_p_keyok
s_sub_u32 s15, s15, 1
s_cbranch_scc1 L_exit
s_sleep 8
s_branch L_p_key
L_p_keyok:
s_and_b32 s53, s52, 0x7ff
s_sub_u32 s53, 2047, s53
s_and_b32 s18, s52, 0xffff0000
s_xor_b32 s19, s18, 0x80000000
s_xor_b32 s18, s18, 0xffff0000
s_bitcmp1_b32 s52, 31
s_cselect_b32 s18, s19, s18
v_mov_b32 v8, s18
v_mul_f32 v8, s60, v8
v_exp_f32 v8, v8
    s_nop 0
v_add_f32 v8, 1.0, v8
v_rcp_f32 v8, v8
    s_nop 0
v_cvt_pk_bf16_f32 v8, v8, v8
v_lshlrev_b32 v8, 16, v8
    s_nop 0
v_readfirstlane_b32 s54, v8
s_bitcmp1_b32 s62, 4
s_cbranch_scc0 L_p_mlpd
s_lshr_b32 s64, s62, 5
s_lshl_b32 s64, s64, 4
s_and_b32 s18, s62, 15
s_add_u32 s64, s64, s18
s_cmp_ge_u32 s64, 56
s_cbranch_scc1 L_p_mlpd
s_load_dwordx4 s[68:71], s[0:1], 72
s_load_dwordx2 s[78:79], s[0:1], 88
s_lshl_b32 s18, s53, 11
s_lshl_b32 s19, s12, 9
s_add_u32 s18, s18, s19
v_lshlrev_b32 v8, 7, v5
buffer_load_dwordx4 v[96:99], v8, s[32:35], s18 offen offset:0
buffer_load_dwordx4 v[100:103], v8, s[32:35], s18 offen offset:16
buffer_load_dwordx4 v[104:107], v8, s[32:35], s18 offen offset:32
buffer_load_dwordx4 v[108:111], v8, s[32:35], s18 offen offset:48
buffer_load_dwordx4 v[112:115], v8, s[32:35], s18 offen offset:64
buffer_load_dwordx4 v[116:119], v8, s[32:35], s18 offen offset:80
buffer_load_dwordx4 v[120:123], v8, s[32:35], s18 offen offset:96
buffer_load_dwordx4 v[124:127], v8, s[32:35], s18 offen offset:112
s_mul_i32 s18, s12, 1835008
s_lshl_b32 s19, s64, 7
s_add_u32 s18, s18, s19
s_mov_b32 s19, 458752
v_mul_lo_u32 v9, v5, s19
v_lshl_add_u32 v9, v4, 3, v9
v_add_u32 v9, s18, v9
v_mov_b32 v24, 0
v_mov_b32 v25, 0
v_mov_b32 v26, 0
v_mov_b32 v27, 0
v_mov_b32 v28, 0
v_mov_b32 v29, 0
v_mov_b32 v30, 0
v_mov_b32 v31, 0
s_waitcnt lgkmcnt(0)
s_mov_b32 s8, s68
s_mov_b32 s9, s69
s_mov_b32 s10, 0x700000
s_mov_b32 s11, 0x20000
s_mov_b32 s18, 0
buffer_load_dwordx2 v[128:129], v9, s[8:11], s18 offen nt
s_mov_b32 s18, 7168
buffer_load_dwordx2 v[130:131], v9, s[8:11], s18 offen nt
s_mov_b32 s18, 14336
buffer_load_dwordx2 v[132:133], v9, s[8:11], s18 offen nt
s_mov_b32 s18, 21504
buffer_load_dwordx2 v[134:135], v9, s[8:11], s18 offen nt
s_mov_b32 s18, 28672
buffer_load_dwordx2 v[136:137], v9, s[8:11], s18 offen nt
s_mov_b32 s18, 35840
buffer_load_dwordx2 v[138:139], v9, s[8:11], s18 offen nt
s_mov_b32 s18, 43008
buffer_load_dwordx2 v[140:141], v9, s[8:11], s18 offen nt
s_mov_b32 s18, 50176
buffer_load_dwordx2 v[142:143], v9, s[8:11], s18 offen nt
s_mov_b32 s18, 57344
buffer_load_dwordx2 v[144:145], v9, s[8:11], s18 offen nt
s_mov_b32 s18, 64512
buffer_load_dwordx2 v[146:147], v9, s[8:11], s18 offen nt
s_mov_b32 s18, 71680
buffer_load_dwordx2 v[148:149], v9, s[8:11], s18 offen nt
s_mov_b32 s18, 78848
buffer_load_dwordx2 v[150:151], v9, s[8:11], s18 offen nt
s_mov_b32 s18, 86016
buffer_load_dwordx2 v[152:153], v9, s[8:11], s18 offen nt
s_mov_b32 s18, 93184
buffer_load_dwordx2 v[154:155], v9, s[8:11], s18 offen nt
s_mov_b32 s18, 100352
buffer_load_dwordx2 v[156:157], v9, s[8:11], s18 offen nt
s_mov_b32 s18, 107520
buffer_load_dwordx2 v[158:159], v9, s[8:11], s18 offen nt
s_mov_b32 s8, s68
s_mov_b32 s9, s69
s_mov_b32 s10, 0x700000
s_mov_b32 s11, 0x20000
s_mov_b32 s18, 114688
buffer_load_dwordx2 v[160:161], v9, s[8:11], s18 offen nt
s_mov_b32 s18, 121856
buffer_load_dwordx2 v[162:163], v9, s[8:11], s18 offen nt
s_mov_b32 s18, 129024
buffer_load_dwordx2 v[164:165], v9, s[8:11], s18 offen nt
s_mov_b32 s18, 136192
buffer_load_dwordx2 v[166:167], v9, s[8:11], s18 offen nt
s_mov_b32 s18, 143360
buffer_load_dwordx2 v[168:169], v9, s[8:11], s18 offen nt
s_mov_b32 s18, 150528
buffer_load_dwordx2 v[170:171], v9, s[8:11], s18 offen nt
s_mov_b32 s18, 157696
buffer_load_dwordx2 v[172:173], v9, s[8:11], s18 offen nt
s_mov_b32 s18, 164864
buffer_load_dwordx2 v[174:175], v9, s[8:11], s18 offen nt
s_mov_b32 s18, 172032
buffer_load_dwordx2 v[176:177], v9, s[8:11], s18 offen nt
s_mov_b32 s18, 179200
buffer_load_dwordx2 v[178:179], v9, s[8:11], s18 offen nt
s_mov_b32 s18, 186368
buffer_load_dwordx2 v[180:181], v9, s[8:11], s18 offen nt
s_mov_b32 s18, 193536
buffer_load_dwordx2 v[182:183], v9, s[8:11], s18 offen nt
s_mov_b32 s18, 200704
buffer_load_dwordx2 v[184:185], v9, s[8:11], s18 offen nt
s_mov_b32 s18, 207872
buffer_load_dwordx2 v[186:187], v9, s[8:11], s18 offen nt
s_mov_b32 s18, 215040
buffer_load_dwordx2 v[188:189], v9, s[8:11], s18 offen nt
s_mov_b32 s18, 222208
buffer_load_dwordx2 v[190:191], v9, s[8:11], s18 offen nt
s_mov_b32 s8, s68
s_mov_b32 s9, s69
s_mov_b32 s10, 0x700000
s_mov_b32 s11, 0x20000
s_mov_b32 s18, 229376
buffer_load_dwordx2 v[192:193], v9, s[8:11], s18 offen nt
s_mov_b32 s18, 236544
buffer_load_dwordx2 v[194:195], v9, s[8:11], s18 offen nt
s_mov_b32 s18, 243712
buffer_load_dwordx2 v[196:197], v9, s[8:11], s18 offen nt
s_mov_b32 s18, 250880
buffer_load_dwordx2 v[198:199], v9, s[8:11], s18 offen nt
s_mov_b32 s18, 258048
buffer_load_dwordx2 v[200:201], v9, s[8:11], s18 offen nt
s_mov_b32 s18, 265216
buffer_load_dwordx2 v[202:203], v9, s[8:11], s18 offen nt
s_mov_b32 s18, 272384
buffer_load_dwordx2 v[204:205], v9, s[8:11], s18 offen nt
s_mov_b32 s18, 279552
buffer_load_dwordx2 v[206:207], v9, s[8:11], s18 offen nt
s_mov_b32 s18, 286720
buffer_load_dwordx2 v[208:209], v9, s[8:11], s18 offen nt
s_mov_b32 s18, 293888
buffer_load_dwordx2 v[210:211], v9, s[8:11], s18 offen nt
s_mov_b32 s18, 301056
buffer_load_dwordx2 v[212:213], v9, s[8:11], s18 offen nt
s_mov_b32 s18, 308224
buffer_load_dwordx2 v[214:215], v9, s[8:11], s18 offen nt
s_mov_b32 s18, 315392
buffer_load_dwordx2 v[216:217], v9, s[8:11], s18 offen nt
s_mov_b32 s18, 322560
buffer_load_dwordx2 v[218:219], v9, s[8:11], s18 offen nt
s_mov_b32 s18, 329728
buffer_load_dwordx2 v[220:221], v9, s[8:11], s18 offen nt
s_mov_b32 s18, 336896
buffer_load_dwordx2 v[222:223], v9, s[8:11], s18 offen nt
s_waitcnt vmcnt(32)
v_perm_b32 v10, v130, v128, s50
v_perm_b32 v11, v130, v128, s51
v_perm_b32 v12, v131, v129, s50
v_perm_b32 v13, v131, v129, s51
v_dot2c_f32_bf16 v24, v10, v96
v_dot2c_f32_bf16 v25, v11, v96
v_dot2c_f32_bf16 v26, v12, v96
v_dot2c_f32_bf16 v27, v13, v96
v_perm_b32 v10, v134, v132, s50
v_perm_b32 v11, v134, v132, s51
v_perm_b32 v12, v135, v133, s50
v_perm_b32 v13, v135, v133, s51
v_dot2c_f32_bf16 v24, v10, v97
v_dot2c_f32_bf16 v25, v11, v97
v_dot2c_f32_bf16 v26, v12, v97
v_dot2c_f32_bf16 v27, v13, v97
v_perm_b32 v10, v138, v136, s50
v_perm_b32 v11, v138, v136, s51
v_perm_b32 v12, v139, v137, s50
v_perm_b32 v13, v139, v137, s51
v_dot2c_f32_bf16 v24, v10, v98
v_dot2c_f32_bf16 v25, v11, v98
v_dot2c_f32_bf16 v26, v12, v98
v_dot2c_f32_bf16 v27, v13, v98
v_perm_b32 v10, v142, v140, s50
v_perm_b32 v11, v142, v140, s51
v_perm_b32 v12, v143, v141, s50
v_perm_b32 v13, v143, v141, s51
v_dot2c_f32_bf16 v24, v10, v99
v_dot2c_f32_bf16 v25, v11, v99
v_dot2c_f32_bf16 v26, v12, v99
v_dot2c_f32_bf16 v27, v13, v99
v_perm_b32 v10, v146, v144, s50
v_perm_b32 v11, v146, v144, s51
v_perm_b32 v12, v147, v145, s50
v_perm_b32 v13, v147, v145, s51
v_dot2c_f32_bf16 v24, v10, v100
v_dot2c_f32_bf16 v25, v11, v100
v_dot2c_f32_bf16 v26, v12, v100
v_dot2c_f32_bf16 v27, v13, v100
v_perm_b32 v10, v150, v148, s50
v_perm_b32 v11, v150, v148, s51
v_perm_b32 v12, v151, v149, s50
v_perm_b32 v13, v151, v149, s51
v_dot2c_f32_bf16 v24, v10, v101
v_dot2c_f32_bf16 v25, v11, v101
v_dot2c_f32_bf16 v26, v12, v101
v_dot2c_f32_bf16 v27, v13, v101
v_perm_b32 v10, v154, v152, s50
v_perm_b32 v11, v154, v152, s51
v_perm_b32 v12, v155, v153, s50
v_perm_b32 v13, v155, v153, s51
v_dot2c_f32_bf16 v24, v10, v102
v_dot2c_f32_bf16 v25, v11, v102
v_dot2c_f32_bf16 v26, v12, v102
v_dot2c_f32_bf16 v27, v13, v102
v_perm_b32 v10, v158, v156, s50
v_perm_b32 v11, v158, v156, s51
v_perm_b32 v12, v159, v157, s50
v_perm_b32 v13, v159, v157, s51
v_dot2c_f32_bf16 v24, v10, v103
v_dot2c_f32_bf16 v25, v11, v103
v_dot2c_f32_bf16 v26, v12, v103
v_dot2c_f32_bf16 v27, v13, v103
s_mov_b32 s8, s68
s_mov_b32 s9, s69
s_mov_b32 s10, 0x700000
s_mov_b32 s11, 0x20000
s_mov_b32 s18, 344064
buffer_load_dwordx2 v[128:129], v9, s[8:11], s18 offen nt
s_mov_b32 s18, 351232
buffer_load_dwordx2 v[130:131], v9, s[8:11], s18 offen nt
s_mov_b32 s18, 358400
buffer_load_dwordx2 v[132:133], v9, s[8:11], s18 offen nt
s_mov_b32 s18, 365568
buffer_load_dwordx2 v[134:135], v9, s[8:11], s18 offen nt
s_mov_b32 s18, 372736
buffer_load_dwordx2 v[136:137], v9, s[8:11], s18 offen nt
s_mov_b32 s18, 379904
buffer_load_dwordx2 v[138:139], v9, s[8:11], s18 offen nt
s_mov_b32 s18, 387072
buffer_load_dwordx2 v[140:141], v9, s[8:11], s18 offen nt
s_mov_b32 s18, 394240
buffer_load_dwordx2 v[142:143], v9, s[8:11], s18 offen nt
s_mov_b32 s18, 401408
buffer_load_dwordx2 v[144:145], v9, s[8:11], s18 offen nt
s_mov_b32 s18, 408576
buffer_load_dwordx2 v[146:147], v9, s[8:11], s18 offen nt
s_mov_b32 s18, 415744
buffer_load_dwordx2 v[148:149], v9, s[8:11], s18 offen nt
s_mov_b32 s18, 422912
buffer_load_dwordx2 v[150:151], v9, s[8:11], s18 offen nt
s_mov_b32 s18, 430080
buffer_load_dwordx2 v[152:153], v9, s[8:11], s18 offen nt
s_mov_b32 s18, 437248
buffer_load_dwordx2 v[154:155], v9, s[8:11], s18 offen nt
s_mov_b32 s18, 444416
buffer_load_dwordx2 v[156:157], v9, s[8:11], s18 offen nt
s_mov_b32 s18, 451584
buffer_load_dwordx2 v[158:159], v9, s[8:11], s18 offen nt
s_waitcnt vmcnt(32)
v_perm_b32 v10, v162, v160, s50
v_perm_b32 v11, v162, v160, s51
v_perm_b32 v12, v163, v161, s50
v_perm_b32 v13, v163, v161, s51
v_dot2c_f32_bf16 v24, v10, v104
v_dot2c_f32_bf16 v25, v11, v104
v_dot2c_f32_bf16 v26, v12, v104
v_dot2c_f32_bf16 v27, v13, v104
v_perm_b32 v10, v166, v164, s50
v_perm_b32 v11, v166, v164, s51
v_perm_b32 v12, v167, v165, s50
v_perm_b32 v13, v167, v165, s51
v_dot2c_f32_bf16 v24, v10, v105
v_dot2c_f32_bf16 v25, v11, v105
v_dot2c_f32_bf16 v26, v12, v105
v_dot2c_f32_bf16 v27, v13, v105
v_perm_b32 v10, v170, v168, s50
v_perm_b32 v11, v170, v168, s51
v_perm_b32 v12, v171, v169, s50
v_perm_b32 v13, v171, v169, s51
v_dot2c_f32_bf16 v24, v10, v106
v_dot2c_f32_bf16 v25, v11, v106
v_dot2c_f32_bf16 v26, v12, v106
v_dot2c_f32_bf16 v27, v13, v106
v_perm_b32 v10, v174, v172, s50
v_perm_b32 v11, v174, v172, s51
v_perm_b32 v12, v175, v173, s50
v_perm_b32 v13, v175, v173, s51
v_dot2c_f32_bf16 v24, v10, v107
v_dot2c_f32_bf16 v25, v11, v107
v_dot2c_f32_bf16 v26, v12, v107
v_dot2c_f32_bf16 v27, v13, v107
v_perm_b32 v10, v178, v176, s50
v_perm_b32 v11, v178, v176, s51
v_perm_b32 v12, v179, v177, s50
v_perm_b32 v13, v179, v177, s51
v_dot2c_f32_bf16 v24, v10, v108
v_dot2c_f32_bf16 v25, v11, v108
v_dot2c_f32_bf16 v26, v12, v108
v_dot2c_f32_bf16 v27, v13, v108
v_perm_b32 v10, v182, v180, s50
v_perm_b32 v11, v182, v180, s51
v_perm_b32 v12, v183, v181, s50
v_perm_b32 v13, v183, v181, s51
v_dot2c_f32_bf16 v24, v10, v109
v_dot2c_f32_bf16 v25, v11, v109
v_dot2c_f32_bf16 v26, v12, v109
v_dot2c_f32_bf16 v27, v13, v109
v_perm_b32 v10, v186, v184, s50
v_perm_b32 v11, v186, v184, s51
v_perm_b32 v12, v187, v185, s50
v_perm_b32 v13, v187, v185, s51
v_dot2c_f32_bf16 v24, v10, v110
v_dot2c_f32_bf16 v25, v11, v110
v_dot2c_f32_bf16 v26, v12, v110
v_dot2c_f32_bf16 v27, v13, v110
v_perm_b32 v10, v190, v188, s50
v_perm_b32 v11, v190, v188, s51
v_perm_b32 v12, v191, v189, s50
v_perm_b32 v13, v191, v189, s51
v_dot2c_f32_bf16 v24, v10, v111
v_dot2c_f32_bf16 v25, v11, v111
v_dot2c_f32_bf16 v26, v12, v111
v_dot2c_f32_bf16 v27, v13, v111
s_mov_b32 s8, s70
s_mov_b32 s9, s71
s_mov_b32 s10, 0x700000
s_mov_b32 s11, 0x20000
s_mov_b32 s18, 0
buffer_load_dwordx2 v[160:161], v9, s[8:11], s18 offen nt
s_mov_b32 s18, 7168
buffer_load_dwordx2 v[162:163], v9, s[8:11], s18 offen nt
s_mov_b32 s18, 14336
buffer_load_dwordx2 v[164:165], v9, s[8:11], s18 offen nt
s_mov_b32 s18, 21504
buffer_load_dwordx2 v[166:167], v9, s[8:11], s18 offen nt
s_mov_b32 s18, 28672
buffer_load_dwordx2 v[168:169], v9, s[8:11], s18 offen nt
s_mov_b32 s18, 35840
buffer_load_dwordx2 v[170:171], v9, s[8:11], s18 offen nt
s_mov_b32 s18, 43008
buffer_load_dwordx2 v[172:173], v9, s[8:11], s18 offen nt
s_mov_b32 s18, 50176
buffer_load_dwordx2 v[174:175], v9, s[8:11], s18 offen nt
s_mov_b32 s18, 57344
buffer_load_dwordx2 v[176:177], v9, s[8:11], s18 offen nt
s_mov_b32 s18, 64512
buffer_load_dwordx2 v[178:179], v9, s[8:11], s18 offen nt
s_mov_b32 s18, 71680
buffer_load_dwordx2 v[180:181], v9, s[8:11], s18 offen nt
s_mov_b32 s18, 78848
buffer_load_dwordx2 v[182:183], v9, s[8:11], s18 offen nt
s_mov_b32 s18, 86016
buffer_load_dwordx2 v[184:185], v9, s[8:11], s18 offen nt
s_mov_b32 s18, 93184
buffer_load_dwordx2 v[186:187], v9, s[8:11], s18 offen nt
s_mov_b32 s18, 100352
buffer_load_dwordx2 v[188:189], v9, s[8:11], s18 offen nt
s_mov_b32 s18, 107520
buffer_load_dwordx2 v[190:191], v9, s[8:11], s18 offen nt
s_waitcnt vmcnt(32)
v_perm_b32 v10, v194, v192, s50
v_perm_b32 v11, v194, v192, s51
v_perm_b32 v12, v195, v193, s50
v_perm_b32 v13, v195, v193, s51
v_dot2c_f32_bf16 v24, v10, v112
v_dot2c_f32_bf16 v25, v11, v112
v_dot2c_f32_bf16 v26, v12, v112
v_dot2c_f32_bf16 v27, v13, v112
v_perm_b32 v10, v198, v196, s50
v_perm_b32 v11, v198, v196, s51
v_perm_b32 v12, v199, v197, s50
v_perm_b32 v13, v199, v197, s51
v_dot2c_f32_bf16 v24, v10, v113
v_dot2c_f32_bf16 v25, v11, v113
v_dot2c_f32_bf16 v26, v12, v113
v_dot2c_f32_bf16 v27, v13, v113
v_perm_b32 v10, v202, v200, s50
v_perm_b32 v11, v202, v200, s51
v_perm_b32 v12, v203, v201, s50
v_perm_b32 v13, v203, v201, s51
v_dot2c_f32_bf16 v24, v10, v114
v_dot2c_f32_bf16 v25, v11, v114
v_dot2c_f32_bf16 v26, v12, v114
v_dot2c_f32_bf16 v27, v13, v114
v_perm_b32 v10, v206, v204, s50
v_perm_b32 v11, v206, v204, s51
v_perm_b32 v12, v207, v205, s50
v_perm_b32 v13, v207, v205, s51
v_dot2c_f32_bf16 v24, v10, v115
v_dot2c_f32_bf16 v25, v11, v115
v_dot2c_f32_bf16 v26, v12, v115
v_dot2c_f32_bf16 v27, v13, v115
v_perm_b32 v10, v210, v208, s50
v_perm_b32 v11, v210, v208, s51
v_perm_b32 v12, v211, v209, s50
v_perm_b32 v13, v211, v209, s51
v_dot2c_f32_bf16 v24, v10, v116
v_dot2c_f32_bf16 v25, v11, v116
v_dot2c_f32_bf16 v26, v12, v116
v_dot2c_f32_bf16 v27, v13, v116
v_perm_b32 v10, v214, v212, s50
v_perm_b32 v11, v214, v212, s51
v_perm_b32 v12, v215, v213, s50
v_perm_b32 v13, v215, v213, s51
v_dot2c_f32_bf16 v24, v10, v117
v_dot2c_f32_bf16 v25, v11, v117
v_dot2c_f32_bf16 v26, v12, v117
v_dot2c_f32_bf16 v27, v13, v117
v_perm_b32 v10, v218, v216, s50
v_perm_b32 v11, v218, v216, s51
v_perm_b32 v12, v219, v217, s50
v_perm_b32 v13, v219, v217, s51
v_dot2c_f32_bf16 v24, v10, v118
v_dot2c_f32_bf16 v25, v11, v118
v_dot2c_f32_bf16 v26, v12, v118
v_dot2c_f32_bf16 v27, v13, v118
v_perm_b32 v10, v222, v220, s50
v_perm_b32 v11, v222, v220, s51
v_perm_b32 v12, v223, v221, s50
v_perm_b32 v13, v223, v221, s51
v_dot2c_f32_bf16 v24, v10, v119
v_dot2c_f32_bf16 v25, v11, v119
v_dot2c_f32_bf16 v26, v12, v119
v_dot2c_f32_bf16 v27, v13, v119
s_mov_b32 s8, s70
s_mov_b32 s9, s71
s_mov_b32 s10, 0x700000
s_mov_b32 s11, 0x20000
s_mov_b32 s18, 114688
buffer_load_dwordx2 v[192:193], v9, s[8:11], s18 offen nt
s_mov_b32 s18, 121856
buffer_load_dwordx2 v[194:195], v9, s[8:11], s18 offen nt
s_mov_b32 s18, 129024
buffer_load_dwordx2 v[196:197], v9, s[8:11], s18 offen nt
s_mov_b32 s18, 136192
buffer_load_dwordx2 v[198:199], v9, s[8:11], s18 offen nt
s_mov_b32 s18, 143360
buffer_load_dwordx2 v[200:201], v9, s[8:11], s18 offen nt
s_mov_b32 s18, 150528
buffer_load_dwordx2 v[202:203], v9, s[8:11], s18 offen nt
s_mov_b32 s18, 157696
buffer_load_dwordx2 v[204:205], v9, s[8:11], s18 offen nt
s_mov_b32 s18, 164864
buffer_load_dwordx2 v[206:207], v9, s[8:11], s18 offen nt
s_mov_b32 s18, 172032
buffer_load_dwordx2 v[208:209], v9, s[8:11], s18 offen nt
s_mov_b32 s18, 179200
buffer_load_dwordx2 v[210:211], v9, s[8:11], s18 offen nt
s_mov_b32 s18, 186368
buffer_load_dwordx2 v[212:213], v9, s[8:11], s18 offen nt
s_mov_b32 s18, 193536
buffer_load_dwordx2 v[214:215], v9, s[8:11], s18 offen nt
s_mov_b32 s18, 200704
buffer_load_dwordx2 v[216:217], v9, s[8:11], s18 offen nt
s_mov_b32 s18, 207872
buffer_load_dwordx2 v[218:219], v9, s[8:11], s18 offen nt
s_mov_b32 s18, 215040
buffer_load_dwordx2 v[220:221], v9, s[8:11], s18 offen nt
s_mov_b32 s18, 222208
buffer_load_dwordx2 v[222:223], v9, s[8:11], s18 offen nt
s_waitcnt vmcnt(32)
v_perm_b32 v10, v130, v128, s50
v_perm_b32 v11, v130, v128, s51
v_perm_b32 v12, v131, v129, s50
v_perm_b32 v13, v131, v129, s51
v_dot2c_f32_bf16 v24, v10, v120
v_dot2c_f32_bf16 v25, v11, v120
v_dot2c_f32_bf16 v26, v12, v120
v_dot2c_f32_bf16 v27, v13, v120
v_perm_b32 v10, v134, v132, s50
v_perm_b32 v11, v134, v132, s51
v_perm_b32 v12, v135, v133, s50
v_perm_b32 v13, v135, v133, s51
v_dot2c_f32_bf16 v24, v10, v121
v_dot2c_f32_bf16 v25, v11, v121
v_dot2c_f32_bf16 v26, v12, v121
v_dot2c_f32_bf16 v27, v13, v121
v_perm_b32 v10, v138, v136, s50
v_perm_b32 v11, v138, v136, s51
v_perm_b32 v12, v139, v137, s50
v_perm_b32 v13, v139, v137, s51
v_dot2c_f32_bf16 v24, v10, v122
v_dot2c_f32_bf16 v25, v11, v122
v_dot2c_f32_bf16 v26, v12, v122
v_dot2c_f32_bf16 v27, v13, v122
v_perm_b32 v10, v142, v140, s50
v_perm_b32 v11, v142, v140, s51
v_perm_b32 v12, v143, v141, s50
v_perm_b32 v13, v143, v141, s51
v_dot2c_f32_bf16 v24, v10, v123
v_dot2c_f32_bf16 v25, v11, v123
v_dot2c_f32_bf16 v26, v12, v123
v_dot2c_f32_bf16 v27, v13, v123
v_perm_b32 v10, v146, v144, s50
v_perm_b32 v11, v146, v144, s51
v_perm_b32 v12, v147, v145, s50
v_perm_b32 v13, v147, v145, s51
v_dot2c_f32_bf16 v24, v10, v124
v_dot2c_f32_bf16 v25, v11, v124
v_dot2c_f32_bf16 v26, v12, v124
v_dot2c_f32_bf16 v27, v13, v124
v_perm_b32 v10, v150, v148, s50
v_perm_b32 v11, v150, v148, s51
v_perm_b32 v12, v151, v149, s50
v_perm_b32 v13, v151, v149, s51
v_dot2c_f32_bf16 v24, v10, v125
v_dot2c_f32_bf16 v25, v11, v125
v_dot2c_f32_bf16 v26, v12, v125
v_dot2c_f32_bf16 v27, v13, v125
v_perm_b32 v10, v154, v152, s50
v_perm_b32 v11, v154, v152, s51
v_perm_b32 v12, v155, v153, s50
v_perm_b32 v13, v155, v153, s51
v_dot2c_f32_bf16 v24, v10, v126
v_dot2c_f32_bf16 v25, v11, v126
v_dot2c_f32_bf16 v26, v12, v126
v_dot2c_f32_bf16 v27, v13, v126
v_perm_b32 v10, v158, v156, s50
v_perm_b32 v11, v158, v156, s51
v_perm_b32 v12, v159, v157, s50
v_perm_b32 v13, v159, v157, s51
v_dot2c_f32_bf16 v24, v10, v127
v_dot2c_f32_bf16 v25, v11, v127
v_dot2c_f32_bf16 v26, v12, v127
v_dot2c_f32_bf16 v27, v13, v127
s_mov_b32 s8, s70
s_mov_b32 s9, s71
s_mov_b32 s10, 0x700000
s_mov_b32 s11, 0x20000
s_mov_b32 s18, 229376
buffer_load_dwordx2 v[128:129], v9, s[8:11], s18 offen nt
s_mov_b32 s18, 236544
buffer_load_dwordx2 v[130:131], v9, s[8:11], s18 offen nt
s_mov_b32 s18, 243712
buffer_load_dwordx2 v[132:133], v9, s[8:11], s18 offen nt
s_mov_b32 s18, 250880
buffer_load_dwordx2 v[134:135], v9, s[8:11], s18 offen nt
s_mov_b32 s18, 258048
buffer_load_dwordx2 v[136:137], v9, s[8:11], s18 offen nt
s_mov_b32 s18, 265216
buffer_load_dwordx2 v[138:139], v9, s[8:11], s18 offen nt
s_mov_b32 s18, 272384
buffer_load_dwordx2 v[140:141], v9, s[8:11], s18 offen nt
s_mov_b32 s18, 279552
buffer_load_dwordx2 v[142:143], v9, s[8:11], s18 offen nt
s_mov_b32 s18, 286720
buffer_load_dwordx2 v[144:145], v9, s[8:11], s18 offen nt
s_mov_b32 s18, 293888
buffer_load_dwordx2 v[146:147], v9, s[8:11], s18 offen nt
s_mov_b32 s18, 301056
buffer_load_dwordx2 v[148:149], v9, s[8:11], s18 offen nt
s_mov_b32 s18, 308224
buffer_load_dwordx2 v[150:151], v9, s[8:11], s18 offen nt
s_mov_b32 s18, 315392
buffer_load_dwordx2 v[152:153], v9, s[8:11], s18 offen nt
s_mov_b32 s18, 322560
buffer_load_dwordx2 v[154:155], v9, s[8:11], s18 offen nt
s_mov_b32 s18, 329728
buffer_load_dwordx2 v[156:157], v9, s[8:11], s18 offen nt
s_mov_b32 s18, 336896
buffer_load_dwordx2 v[158:159], v9, s[8:11], s18 offen nt
s_waitcnt vmcnt(32)
v_perm_b32 v10, v162, v160, s50
v_perm_b32 v11, v162, v160, s51
v_perm_b32 v12, v163, v161, s50
v_perm_b32 v13, v163, v161, s51
v_dot2c_f32_bf16 v28, v10, v96
v_dot2c_f32_bf16 v29, v11, v96
v_dot2c_f32_bf16 v30, v12, v96
v_dot2c_f32_bf16 v31, v13, v96
v_perm_b32 v10, v166, v164, s50
v_perm_b32 v11, v166, v164, s51
v_perm_b32 v12, v167, v165, s50
v_perm_b32 v13, v167, v165, s51
v_dot2c_f32_bf16 v28, v10, v97
v_dot2c_f32_bf16 v29, v11, v97
v_dot2c_f32_bf16 v30, v12, v97
v_dot2c_f32_bf16 v31, v13, v97
v_perm_b32 v10, v170, v168, s50
v_perm_b32 v11, v170, v168, s51
v_perm_b32 v12, v171, v169, s50
v_perm_b32 v13, v171, v169, s51
v_dot2c_f32_bf16 v28, v10, v98
v_dot2c_f32_bf16 v29, v11, v98
v_dot2c_f32_bf16 v30, v12, v98
v_dot2c_f32_bf16 v31, v13, v98
v_perm_b32 v10, v174, v172, s50
v_perm_b32 v11, v174, v172, s51
v_perm_b32 v12, v175, v173, s50
v_perm_b32 v13, v175, v173, s51
v_dot2c_f32_bf16 v28, v10, v99
v_dot2c_f32_bf16 v29, v11, v99
v_dot2c_f32_bf16 v30, v12, v99
v_dot2c_f32_bf16 v31, v13, v99
v_perm_b32 v10, v178, v176, s50
v_perm_b32 v11, v178, v176, s51
v_perm_b32 v12, v179, v177, s50
v_perm_b32 v13, v179, v177, s51
v_dot2c_f32_bf16 v28, v10, v100
v_dot2c_f32_bf16 v29, v11, v100
v_dot2c_f32_bf16 v30, v12, v100
v_dot2c_f32_bf16 v31, v13, v100
v_perm_b32 v10, v182, v180, s50
v_perm_b32 v11, v182, v180, s51
v_perm_b32 v12, v183, v181, s50
v_perm_b32 v13, v183, v181, s51
v_dot2c_f32_bf16 v28, v10, v101
v_dot2c_f32_bf16 v29, v11, v101
v_dot2c_f32_bf16 v30, v12, v101
v_dot2c_f32_bf16 v31, v13, v101
v_perm_b32 v10, v186, v184, s50
v_perm_b32 v11, v186, v184, s51
v_perm_b32 v12, v187, v185, s50
v_perm_b32 v13, v187, v185, s51
v_dot2c_f32_bf16 v28, v10, v102
v_dot2c_f32_bf16 v29, v11, v102
v_dot2c_f32_bf16 v30, v12, v102
v_dot2c_f32_bf16 v31, v13, v102
v_perm_b32 v10, v190, v188, s50
v_perm_b32 v11, v190, v188, s51
v_perm_b32 v12, v191, v189, s50
v_perm_b32 v13, v191, v189, s51
v_dot2c_f32_bf16 v28, v10, v103
v_dot2c_f32_bf16 v29, v11, v103
v_dot2c_f32_bf16 v30, v12, v103
v_dot2c_f32_bf16 v31, v13, v103
s_mov_b32 s8, s70
s_mov_b32 s9, s71
s_mov_b32 s10, 0x700000
s_mov_b32 s11, 0x20000
s_mov_b32 s18, 344064
buffer_load_dwordx2 v[160:161], v9, s[8:11], s18 offen nt
s_mov_b32 s18, 351232
buffer_load_dwordx2 v[162:163], v9, s[8:11], s18 offen nt
s_mov_b32 s18, 358400
buffer_load_dwordx2 v[164:165], v9, s[8:11], s18 offen nt
s_mov_b32 s18, 365568
buffer_load_dwordx2 v[166:167], v9, s[8:11], s18 offen nt
s_mov_b32 s18, 372736
buffer_load_dwordx2 v[168:169], v9, s[8:11], s18 offen nt
s_mov_b32 s18, 379904
buffer_load_dwordx2 v[170:171], v9, s[8:11], s18 offen nt
s_mov_b32 s18, 387072
buffer_load_dwordx2 v[172:173], v9, s[8:11], s18 offen nt
s_mov_b32 s18, 394240
buffer_load_dwordx2 v[174:175], v9, s[8:11], s18 offen nt
s_mov_b32 s18, 401408
buffer_load_dwordx2 v[176:177], v9, s[8:11], s18 offen nt
s_mov_b32 s18, 408576
buffer_load_dwordx2 v[178:179], v9, s[8:11], s18 offen nt
s_mov_b32 s18, 415744
buffer_load_dwordx2 v[180:181], v9, s[8:11], s18 offen nt
s_mov_b32 s18, 422912
buffer_load_dwordx2 v[182:183], v9, s[8:11], s18 offen nt
s_mov_b32 s18, 430080
buffer_load_dwordx2 v[184:185], v9, s[8:11], s18 offen nt
s_mov_b32 s18, 437248
buffer_load_dwordx2 v[186:187], v9, s[8:11], s18 offen nt
s_mov_b32 s18, 444416
buffer_load_dwordx2 v[188:189], v9, s[8:11], s18 offen nt
s_mov_b32 s18, 451584
buffer_load_dwordx2 v[190:191], v9, s[8:11], s18 offen nt
s_mov_b32 s8, s78
s_mov_b32 s9, s79
s_mov_b32 s10, 0x700000
s_mov_b32 s11, 0x20000
s_lshl_b32 s18, s64, 17
s_lshl_b32 s20, s12, 15
s_add_u32 s18, s18, s20
s_add_u32 s18, s18, 0
buffer_load_dwordx4 v[224:227], v6, s[8:11], s18 offen offset:0 nt
buffer_load_dwordx4 v[228:231], v6, s[8:11], s18 offen offset:1024 nt
buffer_load_dwordx4 v[232:235], v6, s[8:11], s18 offen offset:2048 nt
buffer_load_dwordx4 v[236:239], v6, s[8:11], s18 offen offset:3072 nt
s_add_u32 s18, s18, 4096
buffer_load_dwordx4 v[240:243], v6, s[8:11], s18 offen offset:0 nt
buffer_load_dwordx4 v[244:247], v6, s[8:11], s18 offen offset:1024 nt
buffer_load_dwordx4 v[248:251], v6, s[8:11], s18 offen offset:2048 nt
buffer_load_dwordx4 v[252:255], v6, s[8:11], s18 offen offset:3072 nt
s_add_u32 s18, s18, 4096
s_waitcnt vmcnt(40)
v_perm_b32 v10, v194, v192, s50
v_perm_b32 v11, v194, v192, s51
v_perm_b32 v12, v195, v193, s50
v_perm_b32 v13, v195, v193, s51
v_dot2c_f32_bf16 v28, v10, v104
v_dot2c_f32_bf16 v29, v11, v104
v_dot2c_f32_bf16 v30, v12, v104
v_dot2c_f32_bf16 v31, v13, v104
v_perm_b32 v10, v198, v196, s50
v_perm_b32 v11, v198, v196, s51
v_perm_b32 v12, v199, v197, s50
v_perm_b32 v13, v199, v197, s51
v_dot2c_f32_bf16 v28, v10, v105
v_dot2c_f32_bf16 v29, v11, v105
v_dot2c_f32_bf16 v30, v12, v105
v_dot2c_f32_bf16 v31, v13, v105
v_perm_b32 v10, v202, v200, s50
v_perm_b32 v11, v202, v200, s51
v_perm_b32 v12, v203, v201, s50
v_perm_b32 v13, v203, v201, s51
v_dot2c_f32_bf16 v28, v10, v106
v_dot2c_f32_bf16 v29, v11, v106
v_dot2c_f32_bf16 v30, v12, v106
v_dot2c_f32_bf16 v31, v13, v106
v_perm_b32 v10, v206, v204, s50
v_perm_b32 v11, v206, v204, s51
v_perm_b32 v12, v207, v205, s50
v_perm_b32 v13, v207, v205, s51
v_dot2c_f32_bf16 v28, v10, v107
v_dot2c_f32_bf16 v29, v11, v107
v_dot2c_f32_bf16 v30, v12, v107
v_dot2c_f32_bf16 v31, v13, v107
v_perm_b32 v10, v210, v208, s50
v_perm_b32 v11, v210, v208, s51
v_perm_b32 v12, v211, v209, s50
v_perm_b32 v13, v211, v209, s51
v_dot2c_f32_bf16 v28, v10, v108
v_dot2c_f32_bf16 v29, v11, v108
v_dot2c_f32_bf16 v30, v12, v108
v_dot2c_f32_bf16 v31, v13, v108
v_perm_b32 v10, v214, v212, s50
v_perm_b32 v11, v214, v212, s51
v_perm_b32 v12, v215, v213, s50
v_perm_b32 v13, v215, v213, s51
v_dot2c_f32_bf16 v28, v10, v109
v_dot2c_f32_bf16 v29, v11, v109
v_dot2c_f32_bf16 v30, v12, v109
v_dot2c_f32_bf16 v31, v13, v109
v_perm_b32 v10, v218, v216, s50
v_perm_b32 v11, v218, v216, s51
v_perm_b32 v12, v219, v217, s50
v_perm_b32 v13, v219, v217, s51
v_dot2c_f32_bf16 v28, v10, v110
v_dot2c_f32_bf16 v29, v11, v110
v_dot2c_f32_bf16 v30, v12, v110
v_dot2c_f32_bf16 v31, v13, v110
v_perm_b32 v10, v222, v220, s50
v_perm_b32 v11, v222, v220, s51
v_perm_b32 v12, v223, v221, s50
v_perm_b32 v13, v223, v221, s51
v_dot2c_f32_bf16 v28, v10, v111
v_dot2c_f32_bf16 v29, v11, v111
v_dot2c_f32_bf16 v30, v12, v111
v_dot2c_f32_bf16 v31, v13, v111
s_waitcnt vmcnt(24)
v_perm_b32 v10, v130, v128, s50
v_perm_b32 v11, v130, v128, s51
v_perm_b32 v12, v131, v129, s50
v_perm_b32 v13, v131, v129, s51
v_dot2c_f32_bf16 v28, v10, v112
v_dot2c_f32_bf16 v29, v11, v112
v_dot2c_f32_bf16 v30, v12, v112
v_dot2c_f32_bf16 v31, v13, v112
v_perm_b32 v10, v134, v132, s50
v_perm_b32 v11, v134, v132, s51
v_perm_b32 v12, v135, v133, s50
v_perm_b32 v13, v135, v133, s51
v_dot2c_f32_bf16 v28, v10, v113
v_dot2c_f32_bf16 v29, v11, v113
v_dot2c_f32_bf16 v30, v12, v113
v_dot2c_f32_bf16 v31, v13, v113
v_perm_b32 v10, v138, v136, s50
v_perm_b32 v11, v138, v136, s51
v_perm_b32 v12, v139, v137, s50
v_perm_b32 v13, v139, v137, s51
v_dot2c_f32_bf16 v28, v10, v114
v_dot2c_f32_bf16 v29, v11, v114
v_dot2c_f32_bf16 v30, v12, v114
v_dot2c_f32_bf16 v31, v13, v114
v_perm_b32 v10, v142, v140, s50
v_perm_b32 v11, v142, v140, s51
v_perm_b32 v12, v143, v141, s50
v_perm_b32 v13, v143, v141, s51
v_dot2c_f32_bf16 v28, v10, v115
v_dot2c_f32_bf16 v29, v11, v115
v_dot2c_f32_bf16 v30, v12, v115
v_dot2c_f32_bf16 v31, v13, v115
v_perm_b32 v10, v146, v144, s50
v_perm_b32 v11, v146, v144, s51
v_perm_b32 v12, v147, v145, s50
v_perm_b32 v13, v147, v145, s51
v_dot2c_f32_bf16 v28, v10, v116
v_dot2c_f32_bf16 v29, v11, v116
v_dot2c_f32_bf16 v30, v12, v116
v_dot2c_f32_bf16 v31, v13, v116
v_perm_b32 v10, v150, v148, s50
v_perm_b32 v11, v150, v148, s51
v_perm_b32 v12, v151, v149, s50
v_perm_b32 v13, v151, v149, s51
v_dot2c_f32_bf16 v28, v10, v117
v_dot2c_f32_bf16 v29, v11, v117
v_dot2c_f32_bf16 v30, v12, v117
v_dot2c_f32_bf16 v31, v13, v117
v_perm_b32 v10, v154, v152, s50
v_perm_b32 v11, v154, v152, s51
v_perm_b32 v12, v155, v153, s50
v_perm_b32 v13, v155, v153, s51
v_dot2c_f32_bf16 v28, v10, v118
v_dot2c_f32_bf16 v29, v11, v118
v_dot2c_f32_bf16 v30, v12, v118
v_dot2c_f32_bf16 v31, v13, v118
v_perm_b32 v10, v158, v156, s50
v_perm_b32 v11, v158, v156, s51
v_perm_b32 v12, v159, v157, s50
v_perm_b32 v13, v159, v157, s51
v_dot2c_f32_bf16 v28, v10, v119
v_dot2c_f32_bf16 v29, v11, v119
v_dot2c_f32_bf16 v30, v12, v119
v_dot2c_f32_bf16 v31, v13, v119
s_waitcnt vmcnt(8)
v_perm_b32 v10, v162, v160, s50
v_perm_b32 v11, v162, v160, s51
v_perm_b32 v12, v163, v161, s50
v_perm_b32 v13, v163, v161, s51
v_dot2c_f32_bf16 v28, v10, v120
v_dot2c_f32_bf16 v29, v11, v120
v_dot2c_f32_bf16 v30, v12, v120
v_dot2c_f32_bf16 v31, v13, v120
v_perm_b32 v10, v166, v164, s50
v_perm_b32 v11, v166, v164, s51
v_perm_b32 v12, v167, v165, s50
v_perm_b32 v13, v167, v165, s51
v_dot2c_f32_bf16 v28, v10, v121
v_dot2c_f32_bf16 v29, v11, v121
v_dot2c_f32_bf16 v30, v12, v121
v_dot2c_f32_bf16 v31, v13, v121
v_perm_b32 v10, v170, v168, s50
v_perm_b32 v11, v170, v168, s51
v_perm_b32 v12, v171, v169, s50
v_perm_b32 v13, v171, v169, s51
v_dot2c_f32_bf16 v28, v10, v122
v_dot2c_f32_bf16 v29, v11, v122
v_dot2c_f32_bf16 v30, v12, v122
v_dot2c_f32_bf16 v31, v13, v122
v_perm_b32 v10, v174, v172, s50
v_perm_b32 v11, v174, v172, s51
v_perm_b32 v12, v175, v173, s50
v_perm_b32 v13, v175, v173, s51
v_dot2c_f32_bf16 v28, v10, v123
v_dot2c_f32_bf16 v29, v11, v123
v_dot2c_f32_bf16 v30, v12, v123
v_dot2c_f32_bf16 v31, v13, v123
v_perm_b32 v10, v178, v176, s50
v_perm_b32 v11, v178, v176, s51
v_perm_b32 v12, v179, v177, s50
v_perm_b32 v13, v179, v177, s51
v_dot2c_f32_bf16 v28, v10, v124
v_dot2c_f32_bf16 v29, v11, v124
v_dot2c_f32_bf16 v30, v12, v124
v_dot2c_f32_bf16 v31, v13, v124
v_perm_b32 v10, v182, v180, s50
v_perm_b32 v11, v182, v180, s51
v_perm_b32 v12, v183, v181, s50
v_perm_b32 v13, v183, v181, s51
v_dot2c_f32_bf16 v28, v10, v125
v_dot2c_f32_bf16 v29, v11, v125
v_dot2c_f32_bf16 v30, v12, v125
v_dot2c_f32_bf16 v31, v13, v125
v_perm_b32 v10, v186, v184, s50
v_perm_b32 v11, v186, v184, s51
v_perm_b32 v12, v187, v185, s50
v_perm_b32 v13, v187, v185, s51
v_dot2c_f32_bf16 v28, v10, v126
v_dot2c_f32_bf16 v29, v11, v126
v_dot2c_f32_bf16 v30, v12, v126
v_dot2c_f32_bf16 v31, v13, v126
v_perm_b32 v10, v190, v188, s50
v_perm_b32 v11, v190, v188, s51
v_perm_b32 v12, v191, v189, s50
v_perm_b32 v13, v191, v189, s51
v_dot2c_f32_bf16 v28, v10, v127
v_dot2c_f32_bf16 v29, v11, v127
v_dot2c_f32_bf16 v30, v12, v127
v_dot2c_f32_bf16 v31, v13, v127
s_mov_b32 s8, s78
s_mov_b32 s9, s79
s_mov_b32 s10, 0x700000
s_mov_b32 s11, 0x20000
s_lshl_b32 s18, s64, 17
s_lshl_b32 s20, s12, 15
s_add_u32 s18, s18, s20
s_add_u32 s18, s18, 8192
buffer_load_dwordx4 v[128:131], v6, s[8:11], s18 offen offset:0 nt
buffer_load_dwordx4 v[132:135], v6, s[8:11], s18 offen offset:1024 nt
buffer_load_dwordx4 v[136:139], v6, s[8:11], s18 offen offset:2048 nt
buffer_load_dwordx4 v[140:143], v6, s[8:11], s18 offen offset:3072 nt
s_add_u32 s18, s18, 4096
buffer_load_dwordx4 v[144:147], v6, s[8:11], s18 offen offset:0 nt
buffer_load_dwordx4 v[148:151], v6, s[8:11], s18 offen offset:1024 nt
buffer_load_dwordx4 v[152:155], v6, s[8:11], s18 offen offset:2048 nt
buffer_load_dwordx4 v[156:159], v6, s[8:11], s18 offen offset:3072 nt
s_add_u32 s18, s18, 4096
buffer_load_dwordx4 v[160:163], v6, s[8:11], s18 offen offset:0 nt
buffer_load_dwordx4 v[164:167], v6, s[8:11], s18 offen offset:1024 nt
buffer_load_dwordx4 v[168:171], v6, s[8:11], s18 offen offset:2048 nt
buffer_load_dwordx4 v[172:175], v6, s[8:11], s18 offen offset:3072 nt
s_add_u32 s18, s18, 4096
buffer_load_dwordx4 v[176:179], v6, s[8:11], s18 offen offset:0 nt
buffer_load_dwordx4 v[180:183], v6, s[8:11], s18 offen offset:1024 nt
buffer_load_dwordx4 v[184:187], v6, s[8:11], s18 offen offset:2048 nt
buffer_load_dwordx4 v[188:191], v6, s[8:11], s18 offen offset:3072 nt
s_add_u32 s18, s18, 4096
buffer_load_dwordx4 v[192:195], v6, s[8:11], s18 offen offset:0 nt
buffer_load_dwordx4 v[196:199], v6, s[8:11], s18 offen offset:1024 nt
buffer_load_dwordx4 v[200:203], v6, s[8:11], s18 offen offset:2048 nt
buffer_load_dwordx4 v[204:207], v6, s[8:11], s18 offen offset:3072 nt
s_add_u32 s18, s18, 4096
buffer_load_dwordx4 v[208:211], v6, s[8:11], s18 offen offset:0 nt
buffer_load_dwordx4 v[212:215], v6, s[8:11], s18 offen offset:1024 nt
buffer_load_dwordx4 v[216:219], v6, s[8:11], s18 offen offset:2048 nt
buffer_load_dwordx4 v[220:223], v6, s[8:11], s18 offen offset:3072 nt
s_add_u32 s18, s18, 4096
v_mov_b32 v10, v24
    s_nop 1
v_permlane16_swap_b32 v24, v10
v_add_f32 v24, v24, v10
v_mov_b32 v10, v24
    s_nop 1
v_permlane32_swap_b32 v24, v10
v_add_f32 v24, v24, v10
v_mov_b32 v10, v25
    s_nop 1
v_permlane16_swap_b32 v25, v10
v_add_f32 v25, v25, v10
v_mov_b32 v10, v25
    s_nop 1
v_permlane32_swap_b32 v25, v10
v_add_f32 v25, v25, v10
v_mov_b32 v10, v26
    s_nop 1
v_permlane16_swap_b32 v26, v10
v_add_f32 v26, v26, v10
v_mov_b32 v10, v26
    s_nop 1
v_permlane32_swap_b32 v26, v10
v_add_f32 v26, v26, v10
v_mov_b32 v10, v27
    s_nop 1
v_permlane16_swap_b32 v27, v10
v_add_f32 v27, v27, v10
v_mov_b32 v10, v27
    s_nop 1
v_permlane32_swap_b32 v27, v10
v_add_f32 v27, v27, v10
v_mov_b32 v10, v28
    s_nop 1
v_permlane16_swap_b32 v28, v10
v_add_f32 v28, v28, v10
v_mov_b32 v10, v28
    s_nop 1
v_permlane32_swap_b32 v28, v10
v_add_f32 v28, v28, v10
v_mov_b32 v10, v29
    s_nop 1
v_permlane16_swap_b32 v29, v10
v_add_f32 v29, v29, v10
v_mov_b32 v10, v29
    s_nop 1
v_permlane32_swap_b32 v29, v10
v_add_f32 v29, v29, v10
v_mov_b32 v10, v30
    s_nop 1
v_permlane16_swap_b32 v30, v10
v_add_f32 v30, v30, v10
v_mov_b32 v10, v30
    s_nop 1
v_permlane32_swap_b32 v30, v10
v_add_f32 v30, v30, v10
v_mov_b32 v10, v31
    s_nop 1
v_permlane16_swap_b32 v31, v10
v_add_f32 v31, v31, v10
v_mov_b32 v10, v31
    s_nop 1
v_permlane32_swap_b32 v31, v10
v_add_f32 v31, v31, v10
ds_write_b128 v43, v[24:27]
ds_write_b128 v43, v[28:31] offset:1024
s_waitcnt lgkmcnt(0)
s_barrier
ds_read_b128 v[64:67], v6 offset:0
ds_read_b128 v[68:71], v6 offset:1024
ds_read_b128 v[72:75], v6 offset:4096
ds_read_b128 v[76:79], v6 offset:5120
ds_read_b128 v[80:83], v6 offset:8192
ds_read_b128 v[84:87], v6 offset:9216
ds_read_b128 v[88:91], v6 offset:12288
ds_read_b128 v[92:95], v6 offset:13312
s_waitcnt lgkmcnt(0)
s_barrier
v_add_f32 v64, v64, v72
v_add_f32 v80, v80, v88
v_add_f32 v64, v64, v80
v_cvt_pk_bf16_f32 v64, v64, v64
v_lshlrev_b32 v64, 16, v64
v_add_f32 v65, v65, v73
v_add_f32 v81, v81, v89
v_add_f32 v65, v65, v81
v_cvt_pk_bf16_f32 v65, v65, v65
v_lshlrev_b32 v65, 16, v65
v_add_f32 v66, v66, v74
v_add_f32 v82, v82, v90
v_add_f32 v66, v66, v82
v_cvt_pk_bf16_f32 v66, v66, v66
v_lshlrev_b32 v66, 16, v66
v_add_f32 v67, v67, v75
v_add_f32 v83, v83, v91
v_add_f32 v67, v67, v83
v_cvt_pk_bf16_f32 v67, v67, v67
v_lshlrev_b32 v67, 16, v67
v_add_f32 v68, v68, v76
v_add_f32 v84, v84, v92
v_add_f32 v68, v68, v84
v_cvt_pk_bf16_f32 v68, v68, v68
v_lshlrev_b32 v68, 16, v68
v_add_f32 v69, v69, v77
v_add_f32 v85, v85, v93
v_add_f32 v69, v69, v85
v_cvt_pk_bf16_f32 v69, v69, v69
v_lshlrev_b32 v69, 16, v69
v_add_f32 v70, v70, v78
v_add_f32 v86, v86, v94
v_add_f32 v70, v70, v86
v_cvt_pk_bf16_f32 v70, v70, v70
v_lshlrev_b32 v70, 16, v70
v_add_f32 v71, v71, v79
v_add_f32 v87, v87, v95
v_add_f32 v71, v71, v87
v_cvt_pk_bf16_f32 v71, v71, v71
v_lshlrev_b32 v71, 16, v71
v_mul_f32 v10, s60, v64
v_exp_f32 v10, v10
    s_nop 0
v_add_f32 v10, 1.0, v10
v_rcp_f32 v10, v10
    s_nop 0
v_mul_f32 v10, v10, v64
v_cvt_pk_bf16_f32 v10, v10, v10
v_lshlrev_b32 v10, 16, v10
v_mul_f32 v72, v10, v68
v_mul_f32 v10, s60, v65
v_exp_f32 v10, v10
    s_nop 0
v_add_f32 v10, 1.0, v10
v_rcp_f32 v10, v10
    s_nop 0
v_mul_f32 v10, v10, v65
v_cvt_pk_bf16_f32 v10, v10, v10
v_lshlrev_b32 v10, 16, v10
v_mul_f32 v73, v10, v69
v_mul_f32 v10, s60, v66
v_exp_f32 v10, v10
    s_nop 0
v_add_f32 v10, 1.0, v10
v_rcp_f32 v10, v10
    s_nop 0
v_mul_f32 v10, v10, v66
v_cvt_pk_bf16_f32 v10, v10, v10
v_lshlrev_b32 v10, 16, v10
v_mul_f32 v74, v10, v70
v_mul_f32 v10, s60, v67
v_exp_f32 v10, v10
    s_nop 0
v_add_f32 v10, 1.0, v10
v_rcp_f32 v10, v10
    s_nop 0
v_mul_f32 v10, v10, v67
v_cvt_pk_bf16_f32 v10, v10, v10
v_lshlrev_b32 v10, 16, v10
v_mul_f32 v75, v10, v71
v_cvt_pk_bf16_f32 v10, v72, v73
v_cvt_pk_bf16_f32 v11, v74, v75
s_lshl_b32 s18, s12, 2
v_readlane_b32 s80, v10, s18
v_readlane_b32 s81, v11, s18
s_add_u32 s18, s18, 1
v_readlane_b32 s82, v10, s18
v_readlane_b32 s83, v11, s18
s_add_u32 s18, s18, 1
v_readlane_b32 s84, v10, s18
v_readlane_b32 s85, v11, s18
s_add_u32 s18, s18, 1
v_readlane_b32 s86, v10, s18
v_readlane_b32 s87, v11, s18
s_add_u32 s18, s18, 1
v_mov_b32 v24, 0
v_mov_b32 v25, 0
v_mov_b32 v26, 0
v_mov_b32 v27, 0
v_mov_b32 v28, 0
v_mov_b32 v29, 0
v_mov_b32 v30, 0
v_mov_b32 v31, 0
v_mov_b32 v32, 0
v_mov_b32 v33, 0
v_mov_b32 v34, 0
v_mov_b32 v35, 0
v_mov_b32 v36, 0
v_mov_b32 v37, 0
v_mov_b32 v38, 0
v_mov_b32 v39, 0
v_mov_b32 v64, s80
v_mov_b32 v65, s81
v_mov_b32 v66, s82
v_mov_b32 v67, s83
v_mov_b32 v68, s84
v_mov_b32 v69, s85
v_mov_b32 v70, s86
v_mov_b32 v71, s87
s_waitcnt vmcnt(0)
v_perm_b32 v10, v232, v224, s50
v_perm_b32 v11, v232, v224, s51
v_dot2c_f32_bf16 v24, v10, v64
v_dot2c_f32_bf16 v25, v11, v64
v_perm_b32 v10, v233, v225, s50
v_perm_b32 v11, v233, v225, s51
v_dot2c_f32_bf16 v26, v10, v64
v_dot2c_f32_bf16 v27, v11, v64
v_perm_b32 v10, v234, v226, s50
v_perm_b32 v11, v234, v226, s51
v_dot2c_f32_bf16 v28, v10, v64
v_dot2c_f32_bf16 v29, v11, v64
v_perm_b32 v10, v235, v227, s50
v_perm_b32 v11, v235, v227, s51
v_dot2c_f32_bf16 v30, v10, v64
v_dot2c_f32_bf16 v31, v11, v64
v_perm_b32 v10, v236, v228, s50
v_perm_b32 v11, v236, v228, s51
v_dot2c_f32_bf16 v32, v10, v64
v_dot2c_f32_bf16 v33, v11, v64
v_perm_b32 v10, v237, v229, s50
v_perm_b32 v11, v237, v229, s51
v_dot2c_f32_bf16 v34, v10, v64
v_dot2c_f32_bf16 v35, v11, v64
v_perm_b32 v10, v238, v230, s50
v_perm_b32 v11, v238, v230, s51
v_dot2c_f32_bf16 v36, v10, v64
v_dot2c_f32_bf16 v37, v11, v64
v_perm_b32 v10, v239, v231, s50
v_perm_b32 v11, v239, v231, s51
v_dot2c_f32_bf16 v38, v10, v64
v_dot2c_f32_bf16 v39, v11, v64
v_perm_b32 v10, v248, v240, s50
v_perm_b32 v11, v248, v240, s51
v_dot2c_f32_bf16 v24, v10, v65
v_dot2c_f32_bf16 v25, v11, v65
v_perm_b32 v10, v249, v241, s50
v_perm_b32 v11, v249, v241, s51
v_dot2c_f32_bf16 v26, v10, v65
v_dot2c_f32_bf16 v27, v11, v65
v_perm_b32 v10, v250, v242, s50
v_perm_b32 v11, v250, v242, s51
v_dot2c_f32_bf16 v28, v10, v65
v_dot2c_f32_bf16 v29, v11, v65
v_perm_b32 v10, v251, v243, s50
v_perm_b32 v11, v251, v243, s51
v_dot2c_f32_bf16 v30, v10, v65
v_dot2c_f32_bf16 v31, v11, v65
v_perm_b32 v10, v252, v244, s50
v_perm_b32 v11, v252, v244, s51
v_dot2c_f32_bf16 v32, v10, v65
v_dot2c_f32_bf16 v33, v11, v65
v_perm_b32 v10, v253, v245, s50
v_perm_b32 v11, v253, v245, s51
v_dot2c_f32_bf16 v34, v10, v65
v_dot2c_f32_bf16 v35, v11, v65
v_perm_b32 v10, v254, v246, s50
v_perm_b32 v11, v254, v246, s51
v_dot2c_f32_bf16 v36, v10, v65
v_dot2c_f32_bf16 v37, v11, v65
v_perm_b32 v10, v255, v247, s50
v_perm_b32 v11, v255, v247, s51
v_dot2c_f32_bf16 v38, v10, v65
v_dot2c_f32_bf16 v39, v11, v65
v_perm_b32 v10, v136, v128, s50
v_perm_b32 v11, v136, v128, s51
v_dot2c_f32_bf16 v24, v10, v66
v_dot2c_f32_bf16 v25, v11, v66
v_perm_b32 v10, v137, v129, s50
v_perm_b32 v11, v137, v129, s51
v_dot2c_f32_bf16 v26, v10, v66
v_dot2c_f32_bf16 v27, v11, v66
v_perm_b32 v10, v138, v130, s50
v_perm_b32 v11, v138, v130, s51
v_dot2c_f32_bf16 v28, v10, v66
v_dot2c_f32_bf16 v29, v11, v66
v_perm_b32 v10, v139, v131, s50
v_perm_b32 v11, v139, v131, s51
v_dot2c_f32_bf16 v30, v10, v66
v_dot2c_f32_bf16 v31, v11, v66
v_perm_b32 v10, v140, v132, s50
v_perm_b32 v11, v140, v132, s51
v_dot2c_f32_bf16 v32, v10, v66
v_dot2c_f32_bf16 v33, v11, v66
v_perm_b32 v10, v141, v133, s50
v_perm_b32 v11, v141, v133, s51
v_dot2c_f32_bf16 v34, v10, v66
v_dot2c_f32_bf16 v35, v11, v66
v_perm_b32 v10, v142, v134, s50
v_perm_b32 v11, v142, v134, s51
v_dot2c_f32_bf16 v36, v10, v66
v_dot2c_f32_bf16 v37, v11, v66
v_perm_b32 v10, v143, v135, s50
v_perm_b32 v11, v143, v135, s51
v_dot2c_f32_bf16 v38, v10, v66
v_dot2c_f32_bf16 v39, v11, v66
v_perm_b32 v10, v152, v144, s50
v_perm_b32 v11, v152, v144, s51
v_dot2c_f32_bf16 v24, v10, v67
v_dot2c_f32_bf16 v25, v11, v67
v_perm_b32 v10, v153, v145, s50
v_perm_b32 v11, v153, v145, s51
v_dot2c_f32_bf16 v26, v10, v67
v_dot2c_f32_bf16 v27, v11, v67
v_perm_b32 v10, v154, v146, s50
v_perm_b32 v11, v154, v146, s51
v_dot2c_f32_bf16 v28, v10, v67
v_dot2c_f32_bf16 v29, v11, v67
v_perm_b32 v10, v155, v147, s50
v_perm_b32 v11, v155, v147, s51
v_dot2c_f32_bf16 v30, v10, v67
v_dot2c_f32_bf16 v31, v11, v67
v_perm_b32 v10, v156, v148, s50
v_perm_b32 v11, v156, v148, s51
v_dot2c_f32_bf16 v32, v10, v67
v_dot2c_f32_bf16 v33, v11, v67
v_perm_b32 v10, v157, v149, s50
v_perm_b32 v11, v157, v149, s51
v_dot2c_f32_bf16 v34, v10, v67
v_dot2c_f32_bf16 v35, v11, v67
v_perm_b32 v10, v158, v150, s50
v_perm_b32 v11, v158, v150, s51
v_dot2c_f32_bf16 v36, v10, v67
v_dot2c_f32_bf16 v37, v11, v67
v_perm_b32 v10, v159, v151, s50
v_perm_b32 v11, v159, v151, s51
v_dot2c_f32_bf16 v38, v10, v67
v_dot2c_f32_bf16 v39, v11, v67
v_perm_b32 v10, v168, v160, s50
v_perm_b32 v11, v168, v160, s51
v_dot2c_f32_bf16 v24, v10, v68
v_dot2c_f32_bf16 v25, v11, v68
v_perm_b32 v10, v169, v161, s50
v_perm_b32 v11, v169, v161, s51
v_dot2c_f32_bf16 v26, v10, v68
v_dot2c_f32_bf16 v27, v11, v68
v_perm_b32 v10, v170, v162, s50
v_perm_b32 v11, v170, v162, s51
v_dot2c_f32_bf16 v28, v10, v68
v_dot2c_f32_bf16 v29, v11, v68
v_perm_b32 v10, v171, v163, s50
v_perm_b32 v11, v171, v163, s51
v_dot2c_f32_bf16 v30, v10, v68
v_dot2c_f32_bf16 v31, v11, v68
v_perm_b32 v10, v172, v164, s50
v_perm_b32 v11, v172, v164, s51
v_dot2c_f32_bf16 v32, v10, v68
v_dot2c_f32_bf16 v33, v11, v68
v_perm_b32 v10, v173, v165, s50
v_perm_b32 v11, v173, v165, s51
v_dot2c_f32_bf16 v34, v10, v68
v_dot2c_f32_bf16 v35, v11, v68
v_perm_b32 v10, v174, v166, s50
v_perm_b32 v11, v174, v166, s51
v_dot2c_f32_bf16 v36, v10, v68
v_dot2c_f32_bf16 v37, v11, v68
v_perm_b32 v10, v175, v167, s50
v_perm_b32 v11, v175, v167, s51
v_dot2c_f32_bf16 v38, v10, v68
v_dot2c_f32_bf16 v39, v11, v68
v_perm_b32 v10, v184, v176, s50
v_perm_b32 v11, v184, v176, s51
v_dot2c_f32_bf16 v24, v10, v69
v_dot2c_f32_bf16 v25, v11, v69
v_perm_b32 v10, v185, v177, s50
v_perm_b32 v11, v185, v177, s51
v_dot2c_f32_bf16 v26, v10, v69
v_dot2c_f32_bf16 v27, v11, v69
v_perm_b32 v10, v186, v178, s50
v_perm_b32 v11, v186, v178, s51
v_dot2c_f32_bf16 v28, v10, v69
v_dot2c_f32_bf16 v29, v11, v69
v_perm_b32 v10, v187, v179, s50
v_perm_b32 v11, v187, v179, s51
v_dot2c_f32_bf16 v30, v10, v69
v_dot2c_f32_bf16 v31, v11, v69
v_perm_b32 v10, v188, v180, s50
v_perm_b32 v11, v188, v180, s51
v_dot2c_f32_bf16 v32, v10, v69
v_dot2c_f32_bf16 v33, v11, v69
v_perm_b32 v10, v189, v181, s50
v_perm_b32 v11, v189, v181, s51
v_dot2c_f32_bf16 v34, v10, v69
v_dot2c_f32_bf16 v35, v11, v69
v_perm_b32 v10, v190, v182, s50
v_perm_b32 v11, v190, v182, s51
v_dot2c_f32_bf16 v36, v10, v69
v_dot2c_f32_bf16 v37, v11, v69
v_perm_b32 v10, v191, v183, s50
v_perm_b32 v11, v191, v183, s51
v_dot2c_f32_bf16 v38, v10, v69
v_dot2c_f32_bf16 v39, v11, v69
v_perm_b32 v10, v200, v192, s50
v_perm_b32 v11, v200, v192, s51
v_dot2c_f32_bf16 v24, v10, v70
v_dot2c_f32_bf16 v25, v11, v70
v_perm_b32 v10, v201, v193, s50
v_perm_b32 v11, v201, v193, s51
v_dot2c_f32_bf16 v26, v10, v70
v_dot2c_f32_bf16 v27, v11, v70
v_perm_b32 v10, v202, v194, s50
v_perm_b32 v11, v202, v194, s51
v_dot2c_f32_bf16 v28, v10, v70
v_dot2c_f32_bf16 v29, v11, v70
v_perm_b32 v10, v203, v195, s50
v_perm_b32 v11, v203, v195, s51
v_dot2c_f32_bf16 v30, v10, v70
v_dot2c_f32_bf16 v31, v11, v70
v_perm_b32 v10, v204, v196, s50
v_perm_b32 v11, v204, v196, s51
v_dot2c_f32_bf16 v32, v10, v70
v_dot2c_f32_bf16 v33, v11, v70
v_perm_b32 v10, v205, v197, s50
v_perm_b32 v11, v205, v197, s51
v_dot2c_f32_bf16 v34, v10, v70
v_dot2c_f32_bf16 v35, v11, v70
v_perm_b32 v10, v206, v198, s50
v_perm_b32 v11, v206, v198, s51
v_dot2c_f32_bf16 v36, v10, v70
v_dot2c_f32_bf16 v37, v11, v70
v_perm_b32 v10, v207, v199, s50
v_perm_b32 v11, v207, v199, s51
v_dot2c_f32_bf16 v38, v10, v70
v_dot2c_f32_bf16 v39, v11, v70
v_perm_b32 v10, v216, v208, s50
v_perm_b32 v11, v216, v208, s51
v_dot2c_f32_bf16 v24, v10, v71
v_dot2c_f32_bf16 v25, v11, v71
v_perm_b32 v10, v217, v209, s50
v_perm_b32 v11, v217, v209, s51
v_dot2c_f32_bf16 v26, v10, v71
v_dot2c_f32_bf16 v27, v11, v71
v_perm_b32 v10, v218, v210, s50
v_perm_b32 v11, v218, v210, s51
v_dot2c_f32_bf16 v28, v10, v71
v_dot2c_f32_bf16 v29, v11, v71
v_perm_b32 v10, v219, v211, s50
v_perm_b32 v11, v219, v211, s51
v_dot2c_f32_bf16 v30, v10, v71
v_dot2c_f32_bf16 v31, v11, v71
v_perm_b32 v10, v220, v212, s50
v_perm_b32 v11, v220, v212, s51
v_dot2c_f32_bf16 v32, v10, v71
v_dot2c_f32_bf16 v33, v11, v71
v_perm_b32 v10, v221, v213, s50
v_perm_b32 v11, v221, v213, s51
v_dot2c_f32_bf16 v34, v10, v71
v_dot2c_f32_bf16 v35, v11, v71
v_perm_b32 v10, v222, v214, s50
v_perm_b32 v11, v222, v214, s51
v_dot2c_f32_bf16 v36, v10, v71
v_dot2c_f32_bf16 v37, v11, v71
v_perm_b32 v10, v223, v215, s50
v_perm_b32 v11, v223, v215, s51
v_dot2c_f32_bf16 v38, v10, v71
v_dot2c_f32_bf16 v39, v11, v71
ds_write_b128 v43, v[24:27] offset:0
ds_write_b128 v43, v[28:31] offset:1024
ds_write_b128 v43, v[32:35] offset:2048
ds_write_b128 v43, v[36:39] offset:3072
s_lshl_b32 s18, s12, 10
v_add_u32 v10, s18, v6
s_waitcnt lgkmcnt(0)
s_barrier
ds_read_b128 v[64:67], v10 offset:0
ds_read_b128 v[68:71], v10 offset:4096
ds_read_b128 v[72:75], v10 offset:8192
ds_read_b128 v[76:79], v10 offset:12288
s_lshr_b32 s18, s12, 1
s_lshl_b32 s18, s18, 11
s_and_b32 s19, s12, 1
s_lshl_b32 s19, s19, 4
s_add_u32 s18, s18, s19
s_lshl_b32 s19, s64, 12
s_add_u32 s18, s18, s19
s_add_u32 s18, s18, 0x8400000
v_lshlrev_b32 v11, 5, v0
s_waitcnt lgkmcnt(0)
v_add_f32 v64, v64, v68
v_add_f32 v72, v72, v76
v_add_f32 v64, v64, v72
v_add_f32 v65, v65, v69
v_add_f32 v73, v73, v77
v_add_f32 v65, v65, v73
v_add_f32 v66, v66, v70
v_add_f32 v74, v74, v78
v_add_f32 v66, v66, v74
v_add_f32 v67, v67, v71
v_add_f32 v75, v75, v79
v_add_f32 v67, v67, v75
buffer_store_dwordx4 v[64:67], v11, s[4:7], s18 offen sc1
s_waitcnt vmcnt(0)
s_barrier
s_cmp_eq_u32 s12, 0
s_cbranch_scc0 L_p_mlpd
s_lshl_b32 s18, s64, 2
s_add_u32 s18, s18, 0x8188000
v_mov_b32 v11, 0
s_mov_b64 exec, 1
buffer_store_dword v7, v11, s[4:7], s18 offen sc1
s_mov_b64 exec, -1
L_p_mlpd:
s_mov_b32 s8, s46
s_mov_b32 s9, s47
s_mov_b32 s10, 0x800000
s_mov_b32 s11, 0x20000
s_load_dwordx2 s[28:29], s[0:1], 104
s_and_b32 s18, s62, 1
v_bfe_u32 v12, v0, 4, 2
v_lshlrev_b32 v12, 1, v12
v_and_b32 v10, 7, v0
v_xor_b32 v10, v10, v12
v_lshlrev_b32 v10, 4, v10
s_lshl_b32 s84, s18, 1
v_bfe_u32 v12, v0, 3, 2
v_xor_b32 v12, s84, v12
v_lshlrev_b32 v12, 5, v12
v_and_b32 v13, 3, v0
v_lshl_add_u32 v12, v13, 3, v12
v_lshrrev_b32 v13, 2, v0
v_lshl_add_u32 v12, v13, 7, v12
s_lshl_b32 s84, s12, 15
v_add_u32 v12, s84, v12
v_xor_b32 v13, 32, v12
s_lshl_b32 s18, s12, 21
s_and_b32 s19, s57, 0x780
s_add_u32 s18, s18, s19
v_lshrrev_b32 v9, 3, v0
v_lshl_add_u32 v9, v9, 11, v10
v_add_u32 v9, s18, v9
s_add_u32 m0, s84, 0
s_mov_b32 s18, 0x0
buffer_load_dwordx4 v9, s[8:11], s18 offen  lds
s_add_u32 m0, s84, 1024
s_mov_b32 s18, 0x4000
buffer_load_dwordx4 v9, s[8:11], s18 offen  lds
s_add_u32 m0, s84, 2048
s_mov_b32 s18, 0x8000
buffer_load_dwordx4 v9, s[8:11], s18 offen  lds
s_add_u32 m0, s84, 3072
s_mov_b32 s18, 0xc000
buffer_load_dwordx4 v9, s[8:11], s18 offen  lds
s_add_u32 m0, s84, 4096
s_mov_b32 s18, 0x10000
buffer_load_dwordx4 v9, s[8:11], s18 offen  lds
s_add_u32 m0, s84, 5120
s_mov_b32 s18, 0x14000
buffer_load_dwordx4 v9, s[8:11], s18 offen  lds
s_add_u32 m0, s84, 6144
s_mov_b32 s18, 0x18000
buffer_load_dwordx4 v9, s[8:11], s18 offen  lds
s_add_u32 m0, s84, 7168
s_mov_b32 s18, 0x1c000
buffer_load_dwordx4 v9, s[8:11], s18 offen  lds
s_add_u32 m0, s84, 8192
s_mov_b32 s18, 0x20000
buffer_load_dwordx4 v9, s[8:11], s18 offen  lds
s_add_u32 m0, s84, 9216
s_mov_b32 s18, 0x24000
buffer_load_dwordx4 v9, s[8:11], s18 offen  lds
s_add_u32 m0, s84, 10240
s_mov_b32 s18, 0x28000
buffer_load_dwordx4 v9, s[8:11], s18 offen  lds
s_add_u32 m0, s84, 11264
s_mov_b32 s18, 0x2c000
buffer_load_dwordx4 v9, s[8:11], s18 offen  lds
s_add_u32 m0, s84, 12288
s_mov_b32 s18, 0x30000
buffer_load_dwordx4 v9, s[8:11], s18 offen  lds
s_add_u32 m0, s84, 13312
s_mov_b32 s18, 0x34000
buffer_load_dwordx4 v9, s[8:11], s18 offen  lds
s_add_u32 m0, s84, 14336
s_mov_b32 s18, 0x38000
buffer_load_dwordx4 v9, s[8:11], s18 offen  lds
s_add_u32 m0, s84, 15360
s_mov_b32 s18, 0x3c000
buffer_load_dwordx4 v9, s[8:11], s18 offen  lds
s_add_u32 m0, s84, 16384
s_mov_b32 s18, 0x40000
buffer_load_dwordx4 v9, s[8:11], s18 offen  lds
s_add_u32 m0, s84, 17408
s_mov_b32 s18, 0x44000
buffer_load_dwordx4 v9, s[8:11], s18 offen  lds
s_add_u32 m0, s84, 18432
s_mov_b32 s18, 0x48000
buffer_load_dwordx4 v9, s[8:11], s18 offen  lds
s_add_u32 m0, s84, 19456
s_mov_b32 s18, 0x4c000
buffer_load_dwordx4 v9, s[8:11], s18 offen  lds
s_add_u32 m0, s84, 20480
s_mov_b32 s18, 0x50000
buffer_load_dwordx4 v9, s[8:11], s18 offen  lds
s_add_u32 m0, s84, 21504
s_mov_b32 s18, 0x54000
buffer_load_dwordx4 v9, s[8:11], s18 offen  lds
s_add_u32 m0, s84, 22528
s_mov_b32 s18, 0x58000
buffer_load_dwordx4 v9, s[8:11], s18 offen  lds
s_add_u32 m0, s84, 23552
s_mov_b32 s18, 0x5c000
buffer_load_dwordx4 v9, s[8:11], s18 offen  lds
s_add_u32 m0, s84, 24576
s_mov_b32 s18, 0x60000
buffer_load_dwordx4 v9, s[8:11], s18 offen  lds
s_add_u32 m0, s84, 25600
s_mov_b32 s18, 0x64000
buffer_load_dwordx4 v9, s[8:11], s18 offen  lds
s_add_u32 m0, s84, 26624
s_mov_b32 s18, 0x68000
buffer_load_dwordx4 v9, s[8:11], s18 offen  lds
s_add_u32 m0, s84, 27648
s_mov_b32 s18, 0x6c000
buffer_load_dwordx4 v9, s[8:11], s18 offen  lds
s_add_u32 m0, s84, 28672
s_mov_b32 s18, 0x70000
buffer_load_dwordx4 v9, s[8:11], s18 offen  lds
s_add_u32 m0, s84, 29696
s_mov_b32 s18, 0x74000
buffer_load_dwordx4 v9, s[8:11], s18 offen  lds
s_add_u32 m0, s84, 30720
s_mov_b32 s18, 0x78000
buffer_load_dwordx4 v9, s[8:11], s18 offen  lds
s_add_u32 m0, s84, 31744
s_mov_b32 s18, 0x7c000
buffer_load_dwordx4 v9, s[8:11], s18 offen  lds
s_waitcnt vmcnt(16)
ds_read_b64_tr_b16 a[0:1], v12 offset:0
ds_read_b64_tr_b16 a[4:5], v13 offset:0
ds_read_b64_tr_b16 a[2:3], v12 offset:2048
ds_read_b64_tr_b16 a[6:7], v13 offset:2048
ds_read_b64_tr_b16 a[8:9], v12 offset:4096
ds_read_b64_tr_b16 a[12:13], v13 offset:4096
ds_read_b64_tr_b16 a[10:11], v12 offset:6144
ds_read_b64_tr_b16 a[14:15], v13 offset:6144
ds_read_b64_tr_b16 a[16:17], v12 offset:8192
ds_read_b64_tr_b16 a[20:21], v13 offset:8192
ds_read_b64_tr_b16 a[18:19], v12 offset:10240
ds_read_b64_tr_b16 a[22:23], v13 offset:10240
ds_read_b64_tr_b16 a[24:25], v12 offset:12288
ds_read_b64_tr_b16 a[28:29], v13 offset:12288
ds_read_b64_tr_b16 a[26:27], v12 offset:14336
ds_read_b64_tr_b16 a[30:31], v13 offset:14336
s_waitcnt lgkmcnt(0)
s_add_u32 m0, s84, 0
s_mov_b32 s18, 0x80000
buffer_load_dwordx4 v9, s[8:11], s18 offen  lds
s_add_u32 m0, s84, 1024
s_mov_b32 s18, 0x84000
buffer_load_dwordx4 v9, s[8:11], s18 offen  lds
s_add_u32 m0, s84, 2048
s_mov_b32 s18, 0x88000
buffer_load_dwordx4 v9, s[8:11], s18 offen  lds
s_add_u32 m0, s84, 3072
s_mov_b32 s18, 0x8c000
buffer_load_dwordx4 v9, s[8:11], s18 offen  lds
s_add_u32 m0, s84, 4096
s_mov_b32 s18, 0x90000
buffer_load_dwordx4 v9, s[8:11], s18 offen  lds
s_add_u32 m0, s84, 5120
s_mov_b32 s18, 0x94000
buffer_load_dwordx4 v9, s[8:11], s18 offen  lds
s_add_u32 m0, s84, 6144
s_mov_b32 s18, 0x98000
buffer_load_dwordx4 v9, s[8:11], s18 offen  lds
s_add_u32 m0, s84, 7168
s_mov_b32 s18, 0x9c000
buffer_load_dwordx4 v9, s[8:11], s18 offen  lds
s_add_u32 m0, s84, 8192
s_mov_b32 s18, 0xa0000
buffer_load_dwordx4 v9, s[8:11], s18 offen  lds
s_add_u32 m0, s84, 9216
s_mov_b32 s18, 0xa4000
buffer_load_dwordx4 v9, s[8:11], s18 offen  lds
s_add_u32 m0, s84, 10240
s_mov_b32 s18, 0xa8000
buffer_load_dwordx4 v9, s[8:11], s18 offen  lds
s_add_u32 m0, s84, 11264
s_mov_b32 s18, 0xac000
buffer_load_dwordx4 v9, s[8:11], s18 offen  lds
s_add_u32 m0, s84, 12288
s_mov_b32 s18, 0xb0000
buffer_load_dwordx4 v9, s[8:11], s18 offen  lds
s_add_u32 m0, s84, 13312
s_mov_b32 s18, 0xb4000
buffer_load_dwordx4 v9, s[8:11], s18 offen  lds
s_add_u32 m0, s84, 14336
s_mov_b32 s18, 0xb8000
buffer_load_dwordx4 v9, s[8:11], s18 offen  lds
s_add_u32 m0, s84, 15360
s_mov_b32 s18, 0xbc000
buffer_load_dwordx4 v9, s[8:11], s18 offen  lds
s_waitcnt vmcnt(16)
ds_read_b64_tr_b16 a[32:33], v12 offset:16384
ds_read_b64_tr_b16 a[36:37], v13 offset:16384
ds_read_b64_tr_b16 a[34:35], v12 offset:18432
ds_read_b64_tr_b16 a[38:39], v13 offset:18432
ds_read_b64_tr_b16 a[40:41], v12 offset:20480
ds_read_b64_tr_b16 a[44:45], v13 offset:20480
ds_read_b64_tr_b16 a[42:43], v12 offset:22528
ds_read_b64_tr_b16 a[46:47], v13 offset:22528
ds_read_b64_tr_b16 a[48:49], v12 offset:24576
ds_read_b64_tr_b16 a[52:53], v13 offset:24576
ds_read_b64_tr_b16 a[50:51], v12 offset:26624
ds_read_b64_tr_b16 a[54:55], v13 offset:26624
ds_read_b64_tr_b16 a[56:57], v12 offset:28672
ds_read_b64_tr_b16 a[60:61], v13 offset:28672
ds_read_b64_tr_b16 a[58:59], v12 offset:30720
ds_read_b64_tr_b16 a[62:63], v13 offset:30720
s_waitcnt lgkmcnt(0)
s_add_u32 m0, s84, 16384
s_mov_b32 s18, 0xc0000
buffer_load_dwordx4 v9, s[8:11], s18 offen  lds
s_add_u32 m0, s84, 17408
s_mov_b32 s18, 0xc4000
buffer_load_dwordx4 v9, s[8:11], s18 offen  lds
s_add_u32 m0, s84, 18432
s_mov_b32 s18, 0xc8000
buffer_load_dwordx4 v9, s[8:11], s18 offen  lds
s_add_u32 m0, s84, 19456
s_mov_b32 s18, 0xcc000
buffer_load_dwordx4 v9, s[8:11], s18 offen  lds
s_add_u32 m0, s84, 20480
s_mov_b32 s18, 0xd0000
buffer_load_dwordx4 v9, s[8:11], s18 offen  lds
s_add_u32 m0, s84, 21504
s_mov_b32 s18, 0xd4000
buffer_load_dwordx4 v9, s[8:11], s18 offen  lds
s_add_u32 m0, s84, 22528
s_mov_b32 s18, 0xd8000
buffer_load_dwordx4 v9, s[8:11], s18 offen  lds
s_add_u32 m0, s84, 23552
s_mov_b32 s18, 0xdc000
buffer_load_dwordx4 v9, s[8:11], s18 offen  lds
s_add_u32 m0, s84, 24576
s_mov_b32 s18, 0xe0000
buffer_load_dwordx4 v9, s[8:11], s18 offen  lds
s_add_u32 m0, s84, 25600
s_mov_b32 s18, 0xe4000
buffer_load_dwordx4 v9, s[8:11], s18 offen  lds
s_add_u32 m0, s84, 26624
s_mov_b32 s18, 0xe8000
buffer_load_dwordx4 v9, s[8:11], s18 offen  lds
s_add_u32 m0, s84, 27648
s_mov_b32 s18, 0xec000
buffer_load_dwordx4 v9, s[8:11], s18 offen  lds
s_add_u32 m0, s84, 28672
s_mov_b32 s18, 0xf0000
buffer_load_dwordx4 v9, s[8:11], s18 offen  lds
s_add_u32 m0, s84, 29696
s_mov_b32 s18, 0xf4000
buffer_load_dwordx4 v9, s[8:11], s18 offen  lds
s_add_u32 m0, s84, 30720
s_mov_b32 s18, 0xf8000
buffer_load_dwordx4 v9, s[8:11], s18 offen  lds
s_add_u32 m0, s84, 31744
s_mov_b32 s18, 0xfc000
buffer_load_dwordx4 v9, s[8:11], s18 offen  lds
s_waitcnt vmcnt(16)
ds_read_b64_tr_b16 a[64:65], v12 offset:0
ds_read_b64_tr_b16 a[68:69], v13 offset:0
ds_read_b64_tr_b16 a[66:67], v12 offset:2048
ds_read_b64_tr_b16 a[70:71], v13 offset:2048
ds_read_b64_tr_b16 a[72:73], v12 offset:4096
ds_read_b64_tr_b16 a[76:77], v13 offset:4096
ds_read_b64_tr_b16 a[74:75], v12 offset:6144
ds_read_b64_tr_b16 a[78:79], v13 offset:6144
ds_read_b64_tr_b16 a[80:81], v12 offset:8192
ds_read_b64_tr_b16 a[84:85], v13 offset:8192
ds_read_b64_tr_b16 a[82:83], v12 offset:10240
ds_read_b64_tr_b16 a[86:87], v13 offset:10240
ds_read_b64_tr_b16 a[88:89], v12 offset:12288
ds_read_b64_tr_b16 a[92:93], v13 offset:12288
ds_read_b64_tr_b16 a[90:91], v12 offset:14336
ds_read_b64_tr_b16 a[94:95], v13 offset:14336
s_waitcnt lgkmcnt(0)
s_add_u32 m0, s84, 0
s_mov_b32 s18, 0x100000
buffer_load_dwordx4 v9, s[8:11], s18 offen  lds
s_add_u32 m0, s84, 1024
s_mov_b32 s18, 0x104000
buffer_load_dwordx4 v9, s[8:11], s18 offen  lds
s_add_u32 m0, s84, 2048
s_mov_b32 s18, 0x108000
buffer_load_dwordx4 v9, s[8:11], s18 offen  lds
s_add_u32 m0, s84, 3072
s_mov_b32 s18, 0x10c000
buffer_load_dwordx4 v9, s[8:11], s18 offen  lds
s_add_u32 m0, s84, 4096
s_mov_b32 s18, 0x110000
buffer_load_dwordx4 v9, s[8:11], s18 offen  lds
s_add_u32 m0, s84, 5120
s_mov_b32 s18, 0x114000
buffer_load_dwordx4 v9, s[8:11], s18 offen  lds
s_add_u32 m0, s84, 6144
s_mov_b32 s18, 0x118000
buffer_load_dwordx4 v9, s[8:11], s18 offen  lds
s_add_u32 m0, s84, 7168
s_mov_b32 s18, 0x11c000
buffer_load_dwordx4 v9, s[8:11], s18 offen  lds
s_add_u32 m0, s84, 8192
s_mov_b32 s18, 0x120000
buffer_load_dwordx4 v9, s[8:11], s18 offen  lds
s_add_u32 m0, s84, 9216
s_mov_b32 s18, 0x124000
buffer_load_dwordx4 v9, s[8:11], s18 offen  lds
s_add_u32 m0, s84, 10240
s_mov_b32 s18, 0x128000
buffer_load_dwordx4 v9, s[8:11], s18 offen  lds
s_add_u32 m0, s84, 11264
s_mov_b32 s18, 0x12c000
buffer_load_dwordx4 v9, s[8:11], s18 offen  lds
s_add_u32 m0, s84, 12288
s_mov_b32 s18, 0x130000
buffer_load_dwordx4 v9, s[8:11], s18 offen  lds
s_add_u32 m0, s84, 13312
s_mov_b32 s18, 0x134000
buffer_load_dwordx4 v9, s[8:11], s18 offen  lds
s_add_u32 m0, s84, 14336
s_mov_b32 s18, 0x138000
buffer_load_dwordx4 v9, s[8:11], s18 offen  lds
s_add_u32 m0, s84, 15360
s_mov_b32 s18, 0x13c000
buffer_load_dwordx4 v9, s[8:11], s18 offen  lds
s_waitcnt vmcnt(16)
ds_read_b64_tr_b16 a[96:97], v12 offset:16384
ds_read_b64_tr_b16 a[100:101], v13 offset:16384
ds_read_b64_tr_b16 a[98:99], v12 offset:18432
ds_read_b64_tr_b16 a[102:103], v13 offset:18432
ds_read_b64_tr_b16 a[104:105], v12 offset:20480
ds_read_b64_tr_b16 a[108:109], v13 offset:20480
ds_read_b64_tr_b16 a[106:107], v12 offset:22528
ds_read_b64_tr_b16 a[110:111], v13 offset:22528
ds_read_b64_tr_b16 a[112:113], v12 offset:24576
ds_read_b64_tr_b16 a[116:117], v13 offset:24576
ds_read_b64_tr_b16 a[114:115], v12 offset:26624
ds_read_b64_tr_b16 a[118:119], v13 offset:26624
ds_read_b64_tr_b16 a[120:121], v12 offset:28672
ds_read_b64_tr_b16 a[124:125], v13 offset:28672
ds_read_b64_tr_b16 a[122:123], v12 offset:30720
ds_read_b64_tr_b16 a[126:127], v13 offset:30720
s_waitcnt lgkmcnt(0)
s_add_u32 m0, s84, 16384
s_mov_b32 s18, 0x140000
buffer_load_dwordx4 v9, s[8:11], s18 offen  lds
s_add_u32 m0, s84, 17408
s_mov_b32 s18, 0x144000
buffer_load_dwordx4 v9, s[8:11], s18 offen  lds
s_add_u32 m0, s84, 18432
s_mov_b32 s18, 0x148000
buffer_load_dwordx4 v9, s[8:11], s18 offen  lds
s_add_u32 m0, s84, 19456
s_mov_b32 s18, 0x14c000
buffer_load_dwordx4 v9, s[8:11], s18 offen  lds
s_add_u32 m0, s84, 20480
s_mov_b32 s18, 0x150000
buffer_load_dwordx4 v9, s[8:11], s18 offen  lds
s_add_u32 m0, s84, 21504
s_mov_b32 s18, 0x154000
buffer_load_dwordx4 v9, s[8:11], s18 offen  lds
s_add_u32 m0, s84, 22528
s_mov_b32 s18, 0x158000
buffer_load_dwordx4 v9, s[8:11], s18 offen  lds
s_add_u32 m0, s84, 23552
s_mov_b32 s18, 0x15c000
buffer_load_dwordx4 v9, s[8:11], s18 offen  lds
s_add_u32 m0, s84, 24576
s_mov_b32 s18, 0x160000
buffer_load_dwordx4 v9, s[8:11], s18 offen  lds
s_add_u32 m0, s84, 25600
s_mov_b32 s18, 0x164000
buffer_load_dwordx4 v9, s[8:11], s18 offen  lds
s_add_u32 m0, s84, 26624
s_mov_b32 s18, 0x168000
buffer_load_dwordx4 v9, s[8:11], s18 offen  lds
s_add_u32 m0, s84, 27648
s_mov_b32 s18, 0x16c000
buffer_load_dwordx4 v9, s[8:11], s18 offen  lds
s_add_u32 m0, s84, 28672
s_mov_b32 s18, 0x170000
buffer_load_dwordx4 v9, s[8:11], s18 offen  lds
s_add_u32 m0, s84, 29696
s_mov_b32 s18, 0x174000
buffer_load_dwordx4 v9, s[8:11], s18 offen  lds
s_add_u32 m0, s84, 30720
s_mov_b32 s18, 0x178000
buffer_load_dwordx4 v9, s[8:11], s18 offen  lds
s_add_u32 m0, s84, 31744
s_mov_b32 s18, 0x17c000
buffer_load_dwordx4 v9, s[8:11], s18 offen  lds
s_waitcnt vmcnt(16)
ds_read_b64_tr_b16 a[128:129], v12 offset:0
ds_read_b64_tr_b16 a[132:133], v13 offset:0
ds_read_b64_tr_b16 a[130:131], v12 offset:2048
ds_read_b64_tr_b16 a[134:135], v13 offset:2048
ds_read_b64_tr_b16 a[136:137], v12 offset:4096
ds_read_b64_tr_b16 a[140:141], v13 offset:4096
ds_read_b64_tr_b16 a[138:139], v12 offset:6144
ds_read_b64_tr_b16 a[142:143], v13 offset:6144
ds_read_b64_tr_b16 a[144:145], v12 offset:8192
ds_read_b64_tr_b16 a[148:149], v13 offset:8192
ds_read_b64_tr_b16 a[146:147], v12 offset:10240
ds_read_b64_tr_b16 a[150:151], v13 offset:10240
ds_read_b64_tr_b16 a[152:153], v12 offset:12288
ds_read_b64_tr_b16 a[156:157], v13 offset:12288
ds_read_b64_tr_b16 a[154:155], v12 offset:14336
ds_read_b64_tr_b16 a[158:159], v13 offset:14336
s_waitcnt lgkmcnt(0)
s_add_u32 m0, s84, 0
s_mov_b32 s18, 0x180000
buffer_load_dwordx4 v9, s[8:11], s18 offen  lds
s_add_u32 m0, s84, 1024
s_mov_b32 s18, 0x184000
buffer_load_dwordx4 v9, s[8:11], s18 offen  lds
s_add_u32 m0, s84, 2048
s_mov_b32 s18, 0x188000
buffer_load_dwordx4 v9, s[8:11], s18 offen  lds
s_add_u32 m0, s84, 3072
s_mov_b32 s18, 0x18c000
buffer_load_dwordx4 v9, s[8:11], s18 offen  lds
s_add_u32 m0, s84, 4096
s_mov_b32 s18, 0x190000
buffer_load_dwordx4 v9, s[8:11], s18 offen  lds
s_add_u32 m0, s84, 5120
s_mov_b32 s18, 0x194000
buffer_load_dwordx4 v9, s[8:11], s18 offen  lds
s_add_u32 m0, s84, 6144
s_mov_b32 s18, 0x198000
buffer_load_dwordx4 v9, s[8:11], s18 offen  lds
s_add_u32 m0, s84, 7168
s_mov_b32 s18, 0x19c000
buffer_load_dwordx4 v9, s[8:11], s18 offen  lds
s_add_u32 m0, s84, 8192
s_mov_b32 s18, 0x1a0000
buffer_load_dwordx4 v9, s[8:11], s18 offen  lds
s_add_u32 m0, s84, 9216
s_mov_b32 s18, 0x1a4000
buffer_load_dwordx4 v9, s[8:11], s18 offen  lds
s_add_u32 m0, s84, 10240
s_mov_b32 s18, 0x1a8000
buffer_load_dwordx4 v9, s[8:11], s18 offen  lds
s_add_u32 m0, s84, 11264
s_mov_b32 s18, 0x1ac000
buffer_load_dwordx4 v9, s[8:11], s18 offen  lds
s_add_u32 m0, s84, 12288
s_mov_b32 s18, 0x1b0000
buffer_load_dwordx4 v9, s[8:11], s18 offen  lds
s_add_u32 m0, s84, 13312
s_mov_b32 s18, 0x1b4000
buffer_load_dwordx4 v9, s[8:11], s18 offen  lds
s_add_u32 m0, s84, 14336
s_mov_b32 s18, 0x1b8000
buffer_load_dwordx4 v9, s[8:11], s18 offen  lds
s_add_u32 m0, s84, 15360
s_mov_b32 s18, 0x1bc000
buffer_load_dwordx4 v9, s[8:11], s18 offen  lds
s_waitcnt vmcnt(16)
ds_read_b64_tr_b16 a[160:161], v12 offset:16384
ds_read_b64_tr_b16 a[164:165], v13 offset:16384
ds_read_b64_tr_b16 a[162:163], v12 offset:18432
ds_read_b64_tr_b16 a[166:167], v13 offset:18432
ds_read_b64_tr_b16 a[168:169], v12 offset:20480
ds_read_b64_tr_b16 a[172:173], v13 offset:20480
ds_read_b64_tr_b16 a[170:171], v12 offset:22528
ds_read_b64_tr_b16 a[174:175], v13 offset:22528
ds_read_b64_tr_b16 a[176:177], v12 offset:24576
ds_read_b64_tr_b16 a[180:181], v13 offset:24576
ds_read_b64_tr_b16 a[178:179], v12 offset:26624
ds_read_b64_tr_b16 a[182:183], v13 offset:26624
ds_read_b64_tr_b16 a[184:185], v12 offset:28672
ds_read_b64_tr_b16 a[188:189], v13 offset:28672
ds_read_b64_tr_b16 a[186:187], v12 offset:30720
ds_read_b64_tr_b16 a[190:191], v13 offset:30720
s_waitcnt lgkmcnt(0)
s_add_u32 m0, s84, 16384
s_mov_b32 s18, 0x1c0000
buffer_load_dwordx4 v9, s[8:11], s18 offen  lds
s_add_u32 m0, s84, 17408
s_mov_b32 s18, 0x1c4000
buffer_load_dwordx4 v9, s[8:11], s18 offen  lds
s_add_u32 m0, s84, 18432
s_mov_b32 s18, 0x1c8000
buffer_load_dwordx4 v9, s[8:11], s18 offen  lds
s_add_u32 m0, s84, 19456
s_mov_b32 s18, 0x1cc000
buffer_load_dwordx4 v9, s[8:11], s18 offen  lds
s_add_u32 m0, s84, 20480
s_mov_b32 s18, 0x1d0000
buffer_load_dwordx4 v9, s[8:11], s18 offen  lds
s_add_u32 m0, s84, 21504
s_mov_b32 s18, 0x1d4000
buffer_load_dwordx4 v9, s[8:11], s18 offen  lds
s_add_u32 m0, s84, 22528
s_mov_b32 s18, 0x1d8000
buffer_load_dwordx4 v9, s[8:11], s18 offen  lds
s_add_u32 m0, s84, 23552
s_mov_b32 s18, 0x1dc000
buffer_load_dwordx4 v9, s[8:11], s18 offen  lds
s_add_u32 m0, s84, 24576
s_mov_b32 s18, 0x1e0000
buffer_load_dwordx4 v9, s[8:11], s18 offen  lds
s_add_u32 m0, s84, 25600
s_mov_b32 s18, 0x1e4000
buffer_load_dwordx4 v9, s[8:11], s18 offen  lds
s_add_u32 m0, s84, 26624
s_mov_b32 s18, 0x1e8000
buffer_load_dwordx4 v9, s[8:11], s18 offen  lds
s_add_u32 m0, s84, 27648
s_mov_b32 s18, 0x1ec000
buffer_load_dwordx4 v9, s[8:11], s18 offen  lds
s_add_u32 m0, s84, 28672
s_mov_b32 s18, 0x1f0000
buffer_load_dwordx4 v9, s[8:11], s18 offen  lds
s_add_u32 m0, s84, 29696
s_mov_b32 s18, 0x1f4000
buffer_load_dwordx4 v9, s[8:11], s18 offen  lds
s_add_u32 m0, s84, 30720
s_mov_b32 s18, 0x1f8000
buffer_load_dwordx4 v9, s[8:11], s18 offen  lds
s_add_u32 m0, s84, 31744
s_mov_b32 s18, 0x1fc000
buffer_load_dwordx4 v9, s[8:11], s18 offen  lds
s_waitcnt vmcnt(16)
ds_read_b64_tr_b16 a[192:193], v12 offset:0
ds_read_b64_tr_b16 a[196:197], v13 offset:0
ds_read_b64_tr_b16 a[194:195], v12 offset:2048
ds_read_b64_tr_b16 a[198:199], v13 offset:2048
ds_read_b64_tr_b16 a[200:201], v12 offset:4096
ds_read_b64_tr_b16 a[204:205], v13 offset:4096
ds_read_b64_tr_b16 a[202:203], v12 offset:6144
ds_read_b64_tr_b16 a[206:207], v13 offset:6144
ds_read_b64_tr_b16 a[208:209], v12 offset:8192
ds_read_b64_tr_b16 a[212:213], v13 offset:8192
ds_read_b64_tr_b16 a[210:211], v12 offset:10240
ds_read_b64_tr_b16 a[214:215], v13 offset:10240
ds_read_b64_tr_b16 a[216:217], v12 offset:12288
ds_read_b64_tr_b16 a[220:221], v13 offset:12288
ds_read_b64_tr_b16 a[218:219], v12 offset:14336
ds_read_b64_tr_b16 a[222:223], v13 offset:14336
s_waitcnt lgkmcnt(0)
s_waitcnt vmcnt(0)
ds_read_b64_tr_b16 a[224:225], v12 offset:16384
ds_read_b64_tr_b16 a[228:229], v13 offset:16384
ds_read_b64_tr_b16 a[226:227], v12 offset:18432
ds_read_b64_tr_b16 a[230:231], v13 offset:18432
ds_read_b64_tr_b16 a[232:233], v12 offset:20480
ds_read_b64_tr_b16 a[236:237], v13 offset:20480
ds_read_b64_tr_b16 a[234:235], v12 offset:22528
ds_read_b64_tr_b16 a[238:239], v13 offset:22528
ds_read_b64_tr_b16 a[240:241], v12 offset:24576
ds_read_b64_tr_b16 a[244:245], v13 offset:24576
ds_read_b64_tr_b16 a[242:243], v12 offset:26624
ds_read_b64_tr_b16 a[246:247], v13 offset:26624
ds_read_b64_tr_b16 a[248:249], v12 offset:28672
ds_read_b64_tr_b16 a[252:253], v13 offset:28672
ds_read_b64_tr_b16 a[250:251], v12 offset:30720
ds_read_b64_tr_b16 a[254:255], v13 offset:30720
s_waitcnt lgkmcnt(0)
s_barrier
s_waitcnt lgkmcnt(0)
s_mov_b32 s36, s28
s_mov_b32 s37, s29
s_mov_b32 s38, 0x400000
s_mov_b32 s39, 0x20000
s_and_b32 s18, s12, 1
s_lshl_b32 s18, s18, 4
v_add_u32 v8, s18, v4
v_lshlrev_b32 v42, 2, v8
v_add_u32 v42, 0x8186000, v42
v_lshlrev_b32 v41, 11, v8
v_lshl_add_u32 v41, v5, 3, v41
s_lshr_b32 s18, s12, 1
s_lshl_b32 s19, s18, 5
s_add_u32 s19, s19, s57
v_add_u32 v41, s19, v41
s_lshl_b32 s18, s12, 17
s_add_u32 s18, s18, 0x6000000
v_add_u32 v44, s18, v6
s_lshr_b32 s18, s12, 1
s_lshl_b32 s18, s18, 5
s_add_u32 s18, s18, s57
s_lshl_b32 s18, s18, 1
s_add_u32 s18, s18, 0x8400000
v_lshlrev_b32 v47, 12, v4
v_lshl_add_u32 v47, v5, 4, v47
v_add_u32 v47, s18, v47
s_and_b32 s18, s12, 1
s_lshl_b32 s18, s18, 1
s_lshr_b32 s19, s12, 1
s_add_u32 s18, s18, s19
s_lshl_b32 s18, s18, 10
v_add_u32 v50, s18, v6
s_and_b32 s18, s53, 15
v_cmp_eq_u32 s[66:67], s18, v4
s_lshr_b32 s61, s62, 5
s_mov_b32 s58, 0
s_mov_b32 s64, 0
s_and_b32 s88, s12, 1
s_mov_b32 s89, 0
s_cmp_eq_u32 s61, 3
s_cselect_b32 s87, 14, 15
s_lshl_b32 s55, s64, 2
s_add_u32 s55, s55, s61
L_p_cold:
s_and_b32 s19, s55, 0x30
s_add_u32 s18, s55, s19
s_lshl_b32 s18, s18, 9
s_lshl_b32 s19, s12, 7
s_add_u32 s18, s18, s19
s_add_u32 s18, s18, 0x8190000
s_add_u32 s18, s18, s99
v_mov_b32 v40, s18
s_cmp_lt_u32 s55, 62
s_cbranch_scc1 L_p_fac
s_sub_u32 s18, s55, 62
s_lshl_b32 s18, s18, 16
s_lshl_b32 s19, s12, 14
s_add_u32 s18, s18, s19
s_add_u32 s18, s18, 0x81a0000
s_add_u32 s18, s18, s99
v_lshlrev_b32 v40, 7, v0
v_add_u32 v40, s18, v40
L_p_fac:
L_p_poll:
buffer_load_dword v8, v40, s[4:7], 0 offen sc1
s_waitcnt vmcnt(0)
v_cmp_eq_u32 vcc, -1, v8
s_cbranch_vccz L_p_go
s_sub_u32 s15, s15, 1
s_cbranch_scc1 L_exit
s_sleep 1
s_branch L_p_poll
L_p_go:
s_lshl_b32 s56, s55, 19
s_add_u32 s56, s56, s99
s_bitcmp1_b32 s55, 2
s_cselect_b32 s18, 8192, 0
s_xor_b32 s56, s56, s18
buffer_load_dwordx4 v[128:131], v44, s[4:7], s56 offen offset:0 sc1
buffer_load_dwordx4 v[132:135], v44, s[4:7], s56 offen offset:1024 sc1
buffer_load_dwordx4 v[136:139], v44, s[4:7], s56 offen offset:2048 sc1
buffer_load_dwordx4 v[140:143], v44, s[4:7], s56 offen offset:3072 sc1
s_add_u32 s56, s56, 4096
buffer_load_dwordx4 v[144:147], v44, s[4:7], s56 offen offset:0 sc1
buffer_load_dwordx4 v[148:151], v44, s[4:7], s56 offen offset:1024 sc1
buffer_load_dwordx4 v[152:155], v44, s[4:7], s56 offen offset:2048 sc1
buffer_load_dwordx4 v[156:159], v44, s[4:7], s56 offen offset:3072 sc1
s_add_u32 s56, s56, 12288
buffer_load_dwordx4 v[160:163], v44, s[4:7], s56 offen offset:0 sc1
buffer_load_dwordx4 v[164:167], v44, s[4:7], s56 offen offset:1024 sc1
buffer_load_dwordx4 v[168:171], v44, s[4:7], s56 offen offset:2048 sc1
buffer_load_dwordx4 v[172:175], v44, s[4:7], s56 offen offset:3072 sc1
s_add_u32 s56, s56, 4096
buffer_load_dwordx4 v[176:179], v44, s[4:7], s56 offen offset:0 sc1
buffer_load_dwordx4 v[180:183], v44, s[4:7], s56 offen offset:1024 sc1
buffer_load_dwordx4 v[184:187], v44, s[4:7], s56 offen offset:2048 sc1
buffer_load_dwordx4 v[188:191], v44, s[4:7], s56 offen offset:3072 sc1
s_add_u32 s56, s56, 12288
buffer_load_dwordx4 v[192:195], v44, s[4:7], s56 offen offset:0 sc1
buffer_load_dwordx4 v[196:199], v44, s[4:7], s56 offen offset:1024 sc1
buffer_load_dwordx4 v[200:203], v44, s[4:7], s56 offen offset:2048 sc1
buffer_load_dwordx4 v[204:207], v44, s[4:7], s56 offen offset:3072 sc1
s_add_u32 s56, s56, 4096
buffer_load_dwordx4 v[208:211], v44, s[4:7], s56 offen offset:0 sc1
buffer_load_dwordx4 v[212:215], v44, s[4:7], s56 offen offset:1024 sc1
buffer_load_dwordx4 v[216:219], v44, s[4:7], s56 offen offset:2048 sc1
buffer_load_dwordx4 v[220:223], v44, s[4:7], s56 offen offset:3072 sc1
s_add_u32 s56, s56, 12288
buffer_load_dwordx4 v[224:227], v44, s[4:7], s56 offen offset:0 sc1
buffer_load_dwordx4 v[228:231], v44, s[4:7], s56 offen offset:1024 sc1
buffer_load_dwordx4 v[232:235], v44, s[4:7], s56 offen offset:2048 sc1
buffer_load_dwordx4 v[236:239], v44, s[4:7], s56 offen offset:3072 sc1
s_add_u32 s56, s56, 4096
buffer_load_dwordx4 v[240:243], v44, s[4:7], s56 offen offset:0 sc1
buffer_load_dwordx4 v[244:247], v44, s[4:7], s56 offen offset:1024 sc1
buffer_load_dwordx4 v[248:251], v44, s[4:7], s56 offen offset:2048 sc1
buffer_load_dwordx4 v[252:255], v44, s[4:7], s56 offen offset:3072 sc1
s_add_u32 s56, s56, 12288
.p2align 6
L_p_seg:
s_add_u32 s65, s64, 1
s_min_u32 s65, s65, 15
s_lshl_b32 s85, s65, 2
s_add_u32 s85, s85, s61
s_and_b32 s19, s85, 0x30
s_add_u32 s18, s85, s19
s_lshl_b32 s18, s18, 9
s_lshl_b32 s19, s12, 7
s_add_u32 s18, s18, s19
s_add_u32 s18, s18, 0x8190000
s_add_u32 s18, s18, s99
v_mov_b32 v40, s18
s_cmp_lt_u32 s85, 62
s_cbranch_scc1 L_p_fan
s_sub_u32 s18, s85, 62
s_lshl_b32 s18, s18, 16
s_lshl_b32 s19, s12, 14
s_add_u32 s18, s18, s19
s_add_u32 s18, s18, 0x81a0000
s_add_u32 s18, s18, s99
v_lshlrev_b32 v40, 7, v0
v_add_u32 v40, s18, v40
L_p_fan:
s_lshl_b32 s18, s55, 16
s_lshl_b32 s19, s55, 7
buffer_load_dwordx2 v[48:49], v41, s[32:35], s18 offen
buffer_load_dword v45, v42, s[4:7], s19 offen sc1
buffer_load_dword v2, v40, s[4:7], 0 offen sc1
s_waitcnt vmcnt(34)
v_mfma_f32_16x16x32_bf16 v[24:27], a[0:3], v[128:131], 0
v_mfma_f32_16x16x32_bf16 v[28:31], a[4:7], v[128:131], 0
buffer_load_dwordx4 v[128:131], v44, s[4:7], s56 offen offset:0 sc1
s_waitcnt vmcnt(34)
v_mfma_f32_16x16x32_bf16 v[32:35], a[0:3], v[132:135], 0
v_mfma_f32_16x16x32_bf16 v[36:39], a[4:7], v[132:135], 0
buffer_load_dwordx4 v[132:135], v44, s[4:7], s56 offen offset:1024 sc1
s_waitcnt vmcnt(34)
v_mfma_f32_16x16x32_bf16 v[24:27], a[8:11], v[136:139], v[24:27]
v_mfma_f32_16x16x32_bf16 v[28:31], a[12:15], v[136:139], v[28:31]
buffer_load_dwordx4 v[136:139], v44, s[4:7], s56 offen offset:2048 sc1
s_waitcnt vmcnt(34)
v_mfma_f32_16x16x32_bf16 v[32:35], a[8:11], v[140:143], v[32:35]
v_mfma_f32_16x16x32_bf16 v[36:39], a[12:15], v[140:143], v[36:39]
buffer_load_dwordx4 v[140:143], v44, s[4:7], s56 offen offset:3072 sc1
s_add_u32 s56, s56, 4096
s_waitcnt vmcnt(34)
v_mfma_f32_16x16x32_bf16 v[24:27], a[16:19], v[144:147], v[24:27]
v_mfma_f32_16x16x32_bf16 v[28:31], a[20:23], v[144:147], v[28:31]
buffer_load_dwordx4 v[144:147], v44, s[4:7], s56 offen offset:0 sc1
s_waitcnt vmcnt(34)
v_mfma_f32_16x16x32_bf16 v[32:35], a[16:19], v[148:151], v[32:35]
v_mfma_f32_16x16x32_bf16 v[36:39], a[20:23], v[148:151], v[36:39]
buffer_load_dwordx4 v[148:151], v44, s[4:7], s56 offen offset:1024 sc1
s_waitcnt vmcnt(34)
v_mfma_f32_16x16x32_bf16 v[24:27], a[24:27], v[152:155], v[24:27]
v_mfma_f32_16x16x32_bf16 v[28:31], a[28:31], v[152:155], v[28:31]
buffer_load_dwordx4 v[152:155], v44, s[4:7], s56 offen offset:2048 sc1
s_waitcnt vmcnt(34)
v_mfma_f32_16x16x32_bf16 v[32:35], a[24:27], v[156:159], v[32:35]
v_mfma_f32_16x16x32_bf16 v[36:39], a[28:31], v[156:159], v[36:39]
buffer_load_dwordx4 v[156:159], v44, s[4:7], s56 offen offset:3072 sc1
s_add_u32 s56, s56, 12288
s_waitcnt vmcnt(34)
v_mfma_f32_16x16x32_bf16 v[24:27], a[32:35], v[160:163], v[24:27]
v_mfma_f32_16x16x32_bf16 v[28:31], a[36:39], v[160:163], v[28:31]
buffer_load_dwordx4 v[160:163], v44, s[4:7], s56 offen offset:0 sc1
s_waitcnt vmcnt(34)
v_mfma_f32_16x16x32_bf16 v[32:35], a[32:35], v[164:167], v[32:35]
v_mfma_f32_16x16x32_bf16 v[36:39], a[36:39], v[164:167], v[36:39]
buffer_load_dwordx4 v[164:167], v44, s[4:7], s56 offen offset:1024 sc1
s_waitcnt vmcnt(34)
v_mfma_f32_16x16x32_bf16 v[24:27], a[40:43], v[168:171], v[24:27]
v_mfma_f32_16x16x32_bf16 v[28:31], a[44:47], v[168:171], v[28:31]
buffer_load_dwordx4 v[168:171], v44, s[4:7], s56 offen offset:2048 sc1
s_waitcnt vmcnt(34)
v_mfma_f32_16x16x32_bf16 v[32:35], a[40:43], v[172:175], v[32:35]
v_mfma_f32_16x16x32_bf16 v[36:39], a[44:47], v[172:175], v[36:39]
buffer_load_dwordx4 v[172:175], v44, s[4:7], s56 offen offset:3072 sc1
s_add_u32 s56, s56, 4096
s_waitcnt vmcnt(34)
v_mfma_f32_16x16x32_bf16 v[24:27], a[48:51], v[176:179], v[24:27]
v_mfma_f32_16x16x32_bf16 v[28:31], a[52:55], v[176:179], v[28:31]
buffer_load_dwordx4 v[176:179], v44, s[4:7], s56 offen offset:0 sc1
s_waitcnt vmcnt(34)
v_mfma_f32_16x16x32_bf16 v[32:35], a[48:51], v[180:183], v[32:35]
v_mfma_f32_16x16x32_bf16 v[36:39], a[52:55], v[180:183], v[36:39]
buffer_load_dwordx4 v[180:183], v44, s[4:7], s56 offen offset:1024 sc1
s_waitcnt vmcnt(34)
v_mfma_f32_16x16x32_bf16 v[24:27], a[56:59], v[184:187], v[24:27]
v_mfma_f32_16x16x32_bf16 v[28:31], a[60:63], v[184:187], v[28:31]
buffer_load_dwordx4 v[184:187], v44, s[4:7], s56 offen offset:2048 sc1
s_waitcnt vmcnt(34)
v_mfma_f32_16x16x32_bf16 v[32:35], a[56:59], v[188:191], v[32:35]
v_mfma_f32_16x16x32_bf16 v[36:39], a[60:63], v[188:191], v[36:39]
buffer_load_dwordx4 v[188:191], v44, s[4:7], s56 offen offset:3072 sc1
s_add_u32 s56, s56, 12288
s_waitcnt vmcnt(34)
v_mfma_f32_16x16x32_bf16 v[24:27], a[64:67], v[192:195], v[24:27]
v_mfma_f32_16x16x32_bf16 v[28:31], a[68:71], v[192:195], v[28:31]
buffer_load_dwordx4 v[192:195], v44, s[4:7], s56 offen offset:0 sc1
s_waitcnt vmcnt(34)
v_mfma_f32_16x16x32_bf16 v[32:35], a[64:67], v[196:199], v[32:35]
v_mfma_f32_16x16x32_bf16 v[36:39], a[68:71], v[196:199], v[36:39]
buffer_load_dwordx4 v[196:199], v44, s[4:7], s56 offen offset:1024 sc1
s_waitcnt vmcnt(34)
v_mfma_f32_16x16x32_bf16 v[24:27], a[72:75], v[200:203], v[24:27]
v_mfma_f32_16x16x32_bf16 v[28:31], a[76:79], v[200:203], v[28:31]
buffer_load_dwordx4 v[200:203], v44, s[4:7], s56 offen offset:2048 sc1
s_waitcnt vmcnt(34)
v_mfma_f32_16x16x32_bf16 v[32:35], a[72:75], v[204:207], v[32:35]
v_mfma_f32_16x16x32_bf16 v[36:39], a[76:79], v[204:207], v[36:39]
buffer_load_dwordx4 v[204:207], v44, s[4:7], s56 offen offset:3072 sc1
s_add_u32 s56, s56, 4096
s_waitcnt vmcnt(34)
v_mfma_f32_16x16x32_bf16 v[24:27], a[80:83], v[208:211], v[24:27]
v_mfma_f32_16x16x32_bf16 v[28:31], a[84:87], v[208:211], v[28:31]
buffer_load_dwordx4 v[208:211], v44, s[4:7], s56 offen offset:0 sc1
s_waitcnt vmcnt(34)
v_mfma_f32_16x16x32_bf16 v[32:35], a[80:83], v[212:215], v[32:35]
v_mfma_f32_16x16x32_bf16 v[36:39], a[84:87], v[212:215], v[36:39]
buffer_load_dwordx4 v[212:215], v44, s[4:7], s56 offen offset:1024 sc1
s_waitcnt vmcnt(34)
v_mfma_f32_16x16x32_bf16 v[24:27], a[88:91], v[216:219], v[24:27]
v_mfma_f32_16x16x32_bf16 v[28:31], a[92:95], v[216:219], v[28:31]
buffer_load_dwordx4 v[216:219], v44, s[4:7], s56 offen offset:2048 sc1
s_waitcnt vmcnt(34)
v_mfma_f32_16x16x32_bf16 v[32:35], a[88:91], v[220:223], v[32:35]
v_mfma_f32_16x16x32_bf16 v[36:39], a[92:95], v[220:223], v[36:39]
buffer_load_dwordx4 v[220:223], v44, s[4:7], s56 offen offset:3072 sc1
s_add_u32 s56, s56, 12288
s_waitcnt vmcnt(34)
v_mfma_f32_16x16x32_bf16 v[24:27], a[96:99], v[224:227], v[24:27]
v_mfma_f32_16x16x32_bf16 v[28:31], a[100:103], v[224:227], v[28:31]
buffer_load_dwordx4 v[224:227], v44, s[4:7], s56 offen offset:0 sc1
s_waitcnt vmcnt(34)
v_mfma_f32_16x16x32_bf16 v[32:35], a[96:99], v[228:231], v[32:35]
v_mfma_f32_16x16x32_bf16 v[36:39], a[100:103], v[228:231], v[36:39]
buffer_load_dwordx4 v[228:231], v44, s[4:7], s56 offen offset:1024 sc1
s_waitcnt vmcnt(34)
v_mfma_f32_16x16x32_bf16 v[24:27], a[104:107], v[232:235], v[24:27]
v_mfma_f32_16x16x32_bf16 v[28:31], a[108:111], v[232:235], v[28:31]
buffer_load_dwordx4 v[232:235], v44, s[4:7], s56 offen offset:2048 sc1
s_waitcnt vmcnt(34)
v_mfma_f32_16x16x32_bf16 v[32:35], a[104:107], v[236:239], v[32:35]
v_mfma_f32_16x16x32_bf16 v[36:39], a[108:111], v[236:239], v[36:39]
buffer_load_dwordx4 v[236:239], v44, s[4:7], s56 offen offset:3072 sc1
s_add_u32 s56, s56, 4096
s_waitcnt vmcnt(34)
v_mfma_f32_16x16x32_bf16 v[24:27], a[112:115], v[240:243], v[24:27]
v_mfma_f32_16x16x32_bf16 v[28:31], a[116:119], v[240:243], v[28:31]
buffer_load_dwordx4 v[240:243], v44, s[4:7], s56 offen offset:0 sc1
s_waitcnt vmcnt(34)
v_mfma_f32_16x16x32_bf16 v[32:35], a[112:115], v[244:247], v[32:35]
v_mfma_f32_16x16x32_bf16 v[36:39], a[116:119], v[244:247], v[36:39]
buffer_load_dwordx4 v[244:247], v44, s[4:7], s56 offen offset:1024 sc1
s_waitcnt vmcnt(34)
v_mfma_f32_16x16x32_bf16 v[24:27], a[120:123], v[248:251], v[24:27]
v_mfma_f32_16x16x32_bf16 v[28:31], a[124:127], v[248:251], v[28:31]
buffer_load_dwordx4 v[248:251], v44, s[4:7], s56 offen offset:2048 sc1
s_waitcnt vmcnt(34)
v_mfma_f32_16x16x32_bf16 v[32:35], a[120:123], v[252:255], v[32:35]
v_mfma_f32_16x16x32_bf16 v[36:39], a[124:127], v[252:255], v[36:39]
buffer_load_dwordx4 v[252:255], v44, s[4:7], s56 offen offset:3072 sc1
s_waitcnt vmcnt(31)
v_cmp_eq_u32 vcc, -1, v2
s_mov_b32 s86, 0
s_cbranch_vccnz L_p_nopf
s_cmp_eq_u32 s64, s87
s_cbranch_scc1 L_p_nopf
s_mov_b32 s86, 1
s_lshl_b32 s56, s85, 19
s_add_u32 s56, s56, s99
s_bitcmp1_b32 s85, 2
s_cselect_b32 s18, 8192, 0
s_xor_b32 s56, s56, s18
s_waitcnt vmcnt(31)
v_mfma_f32_16x16x32_bf16 v[24:27], a[128:131], v[128:131], v[24:27]
v_mfma_f32_16x16x32_bf16 v[28:31], a[132:135], v[128:131], v[28:31]
buffer_load_dwordx4 v[128:131], v44, s[4:7], s56 offen offset:0 sc1
s_waitcnt vmcnt(31)
v_mfma_f32_16x16x32_bf16 v[32:35], a[128:131], v[132:135], v[32:35]
v_mfma_f32_16x16x32_bf16 v[36:39], a[132:135], v[132:135], v[36:39]
buffer_load_dwordx4 v[132:135], v44, s[4:7], s56 offen offset:1024 sc1
s_waitcnt vmcnt(31)
v_mfma_f32_16x16x32_bf16 v[24:27], a[136:139], v[136:139], v[24:27]
v_mfma_f32_16x16x32_bf16 v[28:31], a[140:143], v[136:139], v[28:31]
buffer_load_dwordx4 v[136:139], v44, s[4:7], s56 offen offset:2048 sc1
s_waitcnt vmcnt(31)
v_mfma_f32_16x16x32_bf16 v[32:35], a[136:139], v[140:143], v[32:35]
v_mfma_f32_16x16x32_bf16 v[36:39], a[140:143], v[140:143], v[36:39]
buffer_load_dwordx4 v[140:143], v44, s[4:7], s56 offen offset:3072 sc1
s_add_u32 s56, s56, 4096
s_waitcnt vmcnt(31)
v_mfma_f32_16x16x32_bf16 v[24:27], a[144:147], v[144:147], v[24:27]
v_mfma_f32_16x16x32_bf16 v[28:31], a[148:151], v[144:147], v[28:31]
buffer_load_dwordx4 v[144:147], v44, s[4:7], s56 offen offset:0 sc1
s_waitcnt vmcnt(31)
v_mfma_f32_16x16x32_bf16 v[32:35], a[144:147], v[148:151], v[32:35]
v_mfma_f32_16x16x32_bf16 v[36:39], a[148:151], v[148:151], v[36:39]
buffer_load_dwordx4 v[148:151], v44, s[4:7], s56 offen offset:1024 sc1
s_waitcnt vmcnt(31)
v_mfma_f32_16x16x32_bf16 v[24:27], a[152:155], v[152:155], v[24:27]
v_mfma_f32_16x16x32_bf16 v[28:31], a[156:159], v[152:155], v[28:31]
buffer_load_dwordx4 v[152:155], v44, s[4:7], s56 offen offset:2048 sc1
s_waitcnt vmcnt(31)
v_mfma_f32_16x16x32_bf16 v[32:35], a[152:155], v[156:159], v[32:35]
v_mfma_f32_16x16x32_bf16 v[36:39], a[156:159], v[156:159], v[36:39]
buffer_load_dwordx4 v[156:159], v44, s[4:7], s56 offen offset:3072 sc1
s_add_u32 s56, s56, 12288
s_waitcnt vmcnt(31)
v_mfma_f32_16x16x32_bf16 v[24:27], a[160:163], v[160:163], v[24:27]
v_mfma_f32_16x16x32_bf16 v[28:31], a[164:167], v[160:163], v[28:31]
buffer_load_dwordx4 v[160:163], v44, s[4:7], s56 offen offset:0 sc1
s_waitcnt vmcnt(31)
v_mfma_f32_16x16x32_bf16 v[32:35], a[160:163], v[164:167], v[32:35]
v_mfma_f32_16x16x32_bf16 v[36:39], a[164:167], v[164:167], v[36:39]
buffer_load_dwordx4 v[164:167], v44, s[4:7], s56 offen offset:1024 sc1
s_waitcnt vmcnt(31)
v_mfma_f32_16x16x32_bf16 v[24:27], a[168:171], v[168:171], v[24:27]
v_mfma_f32_16x16x32_bf16 v[28:31], a[172:175], v[168:171], v[28:31]
buffer_load_dwordx4 v[168:171], v44, s[4:7], s56 offen offset:2048 sc1
s_waitcnt vmcnt(31)
v_mfma_f32_16x16x32_bf16 v[32:35], a[168:171], v[172:175], v[32:35]
v_mfma_f32_16x16x32_bf16 v[36:39], a[172:175], v[172:175], v[36:39]
buffer_load_dwordx4 v[172:175], v44, s[4:7], s56 offen offset:3072 sc1
s_add_u32 s56, s56, 4096
s_waitcnt vmcnt(31)
v_mfma_f32_16x16x32_bf16 v[24:27], a[176:179], v[176:179], v[24:27]
v_mfma_f32_16x16x32_bf16 v[28:31], a[180:183], v[176:179], v[28:31]
buffer_load_dwordx4 v[176:179], v44, s[4:7], s56 offen offset:0 sc1
s_waitcnt vmcnt(31)
v_mfma_f32_16x16x32_bf16 v[32:35], a[176:179], v[180:183], v[32:35]
v_mfma_f32_16x16x32_bf16 v[36:39], a[180:183], v[180:183], v[36:39]
buffer_load_dwordx4 v[180:183], v44, s[4:7], s56 offen offset:1024 sc1
s_waitcnt vmcnt(31)
v_mfma_f32_16x16x32_bf16 v[24:27], a[184:187], v[184:187], v[24:27]
v_mfma_f32_16x16x32_bf16 v[28:31], a[188:191], v[184:187], v[28:31]
buffer_load_dwordx4 v[184:187], v44, s[4:7], s56 offen offset:2048 sc1
s_waitcnt vmcnt(31)
v_mfma_f32_16x16x32_bf16 v[32:35], a[184:187], v[188:191], v[32:35]
v_mfma_f32_16x16x32_bf16 v[36:39], a[188:191], v[188:191], v[36:39]
buffer_load_dwordx4 v[188:191], v44, s[4:7], s56 offen offset:3072 sc1
s_add_u32 s56, s56, 12288
s_waitcnt vmcnt(31)
v_mfma_f32_16x16x32_bf16 v[24:27], a[192:195], v[192:195], v[24:27]
v_mfma_f32_16x16x32_bf16 v[28:31], a[196:199], v[192:195], v[28:31]
buffer_load_dwordx4 v[192:195], v44, s[4:7], s56 offen offset:0 sc1
s_waitcnt vmcnt(31)
v_mfma_f32_16x16x32_bf16 v[32:35], a[192:195], v[196:199], v[32:35]
v_mfma_f32_16x16x32_bf16 v[36:39], a[196:199], v[196:199], v[36:39]
buffer_load_dwordx4 v[196:199], v44, s[4:7], s56 offen offset:1024 sc1
s_waitcnt vmcnt(31)
v_mfma_f32_16x16x32_bf16 v[24:27], a[200:203], v[200:203], v[24:27]
v_mfma_f32_16x16x32_bf16 v[28:31], a[204:207], v[200:203], v[28:31]
buffer_load_dwordx4 v[200:203], v44, s[4:7], s56 offen offset:2048 sc1
s_waitcnt vmcnt(31)
v_mfma_f32_16x16x32_bf16 v[32:35], a[200:203], v[204:207], v[32:35]
v_mfma_f32_16x16x32_bf16 v[36:39], a[204:207], v[204:207], v[36:39]
buffer_load_dwordx4 v[204:207], v44, s[4:7], s56 offen offset:3072 sc1
s_add_u32 s56, s56, 4096
s_waitcnt vmcnt(31)
v_mfma_f32_16x16x32_bf16 v[24:27], a[208:211], v[208:211], v[24:27]
v_mfma_f32_16x16x32_bf16 v[28:31], a[212:215], v[208:211], v[28:31]
buffer_load_dwordx4 v[208:211], v44, s[4:7], s56 offen offset:0 sc1
s_waitcnt vmcnt(31)
v_mfma_f32_16x16x32_bf16 v[32:35], a[208:211], v[212:215], v[32:35]
v_mfma_f32_16x16x32_bf16 v[36:39], a[212:215], v[212:215], v[36:39]
buffer_load_dwordx4 v[212:215], v44, s[4:7], s56 offen offset:1024 sc1
s_waitcnt vmcnt(31)
v_mfma_f32_16x16x32_bf16 v[24:27], a[216:219], v[216:219], v[24:27]
v_mfma_f32_16x16x32_bf16 v[28:31], a[220:223], v[216:219], v[28:31]
buffer_load_dwordx4 v[216:219], v44, s[4:7], s56 offen offset:2048 sc1
s_waitcnt vmcnt(31)
v_mfma_f32_16x16x32_bf16 v[32:35], a[216:219], v[220:223], v[32:35]
v_mfma_f32_16x16x32_bf16 v[36:39], a[220:223], v[220:223], v[36:39]
buffer_load_dwordx4 v[220:223], v44, s[4:7], s56 offen offset:3072 sc1
s_add_u32 s56, s56, 12288
s_waitcnt vmcnt(31)
v_mfma_f32_16x16x32_bf16 v[24:27], a[224:227], v[224:227], v[24:27]
v_mfma_f32_16x16x32_bf16 v[28:31], a[228:231], v[224:227], v[28:31]
buffer_load_dwordx4 v[224:227], v44, s[4:7], s56 offen offset:0 sc1
s_waitcnt vmcnt(31)
v_mfma_f32_16x16x32_bf16 v[32:35], a[224:227], v[228:231], v[32:35]
v_mfma_f32_16x16x32_bf16 v[36:39], a[228:231], v[228:231], v[36:39]
buffer_load_dwordx4 v[228:231], v44, s[4:7], s56 offen offset:1024 sc1
s_waitcnt vmcnt(31)
v_mfma_f32_16x16x32_bf16 v[24:27], a[232:235], v[232:235], v[24:27]
v_mfma_f32_16x16x32_bf16 v[28:31], a[236:239], v[232:235], v[28:31]
buffer_load_dwordx4 v[232:235], v44, s[4:7], s56 offen offset:2048 sc1
s_waitcnt vmcnt(31)
v_mfma_f32_16x16x32_bf16 v[32:35], a[232:235], v[236:239], v[32:35]
v_mfma_f32_16x16x32_bf16 v[36:39], a[236:239], v[236:239], v[36:39]
buffer_load_dwordx4 v[236:239], v44, s[4:7], s56 offen offset:3072 sc1
s_add_u32 s56, s56, 4096
s_waitcnt vmcnt(31)
v_mfma_f32_16x16x32_bf16 v[24:27], a[240:243], v[240:243], v[24:27]
v_mfma_f32_16x16x32_bf16 v[28:31], a[244:247], v[240:243], v[28:31]
buffer_load_dwordx4 v[240:243], v44, s[4:7], s56 offen offset:0 sc1
s_waitcnt vmcnt(31)
v_mfma_f32_16x16x32_bf16 v[32:35], a[240:243], v[244:247], v[32:35]
v_mfma_f32_16x16x32_bf16 v[36:39], a[244:247], v[244:247], v[36:39]
buffer_load_dwordx4 v[244:247], v44, s[4:7], s56 offen offset:1024 sc1
s_waitcnt vmcnt(31)
v_mfma_f32_16x16x32_bf16 v[24:27], a[248:251], v[248:251], v[24:27]
v_mfma_f32_16x16x32_bf16 v[28:31], a[252:255], v[248:251], v[28:31]
buffer_load_dwordx4 v[248:251], v44, s[4:7], s56 offen offset:2048 sc1
s_waitcnt vmcnt(31)
v_mfma_f32_16x16x32_bf16 v[32:35], a[248:251], v[252:255], v[32:35]
v_mfma_f32_16x16x32_bf16 v[36:39], a[252:255], v[252:255], v[36:39]
buffer_load_dwordx4 v[252:255], v44, s[4:7], s56 offen offset:3072 sc1
s_add_u32 s56, s56, 12288
s_branch L_p_red
L_p_nopf:
s_waitcnt vmcnt(31)
v_mfma_f32_16x16x32_bf16 v[24:27], a[128:131], v[128:131], v[24:27]
v_mfma_f32_16x16x32_bf16 v[28:31], a[132:135], v[128:131], v[28:31]
s_waitcnt vmcnt(30)
v_mfma_f32_16x16x32_bf16 v[32:35], a[128:131], v[132:135], v[32:35]
v_mfma_f32_16x16x32_bf16 v[36:39], a[132:135], v[132:135], v[36:39]
s_waitcnt vmcnt(29)
v_mfma_f32_16x16x32_bf16 v[24:27], a[136:139], v[136:139], v[24:27]
v_mfma_f32_16x16x32_bf16 v[28:31], a[140:143], v[136:139], v[28:31]
s_waitcnt vmcnt(28)
v_mfma_f32_16x16x32_bf16 v[32:35], a[136:139], v[140:143], v[32:35]
v_mfma_f32_16x16x32_bf16 v[36:39], a[140:143], v[140:143], v[36:39]
s_waitcnt vmcnt(27)
v_mfma_f32_16x16x32_bf16 v[24:27], a[144:147], v[144:147], v[24:27]
v_mfma_f32_16x16x32_bf16 v[28:31], a[148:151], v[144:147], v[28:31]
s_waitcnt vmcnt(26)
v_mfma_f32_16x16x32_bf16 v[32:35], a[144:147], v[148:151], v[32:35]
v_mfma_f32_16x16x32_bf16 v[36:39], a[148:151], v[148:151], v[36:39]
s_waitcnt vmcnt(25)
v_mfma_f32_16x16x32_bf16 v[24:27], a[152:155], v[152:155], v[24:27]
v_mfma_f32_16x16x32_bf16 v[28:31], a[156:159], v[152:155], v[28:31]
s_waitcnt vmcnt(24)
v_mfma_f32_16x16x32_bf16 v[32:35], a[152:155], v[156:159], v[32:35]
v_mfma_f32_16x16x32_bf16 v[36:39], a[156:159], v[156:159], v[36:39]
s_waitcnt vmcnt(23)
v_mfma_f32_16x16x32_bf16 v[24:27], a[160:163], v[160:163], v[24:27]
v_mfma_f32_16x16x32_bf16 v[28:31], a[164:167], v[160:163], v[28:31]
s_waitcnt vmcnt(22)
v_mfma_f32_16x16x32_bf16 v[32:35], a[160:163], v[164:167], v[32:35]
v_mfma_f32_16x16x32_bf16 v[36:39], a[164:167], v[164:167], v[36:39]
s_waitcnt vmcnt(21)
v_mfma_f32_16x16x32_bf16 v[24:27], a[168:171], v[168:171], v[24:27]
v_mfma_f32_16x16x32_bf16 v[28:31], a[172:175], v[168:171], v[28:31]
s_waitcnt vmcnt(20)
v_mfma_f32_16x16x32_bf16 v[32:35], a[168:171], v[172:175], v[32:35]
v_mfma_f32_16x16x32_bf16 v[36:39], a[172:175], v[172:175], v[36:39]
s_waitcnt vmcnt(19)
v_mfma_f32_16x16x32_bf16 v[24:27], a[176:179], v[176:179], v[24:27]
v_mfma_f32_16x16x32_bf16 v[28:31], a[180:183], v[176:179], v[28:31]
s_waitcnt vmcnt(18)
v_mfma_f32_16x16x32_bf16 v[32:35], a[176:179], v[180:183], v[32:35]
v_mfma_f32_16x16x32_bf16 v[36:39], a[180:183], v[180:183], v[36:39]
s_waitcnt vmcnt(17)
v_mfma_f32_16x16x32_bf16 v[24:27], a[184:187], v[184:187], v[24:27]
v_mfma_f32_16x16x32_bf16 v[28:31], a[188:191], v[184:187], v[28:31]
s_waitcnt vmcnt(16)
v_mfma_f32_16x16x32_bf16 v[32:35], a[184:187], v[188:191], v[32:35]
v_mfma_f32_16x16x32_bf16 v[36:39], a[188:191], v[188:191], v[36:39]
s_waitcnt vmcnt(15)
v_mfma_f32_16x16x32_bf16 v[24:27], a[192:195], v[192:195], v[24:27]
v_mfma_f32_16x16x32_bf16 v[28:31], a[196:199], v[192:195], v[28:31]
s_waitcnt vmcnt(14)
v_mfma_f32_16x16x32_bf16 v[32:35], a[192:195], v[196:199], v[32:35]
v_mfma_f32_16x16x32_bf16 v[36:39], a[196:199], v[196:199], v[36:39]
s_waitcnt vmcnt(13)
v_mfma_f32_16x16x32_bf16 v[24:27], a[200:203], v[200:203], v[24:27]
v_mfma_f32_16x16x32_bf16 v[28:31], a[204:207], v[200:203], v[28:31]
s_waitcnt vmcnt(12)
v_mfma_f32_16x16x32_bf16 v[32:35], a[200:203], v[204:207], v[32:35]
v_mfma_f32_16x16x32_bf16 v[36:39], a[204:207], v[204:207], v[36:39]
s_waitcnt vmcnt(11)
v_mfma_f32_16x16x32_bf16 v[24:27], a[208:211], v[208:211], v[24:27]
v_mfma_f32_16x16x32_bf16 v[28:31], a[212:215], v[208:211], v[28:31]
s_waitcnt vmcnt(10)
v_mfma_f32_16x16x32_bf16 v[32:35], a[208:211], v[212:215], v[32:35]
v_mfma_f32_16x16x32_bf16 v[36:39], a[212:215], v[212:215], v[36:39]
s_waitcnt vmcnt(9)
v_mfma_f32_16x16x32_bf16 v[24:27], a[216:219], v[216:219], v[24:27]
v_mfma_f32_16x16x32_bf16 v[28:31], a[220:223], v[216:219], v[28:31]
s_waitcnt vmcnt(8)
v_mfma_f32_16x16x32_bf16 v[32:35], a[216:219], v[220:223], v[32:35]
v_mfma_f32_16x16x32_bf16 v[36:39], a[220:223], v[220:223], v[36:39]
s_waitcnt vmcnt(7)
v_mfma_f32_16x16x32_bf16 v[24:27], a[224:227], v[224:227], v[24:27]
v_mfma_f32_16x16x32_bf16 v[28:31], a[228:231], v[224:227], v[28:31]
s_waitcnt vmcnt(6)
v_mfma_f32_16x16x32_bf16 v[32:35], a[224:227], v[228:231], v[32:35]
v_mfma_f32_16x16x32_bf16 v[36:39], a[228:231], v[228:231], v[36:39]
s_waitcnt vmcnt(5)
v_mfma_f32_16x16x32_bf16 v[24:27], a[232:235], v[232:235], v[24:27]
v_mfma_f32_16x16x32_bf16 v[28:31], a[236:239], v[232:235], v[28:31]
s_waitcnt vmcnt(4)
v_mfma_f32_16x16x32_bf16 v[32:35], a[232:235], v[236:239], v[32:35]
v_mfma_f32_16x16x32_bf16 v[36:39], a[236:239], v[236:239], v[36:39]
s_waitcnt vmcnt(3)
v_mfma_f32_16x16x32_bf16 v[24:27], a[240:243], v[240:243], v[24:27]
v_mfma_f32_16x16x32_bf16 v[28:31], a[244:247], v[240:243], v[28:31]
s_waitcnt vmcnt(2)
v_mfma_f32_16x16x32_bf16 v[32:35], a[240:243], v[244:247], v[32:35]
v_mfma_f32_16x16x32_bf16 v[36:39], a[244:247], v[244:247], v[36:39]
s_waitcnt vmcnt(1)
v_mfma_f32_16x16x32_bf16 v[24:27], a[248:251], v[248:251], v[24:27]
v_mfma_f32_16x16x32_bf16 v[28:31], a[252:255], v[248:251], v[28:31]
s_waitcnt vmcnt(0)
v_mfma_f32_16x16x32_bf16 v[32:35], a[248:251], v[252:255], v[32:35]
v_mfma_f32_16x16x32_bf16 v[36:39], a[252:255], v[252:255], v[36:39]
L_p_red:
v_add_u32 v8, s58, v43
    s_nop 1
ds_write_b128 v8, v[24:27] offset:0
    s_nop 2
ds_write_b128 v8, v[28:31] offset:1024
ds_write_b128 v8, v[32:35] offset:2048
ds_write_b128 v8, v[36:39] offset:3072
v_add_u32 v8, s58, v50
s_waitcnt lgkmcnt(0)
s_barrier
s_and_b32 s18, s12, s89
s_cbranch_scc1 L_p_next
ds_read_b128 v[64:67], v8 offset:0
ds_read_b128 v[68:71], v8 offset:4096
ds_read_b128 v[72:75], v8 offset:8192
ds_read_b128 v[76:79], v8 offset:12288
v_lshlrev_b32 v52, 16, v48
v_and_b32 v53, s59, v48
v_lshlrev_b32 v54, 16, v49
v_and_b32 v55, s59, v49
v_sub_f32 v46, 1.0, v45
v_cvt_pk_bf16_f32 v46, v46, v46
v_lshlrev_b32 v46, 16, v46
s_lshr_b32 s18, s53, 4
s_lshl_b32 s19, s55, 1
s_add_u32 s19, s19, s88
s_cmp_eq_u32 s18, s19
s_cbranch_scc1 L_p_fix
L_p_fixd:
v_mul_f32 v52, v46, v52
v_mul_f32 v53, v46, v53
v_mul_f32 v54, v46, v54
v_mul_f32 v55, v46, v55
v_cvt_pk_bf16_f32 v48, v52, v53
v_cvt_pk_bf16_f32 v49, v54, v55
v_lshlrev_b32 v52, 16, v48
v_and_b32 v53, s59, v48
v_lshlrev_b32 v54, 16, v49
v_and_b32 v55, s59, v49
s_waitcnt lgkmcnt(0)
v_pk_add_f32 v[64:65], v[64:65], v[68:69]
v_pk_add_f32 v[72:73], v[72:73], v[76:77]
v_pk_add_f32 v[66:67], v[66:67], v[70:71]
v_pk_add_f32 v[74:75], v[74:75], v[78:79]
v_pk_add_f32 v[64:65], v[64:65], v[72:73]
v_pk_add_f32 v[66:67], v[66:67], v[74:75]
v_cvt_pk_bf16_f32 v72, v64, v65
v_cvt_pk_bf16_f32 v73, v66, v67
v_lshlrev_b32 v64, 16, v72
v_and_b32 v65, s59, v72
v_lshlrev_b32 v66, 16, v73
v_and_b32 v67, s59, v73
v_mul_f32 v64, v45, v64
v_mul_f32 v65, v45, v65
v_mul_f32 v66, v45, v66
v_mul_f32 v67, v45, v67
v_cvt_pk_bf16_f32 v72, v64, v65
v_cvt_pk_bf16_f32 v73, v66, v67
v_lshlrev_b32 v64, 16, v72
v_and_b32 v65, s59, v72
v_lshlrev_b32 v66, 16, v73
v_and_b32 v67, s59, v73
v_add_f32 v64, v64, v52
v_add_f32 v65, v65, v53
v_add_f32 v66, v66, v54
v_add_f32 v67, v67, v55
v_cvt_pk_bf16_f32 v72, v64, v65
v_cvt_pk_bf16_f32 v73, v66, v67
s_lshl_b32 s18, s55, 16
buffer_store_dwordx2 v[72:73], v41, s[36:39], s18 offen nt
L_p_next:
s_xor_b32 s58, s58, 16384
s_add_u32 s64, s64, 1
s_mov_b32 s55, s85
s_cmp_eq_u32 s86, 1
s_cbranch_scc1 L_p_seg
s_cmp_le_u32 s64, s87
s_cbranch_scc1 L_p_cold
s_cmp_eq_u32 s89, 1
s_cbranch_scc1 L_p_end
s_add_u32 s18, s61, 1
s_bitcmp1_b32 s18, 1
s_cbranch_scc1 L_p_end
s_mov_b32 s89, 1
s_mov_b32 s86, 0
s_mov_b32 s55, 63
s_and_b32 s88, s61, 1
s_lshl_b32 s18, s88, 15
v_add_u32 v41, s18, v41
s_lshl_b32 s18, s88, 6
v_add_u32 v42, s18, v42
s_mov_b32 s18, 4128768
s_mov_b32 s19, 8064
buffer_load_dwordx2 v[48:49], v41, s[32:35], s18 offen
buffer_load_dword v45, v42, s[4:7], s19 offen sc1
s_and_b32 s19, s55, 0x30
s_add_u32 s18, s55, s19
s_lshl_b32 s18, s18, 9
s_lshl_b32 s19, s12, 7
s_add_u32 s18, s18, s19
s_add_u32 s18, s18, 0x8190000
s_add_u32 s18, s18, s99
v_mov_b32 v40, s18
s_cmp_lt_u32 s55, 62
s_cbranch_scc1 L_p_fal
s_sub_u32 s18, s55, 62
s_lshl_b32 s18, s18, 16
s_lshl_b32 s19, s12, 14
s_add_u32 s18, s18, s19
s_add_u32 s18, s18, 0x81a0000
s_add_u32 s18, s18, s99
v_lshlrev_b32 v40, 7, v0
v_add_u32 v40, s18, v40
L_p_fal:
L_p_poll2:
buffer_load_dword v8, v40, s[4:7], 0 offen sc1
s_waitcnt vmcnt(0)
v_cmp_eq_u32 vcc, -1, v8
s_cbranch_vccz L_p_go2
s_sub_u32 s15, s15, 1
s_cbranch_scc1 L_exit
s_sleep 1
s_branch L_p_poll2
L_p_go2:
s_lshl_b32 s56, s55, 19
s_add_u32 s56, s56, s99
s_bitcmp1_b32 s55, 2
s_cselect_b32 s18, 8192, 0
s_xor_b32 s56, s56, s18
s_lshl_b32 s18, s88, 10
s_add_u32 s56, s56, s18
buffer_load_dwordx4 v[128:131], v44, s[4:7], s56 offen offset:0 sc1
buffer_load_dwordx4 v[132:135], v44, s[4:7], s56 offen offset:2048 sc1
s_add_u32 s56, s56, 4096
buffer_load_dwordx4 v[136:139], v44, s[4:7], s56 offen offset:0 sc1
buffer_load_dwordx4 v[140:143], v44, s[4:7], s56 offen offset:2048 sc1
s_add_u32 s56, s56, 12288
buffer_load_dwordx4 v[144:147], v44, s[4:7], s56 offen offset:0 sc1
buffer_load_dwordx4 v[148:151], v44, s[4:7], s56 offen offset:2048 sc1
s_add_u32 s56, s56, 4096
buffer_load_dwordx4 v[152:155], v44, s[4:7], s56 offen offset:0 sc1
buffer_load_dwordx4 v[156:159], v44, s[4:7], s56 offen offset:2048 sc1
s_add_u32 s56, s56, 12288
buffer_load_dwordx4 v[160:163], v44, s[4:7], s56 offen offset:0 sc1
buffer_load_dwordx4 v[164:167], v44, s[4:7], s56 offen offset:2048 sc1
s_add_u32 s56, s56, 4096
buffer_load_dwordx4 v[168:171], v44, s[4:7], s56 offen offset:0 sc1
buffer_load_dwordx4 v[172:175], v44, s[4:7], s56 offen offset:2048 sc1
s_add_u32 s56, s56, 12288
buffer_load_dwordx4 v[176:179], v44, s[4:7], s56 offen offset:0 sc1
buffer_load_dwordx4 v[180:183], v44, s[4:7], s56 offen offset:2048 sc1
s_add_u32 s56, s56, 4096
buffer_load_dwordx4 v[184:187], v44, s[4:7], s56 offen offset:0 sc1
buffer_load_dwordx4 v[188:191], v44, s[4:7], s56 offen offset:2048 sc1
s_add_u32 s56, s56, 12288
buffer_load_dwordx4 v[192:195], v44, s[4:7], s56 offen offset:0 sc1
buffer_load_dwordx4 v[196:199], v44, s[4:7], s56 offen offset:2048 sc1
s_add_u32 s56, s56, 4096
buffer_load_dwordx4 v[200:203], v44, s[4:7], s56 offen offset:0 sc1
buffer_load_dwordx4 v[204:207], v44, s[4:7], s56 offen offset:2048 sc1
s_add_u32 s56, s56, 12288
buffer_load_dwordx4 v[208:211], v44, s[4:7], s56 offen offset:0 sc1
buffer_load_dwordx4 v[212:215], v44, s[4:7], s56 offen offset:2048 sc1
s_add_u32 s56, s56, 4096
buffer_load_dwordx4 v[216:219], v44, s[4:7], s56 offen offset:0 sc1
buffer_load_dwordx4 v[220:223], v44, s[4:7], s56 offen offset:2048 sc1
s_add_u32 s56, s56, 12288
buffer_load_dwordx4 v[224:227], v44, s[4:7], s56 offen offset:0 sc1
buffer_load_dwordx4 v[228:231], v44, s[4:7], s56 offen offset:2048 sc1
s_add_u32 s56, s56, 4096
buffer_load_dwordx4 v[232:235], v44, s[4:7], s56 offen offset:0 sc1
buffer_load_dwordx4 v[236:239], v44, s[4:7], s56 offen offset:2048 sc1
s_add_u32 s56, s56, 12288
buffer_load_dwordx4 v[240:243], v44, s[4:7], s56 offen offset:0 sc1
buffer_load_dwordx4 v[244:247], v44, s[4:7], s56 offen offset:2048 sc1
s_add_u32 s56, s56, 4096
buffer_load_dwordx4 v[248:251], v44, s[4:7], s56 offen offset:0 sc1
buffer_load_dwordx4 v[252:255], v44, s[4:7], s56 offen offset:2048 sc1
s_waitcnt vmcnt(31)
v_mfma_f32_16x16x32_bf16 v[24:27], a[0:3], v[128:131], 0
v_mfma_f32_16x16x32_bf16 v[28:31], a[4:7], v[128:131], 0
s_waitcnt vmcnt(30)
v_mfma_f32_16x16x32_bf16 v[24:27], a[8:11], v[132:135], v[24:27]
v_mfma_f32_16x16x32_bf16 v[28:31], a[12:15], v[132:135], v[28:31]
s_waitcnt vmcnt(29)
v_mfma_f32_16x16x32_bf16 v[24:27], a[16:19], v[136:139], v[24:27]
v_mfma_f32_16x16x32_bf16 v[28:31], a[20:23], v[136:139], v[28:31]
s_waitcnt vmcnt(28)
v_mfma_f32_16x16x32_bf16 v[24:27], a[24:27], v[140:143], v[24:27]
v_mfma_f32_16x16x32_bf16 v[28:31], a[28:31], v[140:143], v[28:31]
s_waitcnt vmcnt(27)
v_mfma_f32_16x16x32_bf16 v[24:27], a[32:35], v[144:147], v[24:27]
v_mfma_f32_16x16x32_bf16 v[28:31], a[36:39], v[144:147], v[28:31]
s_waitcnt vmcnt(26)
v_mfma_f32_16x16x32_bf16 v[24:27], a[40:43], v[148:151], v[24:27]
v_mfma_f32_16x16x32_bf16 v[28:31], a[44:47], v[148:151], v[28:31]
s_waitcnt vmcnt(25)
v_mfma_f32_16x16x32_bf16 v[24:27], a[48:51], v[152:155], v[24:27]
v_mfma_f32_16x16x32_bf16 v[28:31], a[52:55], v[152:155], v[28:31]
s_waitcnt vmcnt(24)
v_mfma_f32_16x16x32_bf16 v[24:27], a[56:59], v[156:159], v[24:27]
v_mfma_f32_16x16x32_bf16 v[28:31], a[60:63], v[156:159], v[28:31]
s_waitcnt vmcnt(23)
v_mfma_f32_16x16x32_bf16 v[24:27], a[64:67], v[160:163], v[24:27]
v_mfma_f32_16x16x32_bf16 v[28:31], a[68:71], v[160:163], v[28:31]
s_waitcnt vmcnt(22)
v_mfma_f32_16x16x32_bf16 v[24:27], a[72:75], v[164:167], v[24:27]
v_mfma_f32_16x16x32_bf16 v[28:31], a[76:79], v[164:167], v[28:31]
s_waitcnt vmcnt(21)
v_mfma_f32_16x16x32_bf16 v[24:27], a[80:83], v[168:171], v[24:27]
v_mfma_f32_16x16x32_bf16 v[28:31], a[84:87], v[168:171], v[28:31]
s_waitcnt vmcnt(20)
v_mfma_f32_16x16x32_bf16 v[24:27], a[88:91], v[172:175], v[24:27]
v_mfma_f32_16x16x32_bf16 v[28:31], a[92:95], v[172:175], v[28:31]
s_waitcnt vmcnt(19)
v_mfma_f32_16x16x32_bf16 v[24:27], a[96:99], v[176:179], v[24:27]
v_mfma_f32_16x16x32_bf16 v[28:31], a[100:103], v[176:179], v[28:31]
s_waitcnt vmcnt(18)
v_mfma_f32_16x16x32_bf16 v[24:27], a[104:107], v[180:183], v[24:27]
v_mfma_f32_16x16x32_bf16 v[28:31], a[108:111], v[180:183], v[28:31]
s_waitcnt vmcnt(17)
v_mfma_f32_16x16x32_bf16 v[24:27], a[112:115], v[184:187], v[24:27]
v_mfma_f32_16x16x32_bf16 v[28:31], a[116:119], v[184:187], v[28:31]
s_waitcnt vmcnt(16)
v_mfma_f32_16x16x32_bf16 v[24:27], a[120:123], v[188:191], v[24:27]
v_mfma_f32_16x16x32_bf16 v[28:31], a[124:127], v[188:191], v[28:31]
s_waitcnt vmcnt(15)
v_mfma_f32_16x16x32_bf16 v[24:27], a[128:131], v[192:195], v[24:27]
v_mfma_f32_16x16x32_bf16 v[28:31], a[132:135], v[192:195], v[28:31]
s_waitcnt vmcnt(14)
v_mfma_f32_16x16x32_bf16 v[24:27], a[136:139], v[196:199], v[24:27]
v_mfma_f32_16x16x32_bf16 v[28:31], a[140:143], v[196:199], v[28:31]
s_waitcnt vmcnt(13)
v_mfma_f32_16x16x32_bf16 v[24:27], a[144:147], v[200:203], v[24:27]
v_mfma_f32_16x16x32_bf16 v[28:31], a[148:151], v[200:203], v[28:31]
s_waitcnt vmcnt(12)
v_mfma_f32_16x16x32_bf16 v[24:27], a[152:155], v[204:207], v[24:27]
v_mfma_f32_16x16x32_bf16 v[28:31], a[156:159], v[204:207], v[28:31]
s_waitcnt vmcnt(11)
v_mfma_f32_16x16x32_bf16 v[24:27], a[160:163], v[208:211], v[24:27]
v_mfma_f32_16x16x32_bf16 v[28:31], a[164:167], v[208:211], v[28:31]
s_waitcnt vmcnt(10)
v_mfma_f32_16x16x32_bf16 v[24:27], a[168:171], v[212:215], v[24:27]
v_mfma_f32_16x16x32_bf16 v[28:31], a[172:175], v[212:215], v[28:31]
s_waitcnt vmcnt(9)
v_mfma_f32_16x16x32_bf16 v[24:27], a[176:179], v[216:219], v[24:27]
v_mfma_f32_16x16x32_bf16 v[28:31], a[180:183], v[216:219], v[28:31]
s_waitcnt vmcnt(8)
v_mfma_f32_16x16x32_bf16 v[24:27], a[184:187], v[220:223], v[24:27]
v_mfma_f32_16x16x32_bf16 v[28:31], a[188:191], v[220:223], v[28:31]
s_waitcnt vmcnt(7)
v_mfma_f32_16x16x32_bf16 v[24:27], a[192:195], v[224:227], v[24:27]
v_mfma_f32_16x16x32_bf16 v[28:31], a[196:199], v[224:227], v[28:31]
s_waitcnt vmcnt(6)
v_mfma_f32_16x16x32_bf16 v[24:27], a[200:203], v[228:231], v[24:27]
v_mfma_f32_16x16x32_bf16 v[28:31], a[204:207], v[228:231], v[28:31]
s_waitcnt vmcnt(5)
v_mfma_f32_16x16x32_bf16 v[24:27], a[208:211], v[232:235], v[24:27]
v_mfma_f32_16x16x32_bf16 v[28:31], a[212:215], v[232:235], v[28:31]
s_waitcnt vmcnt(4)
v_mfma_f32_16x16x32_bf16 v[24:27], a[216:219], v[236:239], v[24:27]
v_mfma_f32_16x16x32_bf16 v[28:31], a[220:223], v[236:239], v[28:31]
s_waitcnt vmcnt(3)
v_mfma_f32_16x16x32_bf16 v[24:27], a[224:227], v[240:243], v[24:27]
v_mfma_f32_16x16x32_bf16 v[28:31], a[228:231], v[240:243], v[28:31]
s_waitcnt vmcnt(2)
v_mfma_f32_16x16x32_bf16 v[24:27], a[232:235], v[244:247], v[24:27]
v_mfma_f32_16x16x32_bf16 v[28:31], a[236:239], v[244:247], v[28:31]
s_waitcnt vmcnt(1)
v_mfma_f32_16x16x32_bf16 v[24:27], a[240:243], v[248:251], v[24:27]
v_mfma_f32_16x16x32_bf16 v[28:31], a[244:247], v[248:251], v[28:31]
s_waitcnt vmcnt(0)
v_mfma_f32_16x16x32_bf16 v[24:27], a[248:251], v[252:255], v[24:27]
v_mfma_f32_16x16x32_bf16 v[28:31], a[252:255], v[252:255], v[28:31]
s_branch L_p_red
L_p_end:
s_branch L_exit
L_p_fix:
v_min_u32 v10, 55, v0
v_lshlrev_b32 v10, 2, v10
s_mov_b32 s18, 0x8188000
L_p_yf:
buffer_load_dword v12, v10, s[4:7], s18 offen sc1
s_waitcnt vmcnt(0)
v_cmp_eq_u32 vcc, -1, v12
s_cbranch_vccz L_p_yok
s_sub_u32 s15, s15, 1
s_cbranch_scc1 L_exit
s_sleep 3
s_branch L_p_yf
L_p_yok:
v_cmp_lt_u32 vcc, 7, v4
v_mov_b32 v10, 0x7ff00000
    s_nop 0
v_cndmask_b32 v10, v47, v10, vcc
s_mov_b32 s18, 0x0
buffer_load_dwordx4 v[96:99], v47, s[4:7], s18 offen sc1
s_mov_b32 s18, 0x10000
buffer_load_dwordx4 v[100:103], v47, s[4:7], s18 offen sc1
s_mov_b32 s18, 0x20000
buffer_load_dwordx4 v[104:107], v47, s[4:7], s18 offen sc1
s_mov_b32 s18, 0x30000
buffer_load_dwordx4 v[108:111], v10, s[4:7], s18 offen sc1
s_waitcnt vmcnt(0)
v_add_f32 v96, v96, v100
v_add_f32 v97, v97, v101
v_add_f32 v98, v98, v102
v_add_f32 v99, v99, v103
v_add_f32 v96, v96, v104
v_add_f32 v97, v97, v105
v_add_f32 v98, v98, v106
v_add_f32 v99, v99, v107
v_add_f32 v96, v96, v108
v_add_f32 v97, v97, v109
v_add_f32 v98, v98, v110
v_add_f32 v99, v99, v111
v_add_f32_dpp v96, v96, v96 row_ror:8 row_mask:0xf bank_mask:0xf
v_add_f32_dpp v97, v97, v97 row_ror:8 row_mask:0xf bank_mask:0xf
v_add_f32_dpp v98, v98, v98 row_ror:8 row_mask:0xf bank_mask:0xf
v_add_f32_dpp v99, v99, v99 row_ror:8 row_mask:0xf bank_mask:0xf
v_add_f32_dpp v96, v96, v96 row_ror:4 row_mask:0xf bank_mask:0xf
v_add_f32_dpp v97, v97, v97 row_ror:4 row_mask:0xf bank_mask:0xf
v_add_f32_dpp v98, v98, v98 row_ror:4 row_mask:0xf bank_mask:0xf
v_add_f32_dpp v99, v99, v99 row_ror:4 row_mask:0xf bank_mask:0xf
v_add_f32_dpp v96, v96, v96 row_ror:2 row_mask:0xf bank_mask:0xf
v_add_f32_dpp v97, v97, v97 row_ror:2 row_mask:0xf bank_mask:0xf
v_add_f32_dpp v98, v98, v98 row_ror:2 row_mask:0xf bank_mask:0xf
v_add_f32_dpp v99, v99, v99 row_ror:2 row_mask:0xf bank_mask:0xf
v_add_f32_dpp v96, v96, v96 row_ror:1 row_mask:0xf bank_mask:0xf
v_add_f32_dpp v97, v97, v97 row_ror:1 row_mask:0xf bank_mask:0xf
v_add_f32_dpp v98, v98, v98 row_ror:1 row_mask:0xf bank_mask:0xf
v_add_f32_dpp v99, v99, v99 row_ror:1 row_mask:0xf bank_mask:0xf
v_cvt_pk_bf16_f32 v96, v96, v96
v_lshlrev_b32 v96, 16, v96
v_mul_f32 v96, s54, v96
v_cvt_pk_bf16_f32 v96, v96, v96
v_lshlrev_b32 v96, 16, v96
v_add_f32 v96, v96, v52
v_cvt_pk_bf16_f32 v96, v96, v96
v_lshlrev_b32 v96, 16, v96
v_cndmask_b32 v52, v52, v96, s[66:67]
v_cvt_pk_bf16_f32 v97, v97, v97
v_lshlrev_b32 v97, 16, v97
v_mul_f32 v97, s54, v97
v_cvt_pk_bf16_f32 v97, v97, v97
v_lshlrev_b32 v97, 16, v97
v_add_f32 v97, v97, v53
v_cvt_pk_bf16_f32 v97, v97, v97
v_lshlrev_b32 v97, 16, v97
v_cndmask_b32 v53, v53, v97, s[66:67]
v_cvt_pk_bf16_f32 v98, v98, v98
v_lshlrev_b32 v98, 16, v98
v_mul_f32 v98, s54, v98
v_cvt_pk_bf16_f32 v98, v98, v98
v_lshlrev_b32 v98, 16, v98
v_add_f32 v98, v98, v54
v_cvt_pk_bf16_f32 v98, v98, v98
v_lshlrev_b32 v98, 16, v98
v_cndmask_b32 v54, v54, v98, s[66:67]
v_cvt_pk_bf16_f32 v99, v99, v99
v_lshlrev_b32 v99, 16, v99
v_mul_f32 v99, s54, v99
v_cvt_pk_bf16_f32 v99, v99, v99
v_lshlrev_b32 v99, 16, v99
v_add_f32 v99, v99, v55
v_cvt_pk_bf16_f32 v99, v99, v99
v_lshlrev_b32 v99, 16, v99
v_cndmask_b32 v55, v55, v99, s[66:67]
s_branch L_p_fixd
L_exit:
s_endpgm
.section .rodata,"a"
.p2align 6
.amdhsa_kernel gated_mix__memory_aug_recurrent_mem_tr__moe_arch_mod__prompt_kernel
  .amdhsa_next_free_vgpr 512
  .amdhsa_next_free_sgpr 102
  .amdhsa_accum_offset 256
  .amdhsa_group_segment_fixed_size 0
  .amdhsa_kernarg_size 128
  .amdhsa_user_sgpr_count 2
  .amdhsa_user_sgpr_kernarg_segment_ptr 1
  .amdhsa_system_sgpr_workgroup_id_x 1
  .amdhsa_float_denorm_mode_32 3
.end_amdhsa_kernel
```
